```python
import torch

def _softmax(x, axis=-1):
    return torch.softmax(x, dim=axis)
def _gelu(x):
    return torch.nn.functional.gelu(x, approximate="tanh")
def _silu(x):
    return torch.nn.functional.silu(x)
def _sigmoid(x):
    return torch.sigmoid(x)
def _layernorm(x, axis=-1, eps=1e-5):
    m = x.mean(dim=axis, keepdim=True)
    v = x.var(dim=axis, keepdim=True, unbiased=False)
    return (x - m) / torch.sqrt(v + eps)
def _scatter_add(tgt, idx, src, axis=0):
    return tgt.clone().index_add_(axis, idx, src)
def _segment_sum(src, seg, n):
    out = torch.zeros((n,) + src.shape[1:], dtype=src.dtype)
    return out.index_add_(0, seg, src)
def _pad(x, pw):
    flat = tuple(v for pair in reversed(pw) for v in pair)
    return torch.nn.functional.pad(x, flat)

kernel_name = 'gated_mix__sliding_local_dilated__glu_gated_glu__prompt'

def setup_inputs():

    _w = (lambda a: (lambda t: t.to(torch.bfloat16) if t.is_floating_point() else t)(torch.as_tensor(a)))
    def _A_setup():
        B, S, D = 1, 2048, 576
        return {
            "x": _w((lambda *s: torch.randn(*s, dtype=torch.bfloat16) * 0.05)(B, S, D)),
            "wqkv": _w((lambda *s: torch.randn(*s, dtype=torch.bfloat16) * 0.8)(D, 3 * D)),
            "wo": _w((lambda *s: torch.randn(*s, dtype=torch.bfloat16) * 0.05)(D, D)),
        }
    _A_in = _A_setup()

    def _B_setup():
        B, S, D, F = 1, 2048, 576, 4608
        return {
            "x": _w((lambda *s: torch.randn(*s, dtype=torch.bfloat16) * 0.05)(B, S, D)),
            "w_gate": _w((lambda *s: torch.randn(*s, dtype=torch.bfloat16) * 1.6)(D, F)),
            "w_up": _w((lambda *s: torch.randn(*s, dtype=torch.bfloat16) * 0.1)(D, F)),
            "w_down": _w((lambda *s: torch.randn(*s, dtype=torch.bfloat16) * 0.1)(F, D)),
        }
    _B_in = _B_setup()

    return {
        "A_x": _A_in["x"],
        "A_wqkv": _A_in["wqkv"],
        "A_wo": _A_in["wo"],
        "B_x": _B_in["x"],
        "B_w_gate": _B_in["w_gate"],
        "B_w_up": _B_in["w_up"],
        "B_w_down": _B_in["w_down"],
        "gate_w": _w((lambda *s: torch.randn(*s, dtype=torch.bfloat16) * 0.05)(576) * 16.0),
    }

def reference(A_x, A_wqkv, A_wo, B_x, B_w_gate, B_w_up, B_w_down, gate_w):
    def _A_ref(x, wqkv, wo):
        B, S, D = x.shape
        H = 32; Dh = D // H
        W, dil = 8, 2
        qkv = (lambda x, *d: x.permute(*d))((x @ wqkv).reshape(B, S, 3, H, Dh), 2, 0, 3, 1, 4)
        q, k, v = qkv[0], qkv[1], qkv[2]
        scale = Dh ** -0.5
        pos = torch.arange(S)
        off = torch.arange(W) * dil
        idx = pos[:, None] - off[None, :]
        mask = idx >= 0
        idx_c = torch.where(mask, idx, 0).reshape(-1)
        kg = k[:, :, idx_c, :].reshape(B, H, S, W, Dh)
        vg = v[:, :, idx_c, :].reshape(B, H, S, W, Dh)
        logits = torch.einsum("bhsd,bhswd->bhsw", q, kg) * scale
        logits = torch.where(mask[None, None, :, :], logits, -1e9)
        attn = _softmax(logits, axis=-1)
        o = torch.einsum("bhsw,bhswd->bhsd", attn, vg)
        return (lambda x, *d: x.permute(*d))(o, 0, 2, 1, 3).reshape(B, S, D) @ wo

    def _B_ref(x, w_gate, w_up, w_down):
        g = torch.einsum("bsd,df->bsf", x, w_gate)
        u = torch.einsum("bsd,df->bsf", x, w_up)
        h = _sigmoid(g) * u
        return torch.einsum("bsf,fd->bsd", h, w_down)

    x = A_x
    g = _sigmoid((x * gate_w).sum(-1, keepdims=True))
    a = _A_ref(x, A_wqkv, A_wo)
    b = _B_ref(x, B_w_gate, B_w_up, B_w_down)
    return g * a + (1 - g) * b
```

```asm
; @launch grid=(256,1,1) block=(512,1,1) lds=163840
.amdgcn_target "amdgcn-amd-amdhsa--gfx950"
.text
.globl gated_mix__sliding_local_dilated__glu_gated_glu__prompt_kernel
.p2align 8
.type gated_mix__sliding_local_dilated__glu_gated_glu__prompt_kernel,@function
gated_mix__sliding_local_dilated__glu_gated_glu__prompt_kernel:
    s_cmp_ge_u32 s2, 256
    s_cbranch_scc1 L_end
    s_load_dwordx16 s[64:79], s[0:1], 0
    s_load_dwordx4 s[80:83], s[0:1], 64
    s_load_dwordx2 s[84:85], s[0:1], 80
    v_lshrrev_b32 v2, 6, v0
    v_and_b32 v1, 63, v0
    s_nop 0
    v_readfirstlane_b32 s36, v2
    s_and_b32 s50, s2, 7
    s_lshr_b32 s51, s2, 3
    s_and_b32 s37, s36, 3
    s_lshr_b32 s59, s36, 2
    s_lshr_b32 s38, s50, 1
    s_mov_b32 s49, 0xbfb8aa3b
    v_lshlrev_b32 v7, 4, v1
    s_lshl_b32 s62, s2, 3
    s_add_u32 s62, s62, s36
    s_lshl_b32 s62, s62, 8
    s_add_u32 s62, s62, 51380224
    s_cmp_eq_u32 s36, 3
    s_cbranch_scc0 L_nocpf
    s_getpc_b64 s[4:5]
    L_pc:
    s_sub_u32 s4, s4, L_pc-gated_mix__sliding_local_dilated__glu_gated_glu__prompt_kernel
    s_subb_u32 s5, s5, 0
    s_lshl_b32 s6, s51, 11
    v_lshlrev_b32 v56, 7, v1
    v_add_u32 v56, s6, v56
    v_cmp_gt_u32 vcc, 16, v1
    v_mov_b32 v57, L_codeend-gated_mix__sliding_local_dilated__glu_gated_glu__prompt_kernel
    v_cmp_lt_u32 s[6:7], v56, v57
    s_and_b64 vcc, vcc, s[6:7]
    s_and_saveexec_b64 s[6:7], vcc
    s_cbranch_execz L_cpf2
    global_load_dword v61, v56, s[4:5]
    L_cpf2:
    s_mov_b64 exec, -1
L_nocpf:
    s_cmp_ge_u32 s51, 24
    s_cbranch_scc1 L_att
    s_mul_i32 s39, s51, 43
    s_lshr_b32 s39, s39, 8
    s_mul_i32 s40, s39, 6
    s_sub_u32 s40, s51, s40
    s_and_b32 s50, s50, 1
    s_lshl_b32 s50, s50, 2
    s_add_u32 s39, s39, s50
    s_mul_i32 s41, s38, 6
    s_add_u32 s41, s41, s40
    s_cmp_ge_u32 s40, 3
    s_cselect_b32 s42, 1, 0
    s_mul_i32 s43, s42, 3
    s_sub_u32 s43, s40, s43
    s_and_b32 s57, s37, 1
    s_lshr_b32 s63, s37, 1
    s_mul_i32 s44, s57, 147456
    s_mul_i32 s48, s41, 384
    s_add_u32 s44, s44, s48
    s_mul_i32 s45, s63, 6176
    s_mul_i32 s48, s57, 3072
    s_add_u32 s45, s45, s48
    s_add_u32 s45, s45, 98304
    s_lshl_b32 s46, s39, 8
    s_lshl_b32 s48, s37, 5
    s_add_u32 s46, s46, s48
    s_mul_i32 s46, s46, 1152
    s_lshl_b32 s47, s37, 12
    v_add_u32 v56, 0, v1
    s_mov_b32 s50, 5462
    v_mul_u32_u24 v57, s50, v56
    v_lshrrev_b32 v57, 16, v57
    v_mul_u32_u24 v58, 12, v57
    v_sub_u32 v58, v56, v58
    v_bfe_u32 v56, v57, 3, 1
    v_lshlrev_b32 v56, 1, v56
    v_xor_b32 v58, v58, v56
    s_mov_b32 s50, 9216
    v_mul_u32_u24 v57, s50, v57
    v_lshl_add_u32 v8, v58, 4, v57
    v_add_u32 v56, 64, v1
    s_mov_b32 s50, 5462
    v_mul_u32_u24 v57, s50, v56
    v_lshrrev_b32 v57, 16, v57
    v_mul_u32_u24 v58, 12, v57
    v_sub_u32 v58, v56, v58
    v_bfe_u32 v56, v57, 3, 1
    v_lshlrev_b32 v56, 1, v56
    v_xor_b32 v58, v58, v56
    s_mov_b32 s50, 9216
    v_mul_u32_u24 v57, s50, v57
    v_lshl_add_u32 v9, v58, 4, v57
    v_add_u32 v56, 128, v1
    s_mov_b32 s50, 5462
    v_mul_u32_u24 v57, s50, v56
    v_lshrrev_b32 v57, 16, v57
    v_mul_u32_u24 v58, 12, v57
    v_sub_u32 v58, v56, v58
    v_bfe_u32 v56, v57, 3, 1
    v_lshlrev_b32 v56, 1, v56
    v_xor_b32 v58, v58, v56
    s_mov_b32 s50, 9216
    v_mul_u32_u24 v57, s50, v57
    v_lshl_add_u32 v10, v58, 4, v57
    v_lshrrev_b32 v56, 3, v1
    v_and_b32 v57, 7, v1
    v_lshrrev_b32 v58, 1, v56
    s_mov_b32 s50, 1152
    v_mul_u32_u24 v56, s50, v56
    v_xor_b32 v57, v57, v58
    v_lshl_add_u32 v11, v57, 4, v56
    v_xor_b32 v57, 4, v57
    v_lshl_add_u32 v12, v57, 4, v56
    s_waitcnt lgkmcnt(0)
    s_mov_b32 s8, s64
    s_and_b32 s9, s65, 0xffff
    s_mov_b32 s10, 0x240000
    s_mov_b32 s11, 0x20000
    s_cmp_lt_u32 s37, 2
    s_cselect_b32 s55, s72, s74
    s_cselect_b32 s56, s73, s75
    s_mov_b32 s12, s55
    s_and_b32 s13, s56, 0xffff
    s_mov_b32 s14, 0x510000
    s_mov_b32 s15, 0x20000
    s_mov_b32 s20, s84
    s_and_b32 s21, s85, 0xffff
    s_mov_b32 s22, 0x4000000
    s_mov_b32 s23, 0x20000
    s_mov_b32 s28, s82
    s_and_b32 s29, s83, 0xffff
    s_mov_b32 s30, 0x100
    s_mov_b32 s31, 0x20000
    s_and_b32 s52, s39, 3
    s_add_u32 s52, s52, s40
    s_mov_b32 s53, s44
    s_mov_b32 s54, s46
    s_add_u32 s55, s52, 0
    s_mul_i32 s50, s55, 11
    s_lshr_b32 s50, s50, 5
    s_mul_i32 s50, s50, 3
    s_sub_u32 s55, s55, s50
    s_mul_i32 s56, s55, 589824
    s_add_u32 s44, s53, s56
    s_lshl_b32 s56, s55, 7
    s_add_u32 s46, s54, s56
    s_add_u32 s55, s52, 1
    s_mul_i32 s50, s55, 11
    s_lshr_b32 s50, s50, 5
    s_mul_i32 s50, s50, 3
    s_sub_u32 s55, s55, s50
    s_mul_i32 s56, s55, 589824
    s_add_u32 s82, s53, s56
    s_lshl_b32 s56, s55, 7
    s_add_u32 s84, s54, s56
    s_add_u32 s55, s52, 2
    s_mul_i32 s50, s55, 11
    s_lshr_b32 s50, s50, 5
    s_mul_i32 s50, s50, 3
    s_sub_u32 s55, s55, s50
    s_mul_i32 s56, s55, 589824
    s_add_u32 s83, s53, s56
    s_lshl_b32 s56, s55, 7
    s_add_u32 s85, s54, s56
    s_mov_b32 s97, s54
    s_cmp_eq_u32 s59, 1
    s_cbranch_scc1 L_skipdma
    s_add_u32 m0, s45, 0x0
    s_add_u32 s50, s44, 0x0
    buffer_load_dwordx4 v8, s[12:15], s50 offen lds
    s_add_u32 m0, s45, 0x400
    s_add_u32 s50, s44, 0x0
    buffer_load_dwordx4 v9, s[12:15], s50 offen lds
    s_add_u32 m0, s45, 0x800
    s_add_u32 s50, s44, 0x0
    buffer_load_dwordx4 v10, s[12:15], s50 offen lds
    s_add_u32 m0, s47, 0x0
    s_add_u32 s50, s46, 0x0
    buffer_load_dwordx4 v11, s[8:11], s50 offen lds
    s_add_u32 m0, s47, 0x400
    s_add_u32 s50, s46, 0x2400
    buffer_load_dwordx4 v12, s[8:11], s50 offen lds
    s_add_u32 m0, s47, 0x800
    s_add_u32 s50, s46, 0x4800
    buffer_load_dwordx4 v11, s[8:11], s50 offen lds
    s_add_u32 m0, s47, 0xc00
    s_add_u32 s50, s46, 0x6c00
    buffer_load_dwordx4 v12, s[8:11], s50 offen lds
    s_add_u32 m0, s47, 0x4000
    s_add_u32 s50, s46, 0x24000
    buffer_load_dwordx4 v11, s[8:11], s50 offen lds
    s_add_u32 m0, s47, 0x4400
    s_add_u32 s50, s46, 0x26400
    buffer_load_dwordx4 v12, s[8:11], s50 offen lds
    s_add_u32 m0, s47, 0x4800
    s_add_u32 s50, s46, 0x28800
    buffer_load_dwordx4 v11, s[8:11], s50 offen lds
    s_add_u32 m0, s47, 0x4c00
    s_add_u32 s50, s46, 0x2ac00
    buffer_load_dwordx4 v12, s[8:11], s50 offen lds
    s_add_u32 m0, s45, 0x3020
    s_add_u32 s50, s44, 0x48000
    buffer_load_dwordx4 v8, s[12:15], s50 offen lds
    s_add_u32 m0, s45, 0x3420
    s_add_u32 s50, s44, 0x48000
    buffer_load_dwordx4 v9, s[12:15], s50 offen lds
    s_add_u32 m0, s45, 0x3820
    s_add_u32 s50, s44, 0x48000
    buffer_load_dwordx4 v10, s[12:15], s50 offen lds
L_skipdma:
    s_mov_b32 s16, s76
    s_and_b32 s17, s77, 0xffff
    s_mov_b32 s18, 0x510000
    s_mov_b32 s19, 0x20000
    s_mov_b32 s32, s78
    s_and_b32 s33, s79, 0xffff
    s_mov_b32 s34, 0x480
    s_mov_b32 s35, 0x20000
    s_mov_b32 s24, s80
    s_and_b32 s25, s81, 0xffff
    s_mov_b32 s26, 0x240000
    s_mov_b32 s27, 0x20000
    s_lshl_b32 s98, s39, 2
    s_add_u32 s98, s98, s38
    s_mul_i32 s98, s98, 602112
    s_mul_i32 s48, s40, 98304
    s_add_u32 s48, s48, s98
    s_lshl_b32 s55, s37, 12
    s_add_u32 s48, s48, s55
    s_add_u32 s48, s48, 12288
    s_mov_b32 s86, 12320
    s_mov_b32 s87, 32768
    s_mov_b32 s6, s49
    s_mov_b32 s7, s49
    v_lshrrev_b32 v58, 4, v1
    v_lshlrev_b32 v56, 3, v58
    v_bfe_u32 v57, v1, 2, 2
    v_add_u32 v56, v56, v57
    s_mov_b32 s55, 192
    v_mul_u32_u24 v56, s55, v56
    v_and_b32 v57, 3, v1
    v_lshl_add_u32 v56, v57, 3, v56
    s_mul_i32 s56, s59, 36960
    s_add_u32 s55, s56, 98304
    v_add_u32 v56, s55, v56
    v_and_b32 v57, 1, v58
    v_lshlrev_b32 v57, 5, v57
    v_add_u32 v2, v56, v57
    v_sub_u32 v3, v56, v57
    s_mul_i32 s53, s59, 3
    s_mov_b32 s54, 0
    v_and_b32 v56, 15, v1
    v_lshrrev_b32 v57, 1, v56
    v_xor_b32 v57, v57, v58
    v_lshlrev_b32 v56, 7, v56
    v_lshl_add_u32 v4, v57, 4, v56
    s_lshl_b32 s55, s37, 13
    v_add_u32 v4, s55, v4
    v_xor_b32 v5, 64, v4
    s_mul_i32 s58, s37, 6144
    s_mul_i32 s55, s38, 1152
    s_mul_i32 s56, s63, 192
    s_add_u32 s55, s55, s56
    s_mul_i32 s56, s57, 16
    s_add_u32 s55, s55, s56
    s_mul_i32 s55, s55, 1152
    s_mul_i32 s56, s43, 384
    s_add_u32 s88, s55, s56
    s_add_u32 s55, s98, 12288
    s_lshl_b32 s56, s42, 13
    s_add_u32 s55, s55, s56
    s_lshl_b32 s56, s37, 11
    s_add_u32 s91, s55, s56
    s_and_b32 s52, s39, 3
    s_add_u32 s52, s52, s43
    s_add_u32 s52, s52, s42
    s_mov_b32 s101, s88
    s_mov_b32 s100, s91
    s_add_u32 s55, s52, 0
    s_mul_i32 s50, s55, 11
    s_lshr_b32 s50, s50, 5
    s_mul_i32 s50, s50, 3
    s_sub_u32 s55, s55, s50
    s_mul_i32 s56, s55, 442368
    s_add_u32 s88, s101, s56
    s_mul_i32 s56, s55, 196608
    s_add_u32 s91, s100, s56
    s_add_u32 s92, s91, 98304
    s_add_u32 s55, s52, 1
    s_mul_i32 s50, s55, 11
    s_lshr_b32 s50, s50, 5
    s_mul_i32 s50, s50, 3
    s_sub_u32 s55, s55, s50
    s_mul_i32 s56, s55, 442368
    s_add_u32 s89, s101, s56
    s_mul_i32 s56, s55, 196608
    s_add_u32 s93, s100, s56
    s_add_u32 s94, s93, 98304
    s_add_u32 s55, s52, 2
    s_mul_i32 s50, s55, 11
    s_lshr_b32 s50, s50, 5
    s_mul_i32 s50, s50, 3
    s_sub_u32 s55, s55, s50
    s_mul_i32 s56, s55, 442368
    s_add_u32 s90, s101, s56
    s_mul_i32 s56, s55, 196608
    s_add_u32 s95, s100, s56
    s_add_u32 s96, s95, 98304
    s_lshl_b32 s55, s39, 1
    s_add_u32 s55, s55, s42
    s_mul_i32 s55, s55, 3
    s_add_u32 s55, s55, s43
    s_lshl_b32 s55, s55, 2
    s_cmp_eq_u32 s59, 0
    s_cselect_b32 s56, s37, s38
    s_add_u32 s101, s55, s56
    s_mul_i32 s99, s63, 6144
    s_add_u32 s99, s99, s98
    s_lshl_b32 s56, s40, 1
    s_add_u32 s56, s56, s57
    s_lshl_b32 s56, s56, 7
    s_add_u32 s99, s99, s56
    s_mul_i32 s56, s42, 6144
    s_add_u32 s98, s98, s56
    s_mul_i32 s101, s101, 101376
    s_add_u32 s101, s101, 20971520
    v_add_u32 v56, 0, v1
    s_mov_b32 s50, 2731
    v_mul_u32_u24 v57, s50, v56
    v_lshrrev_b32 v57, 16, v57
    v_mul_u32_u24 v58, 24, v57
    v_sub_u32 v58, v56, v58
    v_bfe_u32 v56, v57, 1, 1
    v_lshlrev_b32 v56, 2, v56
    v_xor_b32 v58, v58, v56
    s_mov_b32 s50, 1152
    v_mul_u32_u24 v57, s50, v57
    v_lshl_add_u32 v13, v58, 4, v57
    v_add_u32 v56, 64, v1
    s_mov_b32 s50, 2731
    v_mul_u32_u24 v57, s50, v56
    v_lshrrev_b32 v57, 16, v57
    v_mul_u32_u24 v58, 24, v57
    v_sub_u32 v58, v56, v58
    v_bfe_u32 v56, v57, 1, 1
    v_lshlrev_b32 v56, 2, v56
    v_xor_b32 v58, v58, v56
    s_mov_b32 s50, 1152
    v_mul_u32_u24 v57, s50, v57
    v_lshl_add_u32 v14, v58, 4, v57
    v_add_u32 v56, 128, v1
    s_mov_b32 s50, 2731
    v_mul_u32_u24 v57, s50, v56
    v_lshrrev_b32 v57, 16, v57
    v_mul_u32_u24 v58, 24, v57
    v_sub_u32 v58, v56, v58
    v_bfe_u32 v56, v57, 1, 1
    v_lshlrev_b32 v56, 2, v56
    v_xor_b32 v58, v58, v56
    s_mov_b32 s50, 1152
    v_mul_u32_u24 v57, s50, v57
    v_lshl_add_u32 v15, v58, 4, v57
    v_lshlrev_b32 v59, 2, v1
    v_lshlrev_b32 v56, 5, v1
    v_add_u32 v56, 160928, v56
    ds_write_b128 v56, v[8:11]
    ds_write_b128 v56, v[12:15] offset:16
    s_waitcnt lgkmcnt(0)
    s_cmp_eq_u32 s59, 1
    s_cbranch_scc1 L_Y
    s_lshl_b32 s55, s38, 7
    s_add_u32 s97, s101, s55
    v_lshrrev_b32 v58, 3, v1
    s_movk_i32 s55, 1536
    v_mul_u32_u24 v56, s55, v58
    v_add_u32 v56, s99, v56
    v_lshlrev_b32 v57, 9, v58
    s_sub_u32 s55, s97, 2048
    v_add_u32 v57, s55, v57
    v_cmp_lt_u32 vcc, 3, v58
    v_and_b32 v58, 7, v1
    s_nop 0
    v_cndmask_b32 v56, v56, v57, vcc
    v_lshl_add_u32 v56, v58, 4, v56
    v_mov_b32 v52, 0
    v_mov_b32 v53, 0
    v_mov_b32 v54, 0
    v_mov_b32 v55, 0
    s_mov_b32 exec_hi, 0xffffff
    buffer_store_dwordx4 v[52:55], v56, s[20:23], 0 offen sc1
    s_mov_b32 exec_hi, -1
    v_mov_b32 v64, 0
    v_mov_b32 v65, 0
    v_mov_b32 v66, 0
    v_mov_b32 v67, 0
    v_mov_b32 v68, 0
    v_mov_b32 v69, 0
    v_mov_b32 v70, 0
    v_mov_b32 v71, 0
    v_mov_b32 v72, 0
    v_mov_b32 v73, 0
    v_mov_b32 v74, 0
    v_mov_b32 v75, 0
    v_mov_b32 v76, 0
    v_mov_b32 v77, 0
    v_mov_b32 v78, 0
    v_mov_b32 v79, 0
    v_mov_b32 v80, 0
    v_mov_b32 v81, 0
    v_mov_b32 v82, 0
    v_mov_b32 v83, 0
    v_mov_b32 v84, 0
    v_mov_b32 v85, 0
    v_mov_b32 v86, 0
    v_mov_b32 v87, 0
    v_mov_b32 v88, 0
    v_mov_b32 v89, 0
    v_mov_b32 v90, 0
    v_mov_b32 v91, 0
    v_mov_b32 v92, 0
    v_mov_b32 v93, 0
    v_mov_b32 v94, 0
    v_mov_b32 v95, 0
    v_mov_b32 v96, 0
    v_mov_b32 v97, 0
    v_mov_b32 v98, 0
    v_mov_b32 v99, 0
    v_mov_b32 v100, 0
    v_mov_b32 v101, 0
    v_mov_b32 v102, 0
    v_mov_b32 v103, 0
    v_mov_b32 v104, 0
    v_mov_b32 v105, 0
    v_mov_b32 v106, 0
    v_mov_b32 v107, 0
    v_mov_b32 v108, 0
    v_mov_b32 v109, 0
    v_mov_b32 v110, 0
    v_mov_b32 v111, 0
    v_mov_b32 v112, 0
    v_mov_b32 v113, 0
    v_mov_b32 v114, 0
    v_mov_b32 v115, 0
    v_mov_b32 v116, 0
    v_mov_b32 v117, 0
    v_mov_b32 v118, 0
    v_mov_b32 v119, 0
    v_mov_b32 v120, 0
    v_mov_b32 v121, 0
    v_mov_b32 v122, 0
    v_mov_b32 v123, 0
    v_mov_b32 v124, 0
    v_mov_b32 v125, 0
    v_mov_b32 v126, 0
    v_mov_b32 v127, 0
    v_mov_b32 v128, 0
    v_mov_b32 v129, 0
    v_mov_b32 v130, 0
    v_mov_b32 v131, 0
    v_mov_b32 v132, 0
    v_mov_b32 v133, 0
    v_mov_b32 v134, 0
    v_mov_b32 v135, 0
    v_mov_b32 v136, 0
    v_mov_b32 v137, 0
    v_mov_b32 v138, 0
    v_mov_b32 v139, 0
    v_mov_b32 v140, 0
    v_mov_b32 v141, 0
    v_mov_b32 v142, 0
    v_mov_b32 v143, 0
    v_mov_b32 v144, 0
    v_mov_b32 v145, 0
    v_mov_b32 v146, 0
    v_mov_b32 v147, 0
    v_mov_b32 v148, 0
    v_mov_b32 v149, 0
    v_mov_b32 v150, 0
    v_mov_b32 v151, 0
    v_mov_b32 v152, 0
    v_mov_b32 v153, 0
    v_mov_b32 v154, 0
    v_mov_b32 v155, 0
    v_mov_b32 v156, 0
    v_mov_b32 v157, 0
    v_mov_b32 v158, 0
    v_mov_b32 v159, 0
    v_mov_b32 v160, 0
    v_mov_b32 v161, 0
    v_mov_b32 v162, 0
    v_mov_b32 v163, 0
    v_mov_b32 v164, 0
    v_mov_b32 v165, 0
    v_mov_b32 v166, 0
    v_mov_b32 v167, 0
    v_mov_b32 v168, 0
    v_mov_b32 v169, 0
    v_mov_b32 v170, 0
    v_mov_b32 v171, 0
    v_mov_b32 v172, 0
    v_mov_b32 v173, 0
    v_mov_b32 v174, 0
    v_mov_b32 v175, 0
    v_mov_b32 v176, 0
    v_mov_b32 v177, 0
    v_mov_b32 v178, 0
    v_mov_b32 v179, 0
    v_mov_b32 v180, 0
    v_mov_b32 v181, 0
    v_mov_b32 v182, 0
    v_mov_b32 v183, 0
    v_mov_b32 v184, 0
    v_mov_b32 v185, 0
    v_mov_b32 v186, 0
    v_mov_b32 v187, 0
    v_mov_b32 v188, 0
    v_mov_b32 v189, 0
    v_mov_b32 v190, 0
    v_mov_b32 v191, 0
    v_mov_b32 v192, 0
    v_mov_b32 v193, 0
    v_mov_b32 v194, 0
    v_mov_b32 v195, 0
    v_mov_b32 v196, 0
    v_mov_b32 v197, 0
    v_mov_b32 v198, 0
    v_mov_b32 v199, 0
    v_mov_b32 v200, 0
    v_mov_b32 v201, 0
    v_mov_b32 v202, 0
    v_mov_b32 v203, 0
    v_mov_b32 v204, 0
    v_mov_b32 v205, 0
    v_mov_b32 v206, 0
    v_mov_b32 v207, 0
    v_mov_b32 v208, 0
    v_mov_b32 v209, 0
    v_mov_b32 v210, 0
    v_mov_b32 v211, 0
    v_mov_b32 v212, 0
    v_mov_b32 v213, 0
    v_mov_b32 v214, 0
    v_mov_b32 v215, 0
    v_mov_b32 v216, 0
    v_mov_b32 v217, 0
    v_mov_b32 v218, 0
    v_mov_b32 v219, 0
    v_mov_b32 v220, 0
    v_mov_b32 v221, 0
    v_mov_b32 v222, 0
    v_mov_b32 v223, 0
    v_mov_b32 v224, 0
    v_mov_b32 v225, 0
    v_mov_b32 v226, 0
    v_mov_b32 v227, 0
    v_mov_b32 v228, 0
    v_mov_b32 v229, 0
    v_mov_b32 v230, 0
    v_mov_b32 v231, 0
    v_mov_b32 v232, 0
    v_mov_b32 v233, 0
    v_mov_b32 v234, 0
    v_mov_b32 v235, 0
    v_mov_b32 v236, 0
    v_mov_b32 v237, 0
    v_mov_b32 v238, 0
    v_mov_b32 v239, 0
    v_mov_b32 v240, 0
    v_mov_b32 v241, 0
    v_mov_b32 v242, 0
    v_mov_b32 v243, 0
    v_mov_b32 v244, 0
    v_mov_b32 v245, 0
    v_mov_b32 v246, 0
    v_mov_b32 v247, 0
    v_mov_b32 v248, 0
    v_mov_b32 v249, 0
    v_mov_b32 v250, 0
    v_mov_b32 v251, 0
    v_mov_b32 v252, 0
    v_mov_b32 v253, 0
    v_mov_b32 v254, 0
    v_mov_b32 v255, 0
    s_waitcnt vmcnt(0)
    s_barrier
    ds_read_b128 v[40:43], v4 offset:0
    ds_read_b128 v[44:47], v4 offset:2048
    ds_read_b128 v[48:51], v4 offset:4096
    ds_read_b128 v[52:55], v4 offset:6144
    ds_read_b64_tr_b16 v[16:17], v2 offset:0
    ds_read_b64_tr_b16 v[18:19], v2 offset:768
    ds_read_b64_tr_b16 v[20:21], v2 offset:6176
    ds_read_b64_tr_b16 v[22:23], v2 offset:6944
    ds_read_b64_tr_b16 v[24:25], v3 offset:32
    ds_read_b64_tr_b16 v[26:27], v3 offset:800
    ds_read_b64_tr_b16 v[28:29], v3 offset:6208
    ds_read_b64_tr_b16 v[30:31], v3 offset:6976
    ds_read_b64_tr_b16 v[32:33], v2 offset:64
    ds_read_b64_tr_b16 v[34:35], v2 offset:832
    s_branch L_passentry
L_Y:
    v_lshrrev_b32 v56, 5, v1
    v_lshlrev_b32 v56, 4, v56
    s_lshl_b32 s55, s37, 5
    v_add_u32 v56, s55, v56
    s_sub_u32 s50, s46, s97
    buffer_load_dwordx4 v[16:19], v56, s[32:35], s50 offen offset:0
    s_sub_u32 s50, s84, s97
    buffer_load_dwordx4 v[20:23], v56, s[32:35], s50 offen offset:0
    s_sub_u32 s50, s85, s97
    buffer_load_dwordx4 v[24:27], v56, s[32:35], s50 offen offset:0
    s_sub_u32 s50, s46, s97
    buffer_load_dwordx4 v[28:31], v56, s[32:35], s50 offen offset:384
    s_sub_u32 s50, s84, s97
    buffer_load_dwordx4 v[32:35], v56, s[32:35], s50 offen offset:384
    s_sub_u32 s50, s85, s97
    buffer_load_dwordx4 v[36:39], v56, s[32:35], s50 offen offset:384
    s_sub_u32 s50, s46, s97
    buffer_load_dwordx4 v[40:43], v56, s[32:35], s50 offen offset:768
    s_sub_u32 s50, s84, s97
    buffer_load_dwordx4 v[44:47], v56, s[32:35], s50 offen offset:768
    s_sub_u32 s50, s85, s97
    buffer_load_dwordx4 v[48:51], v56, s[32:35], s50 offen offset:768
    v_and_b32 v57, 31, v1
    v_bfe_u32 v58, v1, 1, 3
    v_lshrrev_b32 v56, 4, v56
    v_xor_b32 v58, v58, v56
    v_lshlrev_b32 v57, 7, v57
    v_lshl_add_u32 v57, v58, 4, v57
    s_lshl_b32 s55, s42, 14
    s_lshl_b32 s56, s38, 12
    s_add_u32 s55, s55, s56
    v_add_u32 v57, s55, v57
    v_add_u32 v0, 65536, v57
    v_mov_b32 v56, 0
    v_mov_b32 v64, 0
    v_mov_b32 v65, 0
    v_mov_b32 v66, 0
    v_mov_b32 v67, 0
    v_mov_b32 v68, 0
    v_mov_b32 v69, 0
    v_mov_b32 v70, 0
    v_mov_b32 v71, 0
    v_mov_b32 v72, 0
    v_mov_b32 v73, 0
    v_mov_b32 v74, 0
    v_mov_b32 v75, 0
    v_mov_b32 v76, 0
    v_mov_b32 v77, 0
    v_mov_b32 v78, 0
    v_mov_b32 v79, 0
    v_mov_b32 v80, 0
    v_mov_b32 v81, 0
    v_mov_b32 v82, 0
    v_mov_b32 v83, 0
    v_mov_b32 v84, 0
    v_mov_b32 v85, 0
    v_mov_b32 v86, 0
    v_mov_b32 v87, 0
    v_mov_b32 v88, 0
    v_mov_b32 v89, 0
    v_mov_b32 v90, 0
    v_mov_b32 v91, 0
    v_mov_b32 v92, 0
    v_mov_b32 v93, 0
    v_mov_b32 v94, 0
    v_mov_b32 v95, 0
    v_mov_b32 v96, 0
    v_mov_b32 v97, 0
    v_mov_b32 v98, 0
    v_mov_b32 v99, 0
    v_mov_b32 v100, 0
    v_mov_b32 v101, 0
    v_mov_b32 v102, 0
    v_mov_b32 v103, 0
    v_mov_b32 v104, 0
    v_mov_b32 v105, 0
    v_mov_b32 v106, 0
    v_mov_b32 v107, 0
    v_mov_b32 v108, 0
    v_mov_b32 v109, 0
    v_mov_b32 v110, 0
    v_mov_b32 v111, 0
    v_mov_b32 v112, 0
    v_mov_b32 v113, 0
    v_mov_b32 v114, 0
    v_mov_b32 v115, 0
    v_mov_b32 v116, 0
    v_mov_b32 v117, 0
    v_mov_b32 v118, 0
    v_mov_b32 v119, 0
    v_mov_b32 v120, 0
    v_mov_b32 v121, 0
    v_mov_b32 v122, 0
    v_mov_b32 v123, 0
    v_mov_b32 v124, 0
    v_mov_b32 v125, 0
    v_mov_b32 v126, 0
    v_mov_b32 v127, 0
    v_mov_b32 v128, 0
    v_mov_b32 v129, 0
    v_mov_b32 v130, 0
    v_mov_b32 v131, 0
    v_mov_b32 v132, 0
    v_mov_b32 v133, 0
    v_mov_b32 v134, 0
    v_mov_b32 v135, 0
    v_mov_b32 v136, 0
    v_mov_b32 v137, 0
    v_mov_b32 v138, 0
    v_mov_b32 v139, 0
    v_mov_b32 v140, 0
    v_mov_b32 v141, 0
    v_mov_b32 v142, 0
    v_mov_b32 v143, 0
    v_mov_b32 v144, 0
    v_mov_b32 v145, 0
    v_mov_b32 v146, 0
    v_mov_b32 v147, 0
    v_mov_b32 v148, 0
    v_mov_b32 v149, 0
    v_mov_b32 v150, 0
    v_mov_b32 v151, 0
    v_mov_b32 v152, 0
    v_mov_b32 v153, 0
    v_mov_b32 v154, 0
    v_mov_b32 v155, 0
    v_mov_b32 v156, 0
    v_mov_b32 v157, 0
    v_mov_b32 v158, 0
    v_mov_b32 v159, 0
    v_mov_b32 v160, 0
    v_mov_b32 v161, 0
    v_mov_b32 v162, 0
    v_mov_b32 v163, 0
    v_mov_b32 v164, 0
    v_mov_b32 v165, 0
    v_mov_b32 v166, 0
    v_mov_b32 v167, 0
    v_mov_b32 v168, 0
    v_mov_b32 v169, 0
    v_mov_b32 v170, 0
    v_mov_b32 v171, 0
    v_mov_b32 v172, 0
    v_mov_b32 v173, 0
    v_mov_b32 v174, 0
    v_mov_b32 v175, 0
    v_mov_b32 v176, 0
    v_mov_b32 v177, 0
    v_mov_b32 v178, 0
    v_mov_b32 v179, 0
    v_mov_b32 v180, 0
    v_mov_b32 v181, 0
    v_mov_b32 v182, 0
    v_mov_b32 v183, 0
    v_mov_b32 v184, 0
    v_mov_b32 v185, 0
    v_mov_b32 v186, 0
    v_mov_b32 v187, 0
    v_mov_b32 v188, 0
    v_mov_b32 v189, 0
    v_mov_b32 v190, 0
    v_mov_b32 v191, 0
    v_mov_b32 v192, 0
    v_mov_b32 v193, 0
    v_mov_b32 v194, 0
    v_mov_b32 v195, 0
    v_mov_b32 v196, 0
    v_mov_b32 v197, 0
    v_mov_b32 v198, 0
    v_mov_b32 v199, 0
    v_mov_b32 v200, 0
    v_mov_b32 v201, 0
    v_mov_b32 v202, 0
    v_mov_b32 v203, 0
    v_mov_b32 v204, 0
    v_mov_b32 v205, 0
    v_mov_b32 v206, 0
    v_mov_b32 v207, 0
    v_mov_b32 v208, 0
    v_mov_b32 v209, 0
    v_mov_b32 v210, 0
    v_mov_b32 v211, 0
    v_mov_b32 v212, 0
    v_mov_b32 v213, 0
    v_mov_b32 v214, 0
    v_mov_b32 v215, 0
    v_mov_b32 v216, 0
    v_mov_b32 v217, 0
    v_mov_b32 v218, 0
    v_mov_b32 v219, 0
    v_mov_b32 v220, 0
    v_mov_b32 v221, 0
    v_mov_b32 v222, 0
    v_mov_b32 v223, 0
    v_mov_b32 v224, 0
    v_mov_b32 v225, 0
    v_mov_b32 v226, 0
    v_mov_b32 v227, 0
    v_mov_b32 v228, 0
    v_mov_b32 v229, 0
    v_mov_b32 v230, 0
    v_mov_b32 v231, 0
    v_mov_b32 v232, 0
    v_mov_b32 v233, 0
    v_mov_b32 v234, 0
    v_mov_b32 v235, 0
    v_mov_b32 v236, 0
    v_mov_b32 v237, 0
    v_mov_b32 v238, 0
    v_mov_b32 v239, 0
    v_mov_b32 v240, 0
    v_mov_b32 v241, 0
    v_mov_b32 v242, 0
    v_mov_b32 v243, 0
    v_mov_b32 v244, 0
    v_mov_b32 v245, 0
    v_mov_b32 v246, 0
    v_mov_b32 v247, 0
    v_mov_b32 v248, 0
    v_mov_b32 v249, 0
    v_mov_b32 v250, 0
    v_mov_b32 v251, 0
    v_mov_b32 v252, 0
    v_mov_b32 v253, 0
    v_mov_b32 v254, 0
    v_mov_b32 v255, 0
    s_barrier
    s_add_u32 m0, s47, 0x8000
    s_add_u32 s50, s84, 0x0
    buffer_load_dwordx4 v11, s[8:11], s50 offen lds
    s_add_u32 m0, s47, 0x8400
    s_add_u32 s50, s84, 0x2400
    buffer_load_dwordx4 v12, s[8:11], s50 offen lds
    s_add_u32 m0, s47, 0x8800
    s_add_u32 s50, s84, 0x4800
    buffer_load_dwordx4 v11, s[8:11], s50 offen lds
    s_add_u32 m0, s47, 0x8c00
    s_add_u32 s50, s84, 0x6c00
    buffer_load_dwordx4 v12, s[8:11], s50 offen lds
    s_add_u32 m0, s47, 0xc000
    s_add_u32 s50, s84, 0x24000
    buffer_load_dwordx4 v11, s[8:11], s50 offen lds
    s_add_u32 m0, s47, 0xc400
    s_add_u32 s50, s84, 0x26400
    buffer_load_dwordx4 v12, s[8:11], s50 offen lds
    s_add_u32 m0, s47, 0xc800
    s_add_u32 s50, s84, 0x28800
    buffer_load_dwordx4 v11, s[8:11], s50 offen lds
    s_add_u32 m0, s47, 0xcc00
    s_add_u32 s50, s84, 0x2ac00
    buffer_load_dwordx4 v12, s[8:11], s50 offen lds
    s_add_u32 m0, s45, 0x6040
    s_add_u32 s50, s82, 0x0
    buffer_load_dwordx4 v8, s[12:15], s50 offen lds
    s_add_u32 m0, s45, 0x6440
    s_add_u32 s50, s82, 0x0
    buffer_load_dwordx4 v9, s[12:15], s50 offen lds
    s_add_u32 m0, s45, 0x6840
    s_add_u32 s50, s82, 0x0
    buffer_load_dwordx4 v10, s[12:15], s50 offen lds
    s_add_u32 m0, s45, 0x9060
    s_add_u32 s50, s82, 0x48000
    buffer_load_dwordx4 v8, s[12:15], s50 offen lds
    s_add_u32 m0, s45, 0x9460
    s_add_u32 s50, s82, 0x48000
    buffer_load_dwordx4 v9, s[12:15], s50 offen lds
    s_add_u32 m0, s45, 0x9860
    s_add_u32 s50, s82, 0x48000
    buffer_load_dwordx4 v10, s[12:15], s50 offen lds
    s_add_u32 m0, s45, 0xc080
    s_add_u32 s50, s83, 0x0
    buffer_load_dwordx4 v8, s[12:15], s50 offen lds
    s_add_u32 m0, s45, 0xc480
    s_add_u32 s50, s83, 0x0
    buffer_load_dwordx4 v9, s[12:15], s50 offen lds
    s_add_u32 m0, s45, 0xc880
    s_add_u32 s50, s83, 0x0
    buffer_load_dwordx4 v10, s[12:15], s50 offen lds
    s_add_u32 m0, s47, 0x10000
    s_add_u32 s50, s85, 0x0
    buffer_load_dwordx4 v11, s[8:11], s50 offen lds
    s_add_u32 m0, s47, 0x10400
    s_add_u32 s50, s85, 0x2400
    buffer_load_dwordx4 v12, s[8:11], s50 offen lds
    s_add_u32 m0, s47, 0x10800
    s_add_u32 s50, s85, 0x4800
    buffer_load_dwordx4 v11, s[8:11], s50 offen lds
    s_add_u32 m0, s47, 0x10c00
    s_add_u32 s50, s85, 0x6c00
    buffer_load_dwordx4 v12, s[8:11], s50 offen lds
    s_waitcnt vmcnt(21)
    ds_read_b128 v[52:55], v57 offset:0
    s_waitcnt lgkmcnt(0)
    v_dot2c_f32_bf16 v56, v52, v16
    v_dot2c_f32_bf16 v56, v53, v17
    v_dot2c_f32_bf16 v56, v54, v18
    v_dot2c_f32_bf16 v56, v55, v19
    s_waitcnt vmcnt(10)
    s_barrier
    s_add_u32 m0, s45, 0x0
    s_add_u32 s50, s83, 0x48000
    buffer_load_dwordx4 v8, s[12:15], s50 offen lds
    s_add_u32 m0, s45, 0x400
    s_add_u32 s50, s83, 0x48000
    buffer_load_dwordx4 v9, s[12:15], s50 offen lds
    s_add_u32 m0, s45, 0x800
    s_add_u32 s50, s83, 0x48000
    buffer_load_dwordx4 v10, s[12:15], s50 offen lds
    s_add_u32 m0, s47, 0x14000
    s_add_u32 s50, s85, 0x24000
    buffer_load_dwordx4 v11, s[8:11], s50 offen lds
    s_add_u32 m0, s47, 0x14400
    s_add_u32 s50, s85, 0x26400
    buffer_load_dwordx4 v12, s[8:11], s50 offen lds
    s_add_u32 m0, s47, 0x14800
    s_add_u32 s50, s85, 0x28800
    buffer_load_dwordx4 v11, s[8:11], s50 offen lds
    s_add_u32 m0, s47, 0x14c00
    s_add_u32 s50, s85, 0x2ac00
    buffer_load_dwordx4 v12, s[8:11], s50 offen lds
    s_cmp_eq_u32 s37, 0
    s_cbranch_scc0 L_noat_1
    s_and_b32 s50, s2, 31
    s_lshl_b32 s50, s50, 2
    s_add_u32 s50, s50, 128
    v_mov_b32 v60, 1
    v_mov_b32 v61, s50
    s_mov_b64 exec, 1
    buffer_atomic_add v60, v61, s[28:31], 0 offen sc1
    s_mov_b64 exec, -1
L_noat_1:
    s_waitcnt vmcnt(14)
    s_barrier
    s_add_u32 m0, s45, 0x3020
    s_add_u32 s50, s44, 0x1b0000
    buffer_load_dwordx4 v8, s[12:15], s50 offen lds
    s_add_u32 m0, s45, 0x3420
    s_add_u32 s50, s44, 0x1b0000
    buffer_load_dwordx4 v9, s[12:15], s50 offen lds
    s_add_u32 m0, s45, 0x3820
    s_add_u32 s50, s44, 0x1b0000
    buffer_load_dwordx4 v10, s[12:15], s50 offen lds
    s_add_u32 m0, s47, 0x0
    s_add_u32 s50, s46, 0x180
    buffer_load_dwordx4 v11, s[8:11], s50 offen lds
    s_add_u32 m0, s47, 0x400
    s_add_u32 s50, s46, 0x2580
    buffer_load_dwordx4 v12, s[8:11], s50 offen lds
    s_add_u32 m0, s47, 0x800
    s_add_u32 s50, s46, 0x4980
    buffer_load_dwordx4 v11, s[8:11], s50 offen lds
    s_add_u32 m0, s47, 0xc00
    s_add_u32 s50, s46, 0x6d80
    buffer_load_dwordx4 v12, s[8:11], s50 offen lds
    ds_read_b128 v[52:55], v57 offset:32768
    s_waitcnt lgkmcnt(0)
    v_dot2c_f32_bf16 v56, v52, v20
    v_dot2c_f32_bf16 v56, v53, v21
    v_dot2c_f32_bf16 v56, v54, v22
    v_dot2c_f32_bf16 v56, v55, v23
    s_waitcnt vmcnt(7)
    s_barrier
    s_add_u32 m0, s45, 0x6040
    s_add_u32 s50, s44, 0x1f8000
    buffer_load_dwordx4 v8, s[12:15], s50 offen lds
    s_add_u32 m0, s45, 0x6440
    s_add_u32 s50, s44, 0x1f8000
    buffer_load_dwordx4 v9, s[12:15], s50 offen lds
    s_add_u32 m0, s45, 0x6840
    s_add_u32 s50, s44, 0x1f8000
    buffer_load_dwordx4 v10, s[12:15], s50 offen lds
    s_add_u32 m0, s47, 0x4000
    s_add_u32 s50, s46, 0x24180
    buffer_load_dwordx4 v11, s[8:11], s50 offen lds
    s_add_u32 m0, s47, 0x4400
    s_add_u32 s50, s46, 0x26580
    buffer_load_dwordx4 v12, s[8:11], s50 offen lds
    s_add_u32 m0, s47, 0x4800
    s_add_u32 s50, s46, 0x28980
    buffer_load_dwordx4 v11, s[8:11], s50 offen lds
    s_add_u32 m0, s47, 0x4c00
    s_add_u32 s50, s46, 0x2ad80
    buffer_load_dwordx4 v12, s[8:11], s50 offen lds
    s_barrier
    s_add_u32 m0, s45, 0x9060
    s_add_u32 s50, s82, 0x1b0000
    buffer_load_dwordx4 v8, s[12:15], s50 offen lds
    s_add_u32 m0, s45, 0x9460
    s_add_u32 s50, s82, 0x1b0000
    buffer_load_dwordx4 v9, s[12:15], s50 offen lds
    s_add_u32 m0, s45, 0x9860
    s_add_u32 s50, s82, 0x1b0000
    buffer_load_dwordx4 v10, s[12:15], s50 offen lds
    s_add_u32 m0, s47, 0x8000
    s_add_u32 s50, s84, 0x180
    buffer_load_dwordx4 v11, s[8:11], s50 offen lds
    s_add_u32 m0, s47, 0x8400
    s_add_u32 s50, s84, 0x2580
    buffer_load_dwordx4 v12, s[8:11], s50 offen lds
    s_add_u32 m0, s47, 0x8800
    s_add_u32 s50, s84, 0x4980
    buffer_load_dwordx4 v11, s[8:11], s50 offen lds
    s_add_u32 m0, s47, 0x8c00
    s_add_u32 s50, s84, 0x6d80
    buffer_load_dwordx4 v12, s[8:11], s50 offen lds
    ds_read_b128 v[52:55], v0
    s_waitcnt lgkmcnt(0)
    v_dot2c_f32_bf16 v56, v52, v24
    v_dot2c_f32_bf16 v56, v53, v25
    v_dot2c_f32_bf16 v56, v54, v26
    v_dot2c_f32_bf16 v56, v55, v27
    s_waitcnt vmcnt(7)
    s_barrier
    s_add_u32 m0, s45, 0xc080
    s_add_u32 s50, s82, 0x1f8000
    buffer_load_dwordx4 v8, s[12:15], s50 offen lds
    s_add_u32 m0, s45, 0xc480
    s_add_u32 s50, s82, 0x1f8000
    buffer_load_dwordx4 v9, s[12:15], s50 offen lds
    s_add_u32 m0, s45, 0xc880
    s_add_u32 s50, s82, 0x1f8000
    buffer_load_dwordx4 v10, s[12:15], s50 offen lds
    s_add_u32 m0, s47, 0xc000
    s_add_u32 s50, s84, 0x24180
    buffer_load_dwordx4 v11, s[8:11], s50 offen lds
    s_add_u32 m0, s47, 0xc400
    s_add_u32 s50, s84, 0x26580
    buffer_load_dwordx4 v12, s[8:11], s50 offen lds
    s_add_u32 m0, s47, 0xc800
    s_add_u32 s50, s84, 0x28980
    buffer_load_dwordx4 v11, s[8:11], s50 offen lds
    s_add_u32 m0, s47, 0xcc00
    s_add_u32 s50, s84, 0x2ad80
    buffer_load_dwordx4 v12, s[8:11], s50 offen lds
    s_barrier
    s_add_u32 m0, s45, 0x0
    s_add_u32 s50, s83, 0x1b0000
    buffer_load_dwordx4 v8, s[12:15], s50 offen lds
    s_add_u32 m0, s45, 0x400
    s_add_u32 s50, s83, 0x1b0000
    buffer_load_dwordx4 v9, s[12:15], s50 offen lds
    s_add_u32 m0, s45, 0x800
    s_add_u32 s50, s83, 0x1b0000
    buffer_load_dwordx4 v10, s[12:15], s50 offen lds
    s_add_u32 m0, s47, 0x10000
    s_add_u32 s50, s85, 0x180
    buffer_load_dwordx4 v11, s[8:11], s50 offen lds
    s_add_u32 m0, s47, 0x10400
    s_add_u32 s50, s85, 0x2580
    buffer_load_dwordx4 v12, s[8:11], s50 offen lds
    s_add_u32 m0, s47, 0x10800
    s_add_u32 s50, s85, 0x4980
    buffer_load_dwordx4 v11, s[8:11], s50 offen lds
    s_add_u32 m0, s47, 0x10c00
    s_add_u32 s50, s85, 0x6d80
    buffer_load_dwordx4 v12, s[8:11], s50 offen lds
    s_lshl_b32 s50, s39, 8
    s_lshl_b32 s51, s42, 7
    s_add_u32 s50, s50, s51
    s_lshl_b32 s51, s38, 5
    s_add_u32 s50, s50, s51
    s_mul_i32 s50, s50, 1152
    s_mul_i32 s51, s43, 384
    s_add_u32 s50, s50, s51
    v_mov_b32 v61, 0
    s_mov_b64 exec, 1
    buffer_load_dword v58, v61, s[24:27], s50 offen
    s_mov_b64 exec, -1
    s_and_b32 s50, s39, 3
    s_lshl_b32 s50, s50, 1
    s_add_u32 s50, s50, s57
    s_mul_i32 s50, s50, 663552
    s_mul_i32 s51, s41, 384
    s_add_u32 s50, s50, s51
    s_add_u32 s50, s50, 256
    s_mov_b32 s51, 9216
    v_mul_u32_u24 v61, s51, v1
    s_mov_b32 exec_hi, 0xf
    buffer_load_dword v58, v61, s[12:15], s50 offen
    s_mov_b64 exec, -1
    ds_read_b128 v[52:55], v57 offset:0
    s_waitcnt lgkmcnt(0)
    v_dot2c_f32_bf16 v56, v52, v28
    v_dot2c_f32_bf16 v56, v53, v29
    v_dot2c_f32_bf16 v56, v54, v30
    v_dot2c_f32_bf16 v56, v55, v31
    s_waitcnt vmcnt(9)
    s_barrier
    s_add_u32 m0, s45, 0x3020
    s_add_u32 s50, s83, 0x1f8000
    buffer_load_dwordx4 v8, s[12:15], s50 offen lds
    s_add_u32 m0, s45, 0x3420
    s_add_u32 s50, s83, 0x1f8000
    buffer_load_dwordx4 v9, s[12:15], s50 offen lds
    s_add_u32 m0, s45, 0x3820
    s_add_u32 s50, s83, 0x1f8000
    buffer_load_dwordx4 v10, s[12:15], s50 offen lds
    s_add_u32 m0, s47, 0x14000
    s_add_u32 s50, s85, 0x24180
    buffer_load_dwordx4 v11, s[8:11], s50 offen lds
    s_add_u32 m0, s47, 0x14400
    s_add_u32 s50, s85, 0x26580
    buffer_load_dwordx4 v12, s[8:11], s50 offen lds
    s_add_u32 m0, s47, 0x14800
    s_add_u32 s50, s85, 0x28980
    buffer_load_dwordx4 v11, s[8:11], s50 offen lds
    s_add_u32 m0, s47, 0x14c00
    s_add_u32 s50, s85, 0x2ad80
    buffer_load_dwordx4 v12, s[8:11], s50 offen lds
    s_barrier
    s_add_u32 m0, s45, 0x6040
    s_add_u32 s50, s44, 0x360000
    buffer_load_dwordx4 v8, s[12:15], s50 offen lds
    s_add_u32 m0, s45, 0x6440
    s_add_u32 s50, s44, 0x360000
    buffer_load_dwordx4 v9, s[12:15], s50 offen lds
    s_add_u32 m0, s45, 0x6840
    s_add_u32 s50, s44, 0x360000
    buffer_load_dwordx4 v10, s[12:15], s50 offen lds
    s_add_u32 m0, s47, 0x0
    s_add_u32 s50, s46, 0x300
    buffer_load_dwordx4 v11, s[8:11], s50 offen lds
    s_add_u32 m0, s47, 0x400
    s_add_u32 s50, s46, 0x2700
    buffer_load_dwordx4 v12, s[8:11], s50 offen lds
    s_add_u32 m0, s47, 0x800
    s_add_u32 s50, s46, 0x4b00
    buffer_load_dwordx4 v11, s[8:11], s50 offen lds
    s_add_u32 m0, s47, 0xc00
    s_add_u32 s50, s46, 0x6f00
    buffer_load_dwordx4 v12, s[8:11], s50 offen lds
    ds_read_b128 v[52:55], v57 offset:32768
    s_waitcnt lgkmcnt(0)
    v_dot2c_f32_bf16 v56, v52, v32
    v_dot2c_f32_bf16 v56, v53, v33
    v_dot2c_f32_bf16 v56, v54, v34
    v_dot2c_f32_bf16 v56, v55, v35
    s_waitcnt vmcnt(7)
    s_barrier
    s_add_u32 m0, s45, 0x9060
    s_add_u32 s50, s44, 0x3a8000
    buffer_load_dwordx4 v8, s[12:15], s50 offen lds
    s_add_u32 m0, s45, 0x9460
    s_add_u32 s50, s44, 0x3a8000
    buffer_load_dwordx4 v9, s[12:15], s50 offen lds
    s_add_u32 m0, s45, 0x9860
    s_add_u32 s50, s44, 0x3a8000
    buffer_load_dwordx4 v10, s[12:15], s50 offen lds
    s_add_u32 m0, s47, 0x4000
    s_add_u32 s50, s46, 0x24300
    buffer_load_dwordx4 v11, s[8:11], s50 offen lds
    s_add_u32 m0, s47, 0x4400
    s_add_u32 s50, s46, 0x26700
    buffer_load_dwordx4 v12, s[8:11], s50 offen lds
    s_add_u32 m0, s47, 0x4800
    s_add_u32 s50, s46, 0x28b00
    buffer_load_dwordx4 v11, s[8:11], s50 offen lds
    s_add_u32 m0, s47, 0x4c00
    s_add_u32 s50, s46, 0x2af00
    buffer_load_dwordx4 v12, s[8:11], s50 offen lds
    s_barrier
    s_add_u32 m0, s45, 0xc080
    s_add_u32 s50, s82, 0x360000
    buffer_load_dwordx4 v8, s[12:15], s50 offen lds
    s_add_u32 m0, s45, 0xc480
    s_add_u32 s50, s82, 0x360000
    buffer_load_dwordx4 v9, s[12:15], s50 offen lds
    s_add_u32 m0, s45, 0xc880
    s_add_u32 s50, s82, 0x360000
    buffer_load_dwordx4 v10, s[12:15], s50 offen lds
    s_add_u32 m0, s47, 0x8000
    s_add_u32 s50, s84, 0x300
    buffer_load_dwordx4 v11, s[8:11], s50 offen lds
    s_add_u32 m0, s47, 0x8400
    s_add_u32 s50, s84, 0x2700
    buffer_load_dwordx4 v12, s[8:11], s50 offen lds
    s_add_u32 m0, s47, 0x8800
    s_add_u32 s50, s84, 0x4b00
    buffer_load_dwordx4 v11, s[8:11], s50 offen lds
    s_add_u32 m0, s47, 0x8c00
    s_add_u32 s50, s84, 0x6f00
    buffer_load_dwordx4 v12, s[8:11], s50 offen lds
    ds_read_b128 v[52:55], v0
    s_waitcnt lgkmcnt(0)
    v_dot2c_f32_bf16 v56, v52, v36
    v_dot2c_f32_bf16 v56, v53, v37
    v_dot2c_f32_bf16 v56, v54, v38
    v_dot2c_f32_bf16 v56, v55, v39
    s_waitcnt vmcnt(7)
    s_barrier
    s_add_u32 m0, s45, 0x0
    s_add_u32 s50, s82, 0x3a8000
    buffer_load_dwordx4 v8, s[12:15], s50 offen lds
    s_add_u32 m0, s45, 0x400
    s_add_u32 s50, s82, 0x3a8000
    buffer_load_dwordx4 v9, s[12:15], s50 offen lds
    s_add_u32 m0, s45, 0x800
    s_add_u32 s50, s82, 0x3a8000
    buffer_load_dwordx4 v10, s[12:15], s50 offen lds
    s_add_u32 m0, s47, 0xc000
    s_add_u32 s50, s84, 0x24300
    buffer_load_dwordx4 v11, s[8:11], s50 offen lds
    s_add_u32 m0, s47, 0xc400
    s_add_u32 s50, s84, 0x26700
    buffer_load_dwordx4 v12, s[8:11], s50 offen lds
    s_add_u32 m0, s47, 0xc800
    s_add_u32 s50, s84, 0x28b00
    buffer_load_dwordx4 v11, s[8:11], s50 offen lds
    s_add_u32 m0, s47, 0xcc00
    s_add_u32 s50, s84, 0x2af00
    buffer_load_dwordx4 v12, s[8:11], s50 offen lds
    s_barrier
    s_add_u32 m0, s45, 0x3020
    s_add_u32 s50, s83, 0x360000
    buffer_load_dwordx4 v8, s[12:15], s50 offen lds
    s_add_u32 m0, s45, 0x3420
    s_add_u32 s50, s83, 0x360000
    buffer_load_dwordx4 v9, s[12:15], s50 offen lds
    s_add_u32 m0, s45, 0x3820
    s_add_u32 s50, s83, 0x360000
    buffer_load_dwordx4 v10, s[12:15], s50 offen lds
    s_add_u32 m0, s47, 0x10000
    s_add_u32 s50, s85, 0x300
    buffer_load_dwordx4 v11, s[8:11], s50 offen lds
    s_add_u32 m0, s47, 0x10400
    s_add_u32 s50, s85, 0x2700
    buffer_load_dwordx4 v12, s[8:11], s50 offen lds
    s_add_u32 m0, s47, 0x10800
    s_add_u32 s50, s85, 0x4b00
    buffer_load_dwordx4 v11, s[8:11], s50 offen lds
    s_add_u32 m0, s47, 0x10c00
    s_add_u32 s50, s85, 0x6f00
    buffer_load_dwordx4 v12, s[8:11], s50 offen lds
    s_and_b32 s50, s39, 3
    s_lshl_b32 s50, s50, 1
    s_add_u32 s50, s50, s57
    s_mul_i32 s50, s50, 663552
    s_mul_i32 s51, s41, 384
    s_add_u32 s50, s50, s51
    s_add_u32 s50, s50, 332032
    s_mov_b32 s51, 9216
    v_mul_u32_u24 v61, s51, v1
    s_mov_b32 exec_hi, 0xf
    buffer_load_dword v58, v61, s[12:15], s50 offen
    s_mov_b64 exec, -1
    ds_read_b128 v[52:55], v57 offset:0
    s_waitcnt lgkmcnt(0)
    v_dot2c_f32_bf16 v56, v52, v40
    v_dot2c_f32_bf16 v56, v53, v41
    v_dot2c_f32_bf16 v56, v54, v42
    v_dot2c_f32_bf16 v56, v55, v43
    s_waitcnt vmcnt(8)
    s_barrier
    s_add_u32 m0, s45, 0x6040
    s_add_u32 s50, s83, 0x3a8000
    buffer_load_dwordx4 v8, s[12:15], s50 offen lds
    s_add_u32 m0, s45, 0x6440
    s_add_u32 s50, s83, 0x3a8000
    buffer_load_dwordx4 v9, s[12:15], s50 offen lds
    s_add_u32 m0, s45, 0x6840
    s_add_u32 s50, s83, 0x3a8000
    buffer_load_dwordx4 v10, s[12:15], s50 offen lds
    s_add_u32 m0, s47, 0x14000
    s_add_u32 s50, s85, 0x24300
    buffer_load_dwordx4 v11, s[8:11], s50 offen lds
    s_add_u32 m0, s47, 0x14400
    s_add_u32 s50, s85, 0x26700
    buffer_load_dwordx4 v12, s[8:11], s50 offen lds
    s_add_u32 m0, s47, 0x14800
    s_add_u32 s50, s85, 0x28b00
    buffer_load_dwordx4 v11, s[8:11], s50 offen lds
    s_add_u32 m0, s47, 0x14c00
    s_add_u32 s50, s85, 0x2af00
    buffer_load_dwordx4 v12, s[8:11], s50 offen lds
    s_barrier
    s_add_u32 m0, s45, 0x9060
    s_add_u32 s50, s44, 0xc0
    buffer_load_dwordx4 v8, s[12:15], s50 offen lds
    s_add_u32 m0, s45, 0x9460
    s_add_u32 s50, s44, 0xc0
    buffer_load_dwordx4 v9, s[12:15], s50 offen lds
    s_add_u32 m0, s45, 0x9860
    s_add_u32 s50, s44, 0xc0
    buffer_load_dwordx4 v10, s[12:15], s50 offen lds
    s_add_u32 m0, s47, 0x0
    s_add_u32 s50, s46, 0x0
    buffer_load_dwordx4 v11, s[8:11], s50 offen lds
    s_add_u32 m0, s47, 0x400
    s_add_u32 s50, s46, 0x2400
    buffer_load_dwordx4 v12, s[8:11], s50 offen lds
    s_add_u32 m0, s47, 0x800
    s_add_u32 s50, s46, 0x4800
    buffer_load_dwordx4 v11, s[8:11], s50 offen lds
    s_add_u32 m0, s47, 0xc00
    s_add_u32 s50, s46, 0x6c00
    buffer_load_dwordx4 v12, s[8:11], s50 offen lds
    ds_read_b128 v[52:55], v57 offset:32768
    s_waitcnt lgkmcnt(0)
    v_dot2c_f32_bf16 v56, v52, v44
    v_dot2c_f32_bf16 v56, v53, v45
    v_dot2c_f32_bf16 v56, v54, v46
    v_dot2c_f32_bf16 v56, v55, v47
    s_waitcnt vmcnt(7)
    s_barrier
    s_add_u32 m0, s45, 0xc080
    s_add_u32 s50, s44, 0x480c0
    buffer_load_dwordx4 v8, s[12:15], s50 offen lds
    s_add_u32 m0, s45, 0xc480
    s_add_u32 s50, s44, 0x480c0
    buffer_load_dwordx4 v9, s[12:15], s50 offen lds
    s_add_u32 m0, s45, 0xc880
    s_add_u32 s50, s44, 0x480c0
    buffer_load_dwordx4 v10, s[12:15], s50 offen lds
    s_add_u32 m0, s47, 0x4000
    s_add_u32 s50, s46, 0x24000
    buffer_load_dwordx4 v11, s[8:11], s50 offen lds
    s_add_u32 m0, s47, 0x4400
    s_add_u32 s50, s46, 0x26400
    buffer_load_dwordx4 v12, s[8:11], s50 offen lds
    s_add_u32 m0, s47, 0x4800
    s_add_u32 s50, s46, 0x28800
    buffer_load_dwordx4 v11, s[8:11], s50 offen lds
    s_add_u32 m0, s47, 0x4c00
    s_add_u32 s50, s46, 0x2ac00
    buffer_load_dwordx4 v12, s[8:11], s50 offen lds
    s_barrier
    s_add_u32 m0, s45, 0x0
    s_add_u32 s50, s82, 0xc0
    buffer_load_dwordx4 v8, s[12:15], s50 offen lds
    s_add_u32 m0, s45, 0x400
    s_add_u32 s50, s82, 0xc0
    buffer_load_dwordx4 v9, s[12:15], s50 offen lds
    s_add_u32 m0, s45, 0x800
    s_add_u32 s50, s82, 0xc0
    buffer_load_dwordx4 v10, s[12:15], s50 offen lds
    s_add_u32 m0, s47, 0x8000
    s_add_u32 s50, s84, 0x0
    buffer_load_dwordx4 v11, s[8:11], s50 offen lds
    s_add_u32 m0, s47, 0x8400
    s_add_u32 s50, s84, 0x2400
    buffer_load_dwordx4 v12, s[8:11], s50 offen lds
    s_add_u32 m0, s47, 0x8800
    s_add_u32 s50, s84, 0x4800
    buffer_load_dwordx4 v11, s[8:11], s50 offen lds
    s_add_u32 m0, s47, 0x8c00
    s_add_u32 s50, s84, 0x6c00
    buffer_load_dwordx4 v12, s[8:11], s50 offen lds
    ds_read_b128 v[52:55], v0
    s_waitcnt lgkmcnt(0)
    v_dot2c_f32_bf16 v56, v52, v48
    v_dot2c_f32_bf16 v56, v53, v49
    v_dot2c_f32_bf16 v56, v54, v50
    v_dot2c_f32_bf16 v56, v55, v51
    s_lshl_b32 s50, s37, 8
    s_add_u32 s50, s50, 159904
    v_add_u32 v57, s50, v59
    s_nop 2
    ds_write_b32 v57, v56
    s_waitcnt lgkmcnt(0)
    s_waitcnt vmcnt(7)
    s_barrier
    s_add_u32 m0, s45, 0x3020
    s_add_u32 s50, s82, 0x480c0
    buffer_load_dwordx4 v8, s[12:15], s50 offen lds
    s_add_u32 m0, s45, 0x3420
    s_add_u32 s50, s82, 0x480c0
    buffer_load_dwordx4 v9, s[12:15], s50 offen lds
    s_add_u32 m0, s45, 0x3820
    s_add_u32 s50, s82, 0x480c0
    buffer_load_dwordx4 v10, s[12:15], s50 offen lds
    s_add_u32 m0, s47, 0xc000
    s_add_u32 s50, s84, 0x24000
    buffer_load_dwordx4 v11, s[8:11], s50 offen lds
    s_add_u32 m0, s47, 0xc400
    s_add_u32 s50, s84, 0x26400
    buffer_load_dwordx4 v12, s[8:11], s50 offen lds
    s_add_u32 m0, s47, 0xc800
    s_add_u32 s50, s84, 0x28800
    buffer_load_dwordx4 v11, s[8:11], s50 offen lds
    s_add_u32 m0, s47, 0xcc00
    s_add_u32 s50, s84, 0x2ac00
    buffer_load_dwordx4 v12, s[8:11], s50 offen lds
    ds_read_b128 v[40:43], v4 offset:0
    ds_read_b128 v[44:47], v4 offset:2048
    ds_read_b128 v[48:51], v4 offset:4096
    ds_read_b128 v[52:55], v4 offset:6144
    ds_read_b64_tr_b16 v[16:17], v2 offset:0
    ds_read_b64_tr_b16 v[18:19], v2 offset:768
    ds_read_b64_tr_b16 v[20:21], v2 offset:6176
    ds_read_b64_tr_b16 v[22:23], v2 offset:6944
    ds_read_b64_tr_b16 v[24:25], v3 offset:32
    ds_read_b64_tr_b16 v[26:27], v3 offset:800
    ds_read_b64_tr_b16 v[28:29], v3 offset:6208
    ds_read_b64_tr_b16 v[30:31], v3 offset:6976
    ds_read_b64_tr_b16 v[32:33], v2 offset:64
    ds_read_b64_tr_b16 v[34:35], v2 offset:832
    s_barrier
L_passentry:
    s_mov_b32 s52, 9
.p2align 6
L_pass:
    s_waitcnt lgkmcnt(8)
    v_mfma_f32_16x16x32_bf16 v[64:67], v[16:19], v[40:43], v[64:67]
    ds_read_b64_tr_b16 v[36:37], v2 offset:6240
    v_mfma_f32_16x16x32_bf16 v[68:71], v[16:19], v[44:47], v[68:71]
    ds_read_b64_tr_b16 v[38:39], v2 offset:7008
    v_mfma_f32_16x16x32_bf16 v[72:75], v[16:19], v[48:51], v[72:75]
    ds_read_b128 v[8:11], v5 offset:0
    v_mfma_f32_16x16x32_bf16 v[76:79], v[16:19], v[52:55], v[76:79]
    s_waitcnt lgkmcnt(9)
    v_mfma_f32_16x16x32_bf16 v[80:83], v[20:23], v[40:43], v[80:83]
    ds_read_b64_tr_b16 v[16:17], v3 offset:96
    v_mfma_f32_16x16x32_bf16 v[84:87], v[20:23], v[44:47], v[84:87]
    ds_read_b64_tr_b16 v[18:19], v3 offset:864
    v_mfma_f32_16x16x32_bf16 v[88:91], v[20:23], v[48:51], v[88:91]
    s_add_u32 s53, s53, 1
    v_mfma_f32_16x16x32_bf16 v[92:95], v[20:23], v[52:55], v[92:95]
    s_cmp_eq_u32 s53, 5
    s_cselect_b32 s55, 0xffff3f80, s86
    s_waitcnt lgkmcnt(9)
    v_mfma_f32_16x16x32_bf16 v[96:99], v[24:27], v[40:43], v[96:99]
    ds_read_b64_tr_b16 v[20:21], v3 offset:6272
    v_mfma_f32_16x16x32_bf16 v[100:103], v[24:27], v[44:47], v[100:103]
    ds_read_b64_tr_b16 v[22:23], v3 offset:7040
    v_mfma_f32_16x16x32_bf16 v[104:107], v[24:27], v[48:51], v[104:107]
    ds_read_b128 v[12:15], v5 offset:2048
    v_mfma_f32_16x16x32_bf16 v[108:111], v[24:27], v[52:55], v[108:111]
    s_cselect_b32 s53, 0, s53
    s_waitcnt lgkmcnt(10)
    v_mfma_f32_16x16x32_bf16 v[112:115], v[28:31], v[40:43], v[112:115]
    ds_read_b64_tr_b16 v[24:25], v2 offset:128
    v_mfma_f32_16x16x32_bf16 v[116:119], v[28:31], v[44:47], v[116:119]
    ds_read_b64_tr_b16 v[26:27], v2 offset:896
    v_mfma_f32_16x16x32_bf16 v[120:123], v[28:31], v[48:51], v[120:123]
    v_mfma_f32_16x16x32_bf16 v[124:127], v[28:31], v[52:55], v[124:127]
    s_waitcnt lgkmcnt(10)
    v_mfma_f32_16x16x32_bf16 v[128:131], v[32:35], v[40:43], v[128:131]
    ds_read_b64_tr_b16 v[28:29], v2 offset:6304
    v_mfma_f32_16x16x32_bf16 v[132:135], v[32:35], v[44:47], v[132:135]
    ds_read_b64_tr_b16 v[30:31], v2 offset:7072
    v_mfma_f32_16x16x32_bf16 v[136:139], v[32:35], v[48:51], v[136:139]
    ds_read_b128 v[56:59], v5 offset:4096
    v_mfma_f32_16x16x32_bf16 v[140:143], v[32:35], v[52:55], v[140:143]
    s_waitcnt lgkmcnt(11)
    v_mfma_f32_16x16x32_bf16 v[144:147], v[36:39], v[40:43], v[144:147]
    ds_read_b64_tr_b16 v[32:33], v3 offset:160
    v_mfma_f32_16x16x32_bf16 v[148:151], v[36:39], v[44:47], v[148:151]
    ds_read_b64_tr_b16 v[34:35], v3 offset:928
    v_mfma_f32_16x16x32_bf16 v[152:155], v[36:39], v[48:51], v[152:155]
    v_mfma_f32_16x16x32_bf16 v[156:159], v[36:39], v[52:55], v[156:159]
    v_add_u32 v2, s55, v2
    s_waitcnt lgkmcnt(10)
    v_mfma_f32_16x16x32_bf16 v[160:163], v[16:19], v[40:43], v[160:163]
    ds_read_b64_tr_b16 v[36:37], v3 offset:6336
    v_mfma_f32_16x16x32_bf16 v[164:167], v[16:19], v[44:47], v[164:167]
    ds_read_b64_tr_b16 v[38:39], v3 offset:7104
    v_mfma_f32_16x16x32_bf16 v[168:171], v[16:19], v[48:51], v[168:171]
    ds_read_b128 v[60:63], v5 offset:6144
    v_mfma_f32_16x16x32_bf16 v[172:175], v[16:19], v[52:55], v[172:175]
    v_add_u32 v3, s55, v3
    s_waitcnt lgkmcnt(11)
    v_mfma_f32_16x16x32_bf16 v[176:179], v[20:23], v[40:43], v[176:179]
    ds_read_b64_tr_b16 v[16:17], v2 offset:0
    v_mfma_f32_16x16x32_bf16 v[180:183], v[20:23], v[44:47], v[180:183]
    ds_read_b64_tr_b16 v[18:19], v2 offset:768
    v_mfma_f32_16x16x32_bf16 v[184:187], v[20:23], v[48:51], v[184:187]
    s_add_u32 s54, s54, 1
    v_mfma_f32_16x16x32_bf16 v[188:191], v[20:23], v[52:55], v[188:191]
    s_cmp_eq_u32 s54, 3
    s_cselect_b32 s56, 0xffff0000, s87
    s_waitcnt lgkmcnt(10)
    v_mfma_f32_16x16x32_bf16 v[192:195], v[24:27], v[40:43], v[192:195]
    ds_read_b64_tr_b16 v[20:21], v2 offset:6176
    v_mfma_f32_16x16x32_bf16 v[196:199], v[24:27], v[44:47], v[196:199]
    ds_read_b64_tr_b16 v[22:23], v2 offset:6944
    v_mfma_f32_16x16x32_bf16 v[200:203], v[24:27], v[48:51], v[200:203]
    s_cselect_b32 s54, 0, s54
    v_mfma_f32_16x16x32_bf16 v[204:207], v[24:27], v[52:55], v[204:207]
    v_add_u32 v4, s56, v4
    s_waitcnt lgkmcnt(10)
    v_mfma_f32_16x16x32_bf16 v[208:211], v[28:31], v[40:43], v[208:211]
    ds_read_b64_tr_b16 v[24:25], v3 offset:32
    v_mfma_f32_16x16x32_bf16 v[212:215], v[28:31], v[44:47], v[212:215]
    ds_read_b64_tr_b16 v[26:27], v3 offset:800
    v_mfma_f32_16x16x32_bf16 v[216:219], v[28:31], v[48:51], v[216:219]
    v_add_u32 v5, s56, v5
    v_mfma_f32_16x16x32_bf16 v[220:223], v[28:31], v[52:55], v[220:223]
    s_waitcnt lgkmcnt(9)
    v_mfma_f32_16x16x32_bf16 v[224:227], v[32:35], v[40:43], v[224:227]
    ds_read_b64_tr_b16 v[28:29], v3 offset:6208
    v_mfma_f32_16x16x32_bf16 v[228:231], v[32:35], v[44:47], v[228:231]
    ds_read_b64_tr_b16 v[30:31], v3 offset:6976
    v_mfma_f32_16x16x32_bf16 v[232:235], v[32:35], v[48:51], v[232:235]
    v_mfma_f32_16x16x32_bf16 v[236:239], v[32:35], v[52:55], v[236:239]
    s_waitcnt lgkmcnt(9)
    v_mfma_f32_16x16x32_bf16 v[240:243], v[36:39], v[40:43], v[240:243]
    ds_read_b64_tr_b16 v[32:33], v2 offset:64
    v_mfma_f32_16x16x32_bf16 v[244:247], v[36:39], v[44:47], v[244:247]
    ds_read_b64_tr_b16 v[34:35], v2 offset:832
    v_mfma_f32_16x16x32_bf16 v[248:251], v[36:39], v[48:51], v[248:251]
    v_mfma_f32_16x16x32_bf16 v[252:255], v[36:39], v[52:55], v[252:255]
    s_waitcnt vmcnt(0)
    s_barrier
    s_waitcnt lgkmcnt(8)
    v_mfma_f32_16x16x32_bf16 v[64:67], v[16:19], v[8:11], v[64:67]
    ds_read_b64_tr_b16 v[36:37], v2 offset:6240
    v_mfma_f32_16x16x32_bf16 v[68:71], v[16:19], v[12:15], v[68:71]
    ds_read_b64_tr_b16 v[38:39], v2 offset:7008
    v_mfma_f32_16x16x32_bf16 v[72:75], v[16:19], v[56:59], v[72:75]
    ds_read_b128 v[40:43], v4 offset:0
    v_mfma_f32_16x16x32_bf16 v[76:79], v[16:19], v[60:63], v[76:79]
    s_waitcnt lgkmcnt(9)
    v_mfma_f32_16x16x32_bf16 v[80:83], v[20:23], v[8:11], v[80:83]
    ds_read_b64_tr_b16 v[16:17], v3 offset:96
    v_mfma_f32_16x16x32_bf16 v[84:87], v[20:23], v[12:15], v[84:87]
    ds_read_b64_tr_b16 v[18:19], v3 offset:864
    v_mfma_f32_16x16x32_bf16 v[88:91], v[20:23], v[56:59], v[88:91]
    s_add_u32 s53, s53, 1
    v_mfma_f32_16x16x32_bf16 v[92:95], v[20:23], v[60:63], v[92:95]
    s_cmp_eq_u32 s53, 5
    s_cselect_b32 s55, 0xffff3f80, s86
    s_waitcnt lgkmcnt(9)
    v_mfma_f32_16x16x32_bf16 v[96:99], v[24:27], v[8:11], v[96:99]
    ds_read_b64_tr_b16 v[20:21], v3 offset:6272
    v_mfma_f32_16x16x32_bf16 v[100:103], v[24:27], v[12:15], v[100:103]
    ds_read_b64_tr_b16 v[22:23], v3 offset:7040
    v_mfma_f32_16x16x32_bf16 v[104:107], v[24:27], v[56:59], v[104:107]
    ds_read_b128 v[44:47], v4 offset:2048
    v_mfma_f32_16x16x32_bf16 v[108:111], v[24:27], v[60:63], v[108:111]
    s_cselect_b32 s53, 0, s53
    s_waitcnt lgkmcnt(10)
    v_mfma_f32_16x16x32_bf16 v[112:115], v[28:31], v[8:11], v[112:115]
    ds_read_b64_tr_b16 v[24:25], v2 offset:128
    v_mfma_f32_16x16x32_bf16 v[116:119], v[28:31], v[12:15], v[116:119]
    ds_read_b64_tr_b16 v[26:27], v2 offset:896
    v_mfma_f32_16x16x32_bf16 v[120:123], v[28:31], v[56:59], v[120:123]
    v_mfma_f32_16x16x32_bf16 v[124:127], v[28:31], v[60:63], v[124:127]
    s_waitcnt lgkmcnt(10)
    v_mfma_f32_16x16x32_bf16 v[128:131], v[32:35], v[8:11], v[128:131]
    ds_read_b64_tr_b16 v[28:29], v2 offset:6304
    v_mfma_f32_16x16x32_bf16 v[132:135], v[32:35], v[12:15], v[132:135]
    ds_read_b64_tr_b16 v[30:31], v2 offset:7072
    v_mfma_f32_16x16x32_bf16 v[136:139], v[32:35], v[56:59], v[136:139]
    ds_read_b128 v[48:51], v4 offset:4096
    v_mfma_f32_16x16x32_bf16 v[140:143], v[32:35], v[60:63], v[140:143]
    s_waitcnt lgkmcnt(11)
    v_mfma_f32_16x16x32_bf16 v[144:147], v[36:39], v[8:11], v[144:147]
    ds_read_b64_tr_b16 v[32:33], v3 offset:160
    v_mfma_f32_16x16x32_bf16 v[148:151], v[36:39], v[12:15], v[148:151]
    ds_read_b64_tr_b16 v[34:35], v3 offset:928
    v_mfma_f32_16x16x32_bf16 v[152:155], v[36:39], v[56:59], v[152:155]
    v_mfma_f32_16x16x32_bf16 v[156:159], v[36:39], v[60:63], v[156:159]
    v_add_u32 v2, s55, v2
    s_waitcnt lgkmcnt(10)
    v_mfma_f32_16x16x32_bf16 v[160:163], v[16:19], v[8:11], v[160:163]
    ds_read_b64_tr_b16 v[36:37], v3 offset:6336
    v_mfma_f32_16x16x32_bf16 v[164:167], v[16:19], v[12:15], v[164:167]
    ds_read_b64_tr_b16 v[38:39], v3 offset:7104
    v_mfma_f32_16x16x32_bf16 v[168:171], v[16:19], v[56:59], v[168:171]
    ds_read_b128 v[52:55], v4 offset:6144
    v_mfma_f32_16x16x32_bf16 v[172:175], v[16:19], v[60:63], v[172:175]
    v_add_u32 v3, s55, v3
    s_waitcnt lgkmcnt(11)
    v_mfma_f32_16x16x32_bf16 v[176:179], v[20:23], v[8:11], v[176:179]
    ds_read_b64_tr_b16 v[16:17], v2 offset:0
    v_mfma_f32_16x16x32_bf16 v[180:183], v[20:23], v[12:15], v[180:183]
    ds_read_b64_tr_b16 v[18:19], v2 offset:768
    v_mfma_f32_16x16x32_bf16 v[184:187], v[20:23], v[56:59], v[184:187]
    v_mfma_f32_16x16x32_bf16 v[188:191], v[20:23], v[60:63], v[188:191]
    s_waitcnt lgkmcnt(10)
    v_mfma_f32_16x16x32_bf16 v[192:195], v[24:27], v[8:11], v[192:195]
    ds_read_b64_tr_b16 v[20:21], v2 offset:6176
    v_mfma_f32_16x16x32_bf16 v[196:199], v[24:27], v[12:15], v[196:199]
    ds_read_b64_tr_b16 v[22:23], v2 offset:6944
    v_mfma_f32_16x16x32_bf16 v[200:203], v[24:27], v[56:59], v[200:203]
    v_mfma_f32_16x16x32_bf16 v[204:207], v[24:27], v[60:63], v[204:207]
    s_waitcnt lgkmcnt(10)
    v_mfma_f32_16x16x32_bf16 v[208:211], v[28:31], v[8:11], v[208:211]
    ds_read_b64_tr_b16 v[24:25], v3 offset:32
    v_mfma_f32_16x16x32_bf16 v[212:215], v[28:31], v[12:15], v[212:215]
    ds_read_b64_tr_b16 v[26:27], v3 offset:800
    v_mfma_f32_16x16x32_bf16 v[216:219], v[28:31], v[56:59], v[216:219]
    s_sub_u32 s52, s52, 1
    v_mfma_f32_16x16x32_bf16 v[220:223], v[28:31], v[60:63], v[220:223]
    s_cmp_lg_u32 s52, 0
    s_waitcnt lgkmcnt(9)
    v_mfma_f32_16x16x32_bf16 v[224:227], v[32:35], v[8:11], v[224:227]
    ds_read_b64_tr_b16 v[28:29], v3 offset:6208
    v_mfma_f32_16x16x32_bf16 v[228:231], v[32:35], v[12:15], v[228:231]
    ds_read_b64_tr_b16 v[30:31], v3 offset:6976
    v_mfma_f32_16x16x32_bf16 v[232:235], v[32:35], v[56:59], v[232:235]
    v_mfma_f32_16x16x32_bf16 v[236:239], v[32:35], v[60:63], v[236:239]
    s_waitcnt lgkmcnt(9)
    v_mfma_f32_16x16x32_bf16 v[240:243], v[36:39], v[8:11], v[240:243]
    ds_read_b64_tr_b16 v[32:33], v2 offset:64
    v_mfma_f32_16x16x32_bf16 v[244:247], v[36:39], v[12:15], v[244:247]
    ds_read_b64_tr_b16 v[34:35], v2 offset:832
    v_mfma_f32_16x16x32_bf16 v[248:251], v[36:39], v[56:59], v[248:251]
    v_mfma_f32_16x16x32_bf16 v[252:255], v[36:39], v[60:63], v[252:255]
    s_waitcnt vmcnt(0)
    s_barrier
    s_cbranch_scc1 L_pass
    s_waitcnt lgkmcnt(0)
    s_cmp_eq_u32 s59, 1
    s_cbranch_scc1 L_Y2
    v_lshlrev_b32 v56, 5, v1
    v_add_u32 v56, 160928, v56
    ds_read_b128 v[8:11], v56
    ds_read_b128 v[12:15], v56 offset:16
    v_lshlrev_b32 v59, 2, v1
    s_waitcnt lgkmcnt(0)
    s_add_u32 m0, s45, 0x6040
    s_add_u32 s50, s83, 0xc0
    buffer_load_dwordx4 v8, s[12:15], s50 offen lds
    s_add_u32 m0, s45, 0x6440
    s_add_u32 s50, s83, 0xc0
    buffer_load_dwordx4 v9, s[12:15], s50 offen lds
    s_add_u32 m0, s45, 0x6840
    s_add_u32 s50, s83, 0xc0
    buffer_load_dwordx4 v10, s[12:15], s50 offen lds
    s_add_u32 m0, s47, 0x10000
    s_add_u32 s50, s85, 0x0
    buffer_load_dwordx4 v11, s[8:11], s50 offen lds
    s_add_u32 m0, s47, 0x10400
    s_add_u32 s50, s85, 0x2400
    buffer_load_dwordx4 v12, s[8:11], s50 offen lds
    s_add_u32 m0, s47, 0x10800
    s_add_u32 s50, s85, 0x4800
    buffer_load_dwordx4 v11, s[8:11], s50 offen lds
    s_add_u32 m0, s47, 0x10c00
    s_add_u32 s50, s85, 0x6c00
    buffer_load_dwordx4 v12, s[8:11], s50 offen lds
    v_mul_f32 v16, s49, v64
    v_mul_f32 v17, s49, v65
    v_mul_f32 v18, s49, v66
    v_mul_f32 v19, s49, v67
    v_mul_f32 v20, s49, v96
    v_mul_f32 v21, s49, v97
    v_mul_f32 v22, s49, v98
    v_mul_f32 v23, s49, v99
    v_exp_f32 v16, v16
    v_exp_f32 v17, v17
    v_exp_f32 v18, v18
    v_exp_f32 v19, v19
    v_exp_f32 v20, v20
    v_exp_f32 v21, v21
    v_exp_f32 v22, v22
    v_exp_f32 v23, v23
    v_add_f32 v16, 1.0, v16
    v_add_f32 v17, 1.0, v17
    v_add_f32 v18, 1.0, v18
    v_add_f32 v19, 1.0, v19
    v_add_f32 v20, 1.0, v20
    v_add_f32 v21, 1.0, v21
    v_add_f32 v22, 1.0, v22
    v_add_f32 v23, 1.0, v23
    v_rcp_f32 v16, v16
    v_rcp_f32 v17, v17
    v_rcp_f32 v18, v18
    v_rcp_f32 v19, v19
    v_rcp_f32 v20, v20
    v_rcp_f32 v21, v21
    v_rcp_f32 v22, v22
    v_rcp_f32 v23, v23
    v_mul_f32 v16, v80, v16
    v_mul_f32 v17, v81, v17
    v_mul_f32 v18, v82, v18
    v_mul_f32 v19, v83, v19
    v_mul_f32 v20, v112, v20
    v_mul_f32 v21, v113, v21
    v_mul_f32 v22, v114, v22
    v_mul_f32 v23, v115, v23
    v_cvt_pk_bf16_f32 v40, v16, v17
    v_cvt_pk_bf16_f32 v41, v18, v19
    v_cvt_pk_bf16_f32 v42, v20, v21
    v_cvt_pk_bf16_f32 v43, v22, v23
    s_add_u32 s51, s48, 0
    buffer_store_dwordx4 v[40:43], v7, s[20:23], s51 offen sc1
    v_mul_f32 v16, s49, v68
    v_mul_f32 v17, s49, v69
    v_mul_f32 v18, s49, v70
    v_mul_f32 v19, s49, v71
    v_mul_f32 v20, s49, v100
    v_mul_f32 v21, s49, v101
    v_mul_f32 v22, s49, v102
    v_mul_f32 v23, s49, v103
    v_exp_f32 v16, v16
    v_exp_f32 v17, v17
    v_exp_f32 v18, v18
    v_exp_f32 v19, v19
    v_exp_f32 v20, v20
    v_exp_f32 v21, v21
    v_exp_f32 v22, v22
    v_exp_f32 v23, v23
    v_add_f32 v16, 1.0, v16
    v_add_f32 v17, 1.0, v17
    v_add_f32 v18, 1.0, v18
    v_add_f32 v19, 1.0, v19
    v_add_f32 v20, 1.0, v20
    v_add_f32 v21, 1.0, v21
    v_add_f32 v22, 1.0, v22
    v_add_f32 v23, 1.0, v23
    v_rcp_f32 v16, v16
    v_rcp_f32 v17, v17
    v_rcp_f32 v18, v18
    v_rcp_f32 v19, v19
    v_rcp_f32 v20, v20
    v_rcp_f32 v21, v21
    v_rcp_f32 v22, v22
    v_rcp_f32 v23, v23
    v_mul_f32 v16, v84, v16
    v_mul_f32 v17, v85, v17
    v_mul_f32 v18, v86, v18
    v_mul_f32 v19, v87, v19
    v_mul_f32 v20, v116, v20
    v_mul_f32 v21, v117, v21
    v_mul_f32 v22, v118, v22
    v_mul_f32 v23, v119, v23
    v_cvt_pk_bf16_f32 v44, v16, v17
    v_cvt_pk_bf16_f32 v45, v18, v19
    v_cvt_pk_bf16_f32 v46, v20, v21
    v_cvt_pk_bf16_f32 v47, v22, v23
    s_add_u32 s51, s48, 1024
    buffer_store_dwordx4 v[44:47], v7, s[20:23], s51 offen sc1
    s_barrier
    s_add_u32 m0, s45, 0x9060
    s_add_u32 s50, s83, 0x480c0
    buffer_load_dwordx4 v8, s[12:15], s50 offen lds
    s_add_u32 m0, s45, 0x9460
    s_add_u32 s50, s83, 0x480c0
    buffer_load_dwordx4 v9, s[12:15], s50 offen lds
    s_add_u32 m0, s45, 0x9860
    s_add_u32 s50, s83, 0x480c0
    buffer_load_dwordx4 v10, s[12:15], s50 offen lds
    s_add_u32 m0, s47, 0x14000
    s_add_u32 s50, s85, 0x24000
    buffer_load_dwordx4 v11, s[8:11], s50 offen lds
    s_add_u32 m0, s47, 0x14400
    s_add_u32 s50, s85, 0x26400
    buffer_load_dwordx4 v12, s[8:11], s50 offen lds
    s_add_u32 m0, s47, 0x14800
    s_add_u32 s50, s85, 0x28800
    buffer_load_dwordx4 v11, s[8:11], s50 offen lds
    s_add_u32 m0, s47, 0x14c00
    s_add_u32 s50, s85, 0x2ac00
    buffer_load_dwordx4 v12, s[8:11], s50 offen lds
    v_mul_f32 v16, s49, v72
    v_mul_f32 v17, s49, v73
    v_mul_f32 v18, s49, v74
    v_mul_f32 v19, s49, v75
    v_mul_f32 v20, s49, v104
    v_mul_f32 v21, s49, v105
    v_mul_f32 v22, s49, v106
    v_mul_f32 v23, s49, v107
    v_exp_f32 v16, v16
    v_exp_f32 v17, v17
    v_exp_f32 v18, v18
    v_exp_f32 v19, v19
    v_exp_f32 v20, v20
    v_exp_f32 v21, v21
    v_exp_f32 v22, v22
    v_exp_f32 v23, v23
    v_add_f32 v16, 1.0, v16
    v_add_f32 v17, 1.0, v17
    v_add_f32 v18, 1.0, v18
    v_add_f32 v19, 1.0, v19
    v_add_f32 v20, 1.0, v20
    v_add_f32 v21, 1.0, v21
    v_add_f32 v22, 1.0, v22
    v_add_f32 v23, 1.0, v23
    v_rcp_f32 v16, v16
    v_rcp_f32 v17, v17
    v_rcp_f32 v18, v18
    v_rcp_f32 v19, v19
    v_rcp_f32 v20, v20
    v_rcp_f32 v21, v21
    v_rcp_f32 v22, v22
    v_rcp_f32 v23, v23
    v_mul_f32 v16, v88, v16
    v_mul_f32 v17, v89, v17
    v_mul_f32 v18, v90, v18
    v_mul_f32 v19, v91, v19
    v_mul_f32 v20, v120, v20
    v_mul_f32 v21, v121, v21
    v_mul_f32 v22, v122, v22
    v_mul_f32 v23, v123, v23
    v_cvt_pk_bf16_f32 v48, v16, v17
    v_cvt_pk_bf16_f32 v49, v18, v19
    v_cvt_pk_bf16_f32 v50, v20, v21
    v_cvt_pk_bf16_f32 v51, v22, v23
    s_add_u32 s51, s48, 2048
    buffer_store_dwordx4 v[48:51], v7, s[20:23], s51 offen sc1
    s_barrier
    s_add_u32 m0, s45, 0xc080
    s_add_u32 s50, s44, 0x1b00c0
    buffer_load_dwordx4 v8, s[12:15], s50 offen lds
    s_add_u32 m0, s45, 0xc480
    s_add_u32 s50, s44, 0x1b00c0
    buffer_load_dwordx4 v9, s[12:15], s50 offen lds
    s_add_u32 m0, s45, 0xc880
    s_add_u32 s50, s44, 0x1b00c0
    buffer_load_dwordx4 v10, s[12:15], s50 offen lds
    s_add_u32 m0, s47, 0x0
    s_add_u32 s50, s46, 0x180
    buffer_load_dwordx4 v11, s[8:11], s50 offen lds
    s_add_u32 m0, s47, 0x400
    s_add_u32 s50, s46, 0x2580
    buffer_load_dwordx4 v12, s[8:11], s50 offen lds
    s_add_u32 m0, s47, 0x800
    s_add_u32 s50, s46, 0x4980
    buffer_load_dwordx4 v11, s[8:11], s50 offen lds
    s_add_u32 m0, s47, 0xc00
    s_add_u32 s50, s46, 0x6d80
    buffer_load_dwordx4 v12, s[8:11], s50 offen lds
    v_mul_f32 v16, s49, v76
    v_mul_f32 v17, s49, v77
    v_mul_f32 v18, s49, v78
    v_mul_f32 v19, s49, v79
    v_mul_f32 v20, s49, v108
    v_mul_f32 v21, s49, v109
    v_mul_f32 v22, s49, v110
    v_mul_f32 v23, s49, v111
    v_exp_f32 v16, v16
    v_exp_f32 v17, v17
    v_exp_f32 v18, v18
    v_exp_f32 v19, v19
    v_exp_f32 v20, v20
    v_exp_f32 v21, v21
    v_exp_f32 v22, v22
    v_exp_f32 v23, v23
    v_add_f32 v16, 1.0, v16
    v_add_f32 v17, 1.0, v17
    v_add_f32 v18, 1.0, v18
    v_add_f32 v19, 1.0, v19
    v_add_f32 v20, 1.0, v20
    v_add_f32 v21, 1.0, v21
    v_add_f32 v22, 1.0, v22
    v_add_f32 v23, 1.0, v23
    v_rcp_f32 v16, v16
    v_rcp_f32 v17, v17
    v_rcp_f32 v18, v18
    v_rcp_f32 v19, v19
    v_rcp_f32 v20, v20
    v_rcp_f32 v21, v21
    v_rcp_f32 v22, v22
    v_rcp_f32 v23, v23
    v_mul_f32 v16, v92, v16
    v_mul_f32 v17, v93, v17
    v_mul_f32 v18, v94, v18
    v_mul_f32 v19, v95, v19
    v_mul_f32 v20, v124, v20
    v_mul_f32 v21, v125, v21
    v_mul_f32 v22, v126, v22
    v_mul_f32 v23, v127, v23
    v_cvt_pk_bf16_f32 v52, v16, v17
    v_cvt_pk_bf16_f32 v53, v18, v19
    v_cvt_pk_bf16_f32 v54, v20, v21
    v_cvt_pk_bf16_f32 v55, v22, v23
    s_add_u32 s51, s48, 3072
    buffer_store_dwordx4 v[52:55], v7, s[20:23], s51 offen sc1
    v_mul_f32 v16, s49, v128
    v_mul_f32 v17, s49, v129
    v_mul_f32 v18, s49, v130
    v_mul_f32 v19, s49, v131
    v_mul_f32 v20, s49, v160
    v_mul_f32 v21, s49, v161
    v_mul_f32 v22, s49, v162
    v_mul_f32 v23, s49, v163
    v_exp_f32 v16, v16
    v_exp_f32 v17, v17
    v_exp_f32 v18, v18
    v_exp_f32 v19, v19
    v_exp_f32 v20, v20
    v_exp_f32 v21, v21
    v_exp_f32 v22, v22
    v_exp_f32 v23, v23
    v_add_f32 v16, 1.0, v16
    v_add_f32 v17, 1.0, v17
    v_add_f32 v18, 1.0, v18
    v_add_f32 v19, 1.0, v19
    v_add_f32 v20, 1.0, v20
    v_add_f32 v21, 1.0, v21
    v_add_f32 v22, 1.0, v22
    v_add_f32 v23, 1.0, v23
    v_rcp_f32 v16, v16
    v_rcp_f32 v17, v17
    v_rcp_f32 v18, v18
    v_rcp_f32 v19, v19
    v_rcp_f32 v20, v20
    v_rcp_f32 v21, v21
    v_rcp_f32 v22, v22
    v_rcp_f32 v23, v23
    v_mul_f32 v16, v144, v16
    v_mul_f32 v17, v145, v17
    v_mul_f32 v18, v146, v18
    v_mul_f32 v19, v147, v19
    v_mul_f32 v20, v176, v20
    v_mul_f32 v21, v177, v21
    v_mul_f32 v22, v178, v22
    v_mul_f32 v23, v179, v23
    v_cvt_pk_bf16_f32 v40, v16, v17
    v_cvt_pk_bf16_f32 v41, v18, v19
    v_cvt_pk_bf16_f32 v42, v20, v21
    v_cvt_pk_bf16_f32 v43, v22, v23
    s_add_u32 s51, s48, 16384
    buffer_store_dwordx4 v[40:43], v7, s[20:23], s51 offen sc1
    s_waitcnt vmcnt(10)
    s_barrier
    s_add_u32 m0, s45, 0x0
    s_add_u32 s50, s44, 0x1f80c0
    buffer_load_dwordx4 v8, s[12:15], s50 offen lds
    s_add_u32 m0, s45, 0x400
    s_add_u32 s50, s44, 0x1f80c0
    buffer_load_dwordx4 v9, s[12:15], s50 offen lds
    s_add_u32 m0, s45, 0x800
    s_add_u32 s50, s44, 0x1f80c0
    buffer_load_dwordx4 v10, s[12:15], s50 offen lds
    s_add_u32 m0, s47, 0x4000
    s_add_u32 s50, s46, 0x24180
    buffer_load_dwordx4 v11, s[8:11], s50 offen lds
    s_add_u32 m0, s47, 0x4400
    s_add_u32 s50, s46, 0x26580
    buffer_load_dwordx4 v12, s[8:11], s50 offen lds
    s_add_u32 m0, s47, 0x4800
    s_add_u32 s50, s46, 0x28980
    buffer_load_dwordx4 v11, s[8:11], s50 offen lds
    s_add_u32 m0, s47, 0x4c00
    s_add_u32 s50, s46, 0x2ad80
    buffer_load_dwordx4 v12, s[8:11], s50 offen lds
    v_mul_f32 v16, s49, v132
    v_mul_f32 v17, s49, v133
    v_mul_f32 v18, s49, v134
    v_mul_f32 v19, s49, v135
    v_mul_f32 v20, s49, v164
    v_mul_f32 v21, s49, v165
    v_mul_f32 v22, s49, v166
    v_mul_f32 v23, s49, v167
    v_exp_f32 v16, v16
    v_exp_f32 v17, v17
    v_exp_f32 v18, v18
    v_exp_f32 v19, v19
    v_exp_f32 v20, v20
    v_exp_f32 v21, v21
    v_exp_f32 v22, v22
    v_exp_f32 v23, v23
    v_add_f32 v16, 1.0, v16
    v_add_f32 v17, 1.0, v17
    v_add_f32 v18, 1.0, v18
    v_add_f32 v19, 1.0, v19
    v_add_f32 v20, 1.0, v20
    v_add_f32 v21, 1.0, v21
    v_add_f32 v22, 1.0, v22
    v_add_f32 v23, 1.0, v23
    v_rcp_f32 v16, v16
    v_rcp_f32 v17, v17
    v_rcp_f32 v18, v18
    v_rcp_f32 v19, v19
    v_rcp_f32 v20, v20
    v_rcp_f32 v21, v21
    v_rcp_f32 v22, v22
    v_rcp_f32 v23, v23
    v_mul_f32 v16, v148, v16
    v_mul_f32 v17, v149, v17
    v_mul_f32 v18, v150, v18
    v_mul_f32 v19, v151, v19
    v_mul_f32 v20, v180, v20
    v_mul_f32 v21, v181, v21
    v_mul_f32 v22, v182, v22
    v_mul_f32 v23, v183, v23
    v_cvt_pk_bf16_f32 v44, v16, v17
    v_cvt_pk_bf16_f32 v45, v18, v19
    v_cvt_pk_bf16_f32 v46, v20, v21
    v_cvt_pk_bf16_f32 v47, v22, v23
    s_add_u32 s51, s48, 17408
    buffer_store_dwordx4 v[44:47], v7, s[20:23], s51 offen sc1
    s_barrier
    s_add_u32 m0, s45, 0x3020
    s_add_u32 s50, s82, 0x1b00c0
    buffer_load_dwordx4 v8, s[12:15], s50 offen lds
    s_add_u32 m0, s45, 0x3420
    s_add_u32 s50, s82, 0x1b00c0
    buffer_load_dwordx4 v9, s[12:15], s50 offen lds
    s_add_u32 m0, s45, 0x3820
    s_add_u32 s50, s82, 0x1b00c0
    buffer_load_dwordx4 v10, s[12:15], s50 offen lds
    s_add_u32 m0, s47, 0x8000
    s_add_u32 s50, s84, 0x180
    buffer_load_dwordx4 v11, s[8:11], s50 offen lds
    s_add_u32 m0, s47, 0x8400
    s_add_u32 s50, s84, 0x2580
    buffer_load_dwordx4 v12, s[8:11], s50 offen lds
    s_add_u32 m0, s47, 0x8800
    s_add_u32 s50, s84, 0x4980
    buffer_load_dwordx4 v11, s[8:11], s50 offen lds
    s_add_u32 m0, s47, 0x8c00
    s_add_u32 s50, s84, 0x6d80
    buffer_load_dwordx4 v12, s[8:11], s50 offen lds
    v_mul_f32 v16, s49, v136
    v_mul_f32 v17, s49, v137
    v_mul_f32 v18, s49, v138
    v_mul_f32 v19, s49, v139
    v_mul_f32 v20, s49, v168
    v_mul_f32 v21, s49, v169
    v_mul_f32 v22, s49, v170
    v_mul_f32 v23, s49, v171
    v_exp_f32 v16, v16
    v_exp_f32 v17, v17
    v_exp_f32 v18, v18
    v_exp_f32 v19, v19
    v_exp_f32 v20, v20
    v_exp_f32 v21, v21
    v_exp_f32 v22, v22
    v_exp_f32 v23, v23
    v_add_f32 v16, 1.0, v16
    v_add_f32 v17, 1.0, v17
    v_add_f32 v18, 1.0, v18
    v_add_f32 v19, 1.0, v19
    v_add_f32 v20, 1.0, v20
    v_add_f32 v21, 1.0, v21
    v_add_f32 v22, 1.0, v22
    v_add_f32 v23, 1.0, v23
    v_rcp_f32 v16, v16
    v_rcp_f32 v17, v17
    v_rcp_f32 v18, v18
    v_rcp_f32 v19, v19
    v_rcp_f32 v20, v20
    v_rcp_f32 v21, v21
    v_rcp_f32 v22, v22
    v_rcp_f32 v23, v23
    v_mul_f32 v16, v152, v16
    v_mul_f32 v17, v153, v17
    v_mul_f32 v18, v154, v18
    v_mul_f32 v19, v155, v19
    v_mul_f32 v20, v184, v20
    v_mul_f32 v21, v185, v21
    v_mul_f32 v22, v186, v22
    v_mul_f32 v23, v187, v23
    v_cvt_pk_bf16_f32 v48, v16, v17
    v_cvt_pk_bf16_f32 v49, v18, v19
    v_cvt_pk_bf16_f32 v50, v20, v21
    v_cvt_pk_bf16_f32 v51, v22, v23
    s_add_u32 s51, s48, 18432
    buffer_store_dwordx4 v[48:51], v7, s[20:23], s51 offen sc1
    v_mul_f32 v16, s49, v140
    v_mul_f32 v17, s49, v141
    v_mul_f32 v18, s49, v142
    v_mul_f32 v19, s49, v143
    v_mul_f32 v20, s49, v172
    v_mul_f32 v21, s49, v173
    v_mul_f32 v22, s49, v174
    v_mul_f32 v23, s49, v175
    v_exp_f32 v16, v16
    v_exp_f32 v17, v17
    v_exp_f32 v18, v18
    v_exp_f32 v19, v19
    v_exp_f32 v20, v20
    v_exp_f32 v21, v21
    v_exp_f32 v22, v22
    v_exp_f32 v23, v23
    v_add_f32 v16, 1.0, v16
    v_add_f32 v17, 1.0, v17
    v_add_f32 v18, 1.0, v18
    v_add_f32 v19, 1.0, v19
    v_add_f32 v20, 1.0, v20
    v_add_f32 v21, 1.0, v21
    v_add_f32 v22, 1.0, v22
    v_add_f32 v23, 1.0, v23
    v_rcp_f32 v16, v16
    v_rcp_f32 v17, v17
    v_rcp_f32 v18, v18
    v_rcp_f32 v19, v19
    v_rcp_f32 v20, v20
    v_rcp_f32 v21, v21
    v_rcp_f32 v22, v22
    v_rcp_f32 v23, v23
    v_mul_f32 v16, v156, v16
    v_mul_f32 v17, v157, v17
    v_mul_f32 v18, v158, v18
    v_mul_f32 v19, v159, v19
    v_mul_f32 v20, v188, v20
    v_mul_f32 v21, v189, v21
    v_mul_f32 v22, v190, v22
    v_mul_f32 v23, v191, v23
    v_cvt_pk_bf16_f32 v52, v16, v17
    v_cvt_pk_bf16_f32 v53, v18, v19
    v_cvt_pk_bf16_f32 v54, v20, v21
    v_cvt_pk_bf16_f32 v55, v22, v23
    s_add_u32 s51, s48, 19456
    buffer_store_dwordx4 v[52:55], v7, s[20:23], s51 offen sc1
    s_waitcnt vmcnt(10)
    s_barrier
    s_add_u32 m0, s45, 0x6040
    s_add_u32 s50, s82, 0x1f80c0
    buffer_load_dwordx4 v8, s[12:15], s50 offen lds
    s_add_u32 m0, s45, 0x6440
    s_add_u32 s50, s82, 0x1f80c0
    buffer_load_dwordx4 v9, s[12:15], s50 offen lds
    s_add_u32 m0, s45, 0x6840
    s_add_u32 s50, s82, 0x1f80c0
    buffer_load_dwordx4 v10, s[12:15], s50 offen lds
    s_add_u32 m0, s47, 0xc000
    s_add_u32 s50, s84, 0x24180
    buffer_load_dwordx4 v11, s[8:11], s50 offen lds
    s_add_u32 m0, s47, 0xc400
    s_add_u32 s50, s84, 0x26580
    buffer_load_dwordx4 v12, s[8:11], s50 offen lds
    s_add_u32 m0, s47, 0xc800
    s_add_u32 s50, s84, 0x28980
    buffer_load_dwordx4 v11, s[8:11], s50 offen lds
    s_add_u32 m0, s47, 0xcc00
    s_add_u32 s50, s84, 0x2ad80
    buffer_load_dwordx4 v12, s[8:11], s50 offen lds
    v_mul_f32 v16, s49, v192
    v_mul_f32 v17, s49, v193
    v_mul_f32 v18, s49, v194
    v_mul_f32 v19, s49, v195
    v_mul_f32 v20, s49, v224
    v_mul_f32 v21, s49, v225
    v_mul_f32 v22, s49, v226
    v_mul_f32 v23, s49, v227
    v_exp_f32 v16, v16
    v_exp_f32 v17, v17
    v_exp_f32 v18, v18
    v_exp_f32 v19, v19
    v_exp_f32 v20, v20
    v_exp_f32 v21, v21
    v_exp_f32 v22, v22
    v_exp_f32 v23, v23
    v_add_f32 v16, 1.0, v16
    v_add_f32 v17, 1.0, v17
    v_add_f32 v18, 1.0, v18
    v_add_f32 v19, 1.0, v19
    v_add_f32 v20, 1.0, v20
    v_add_f32 v21, 1.0, v21
    v_add_f32 v22, 1.0, v22
    v_add_f32 v23, 1.0, v23
    v_rcp_f32 v16, v16
    v_rcp_f32 v17, v17
    v_rcp_f32 v18, v18
    v_rcp_f32 v19, v19
    v_rcp_f32 v20, v20
    v_rcp_f32 v21, v21
    v_rcp_f32 v22, v22
    v_rcp_f32 v23, v23
    v_mul_f32 v16, v208, v16
    v_mul_f32 v17, v209, v17
    v_mul_f32 v18, v210, v18
    v_mul_f32 v19, v211, v19
    v_mul_f32 v20, v240, v20
    v_mul_f32 v21, v241, v21
    v_mul_f32 v22, v242, v22
    v_mul_f32 v23, v243, v23
    v_cvt_pk_bf16_f32 v40, v16, v17
    v_cvt_pk_bf16_f32 v41, v18, v19
    v_cvt_pk_bf16_f32 v42, v20, v21
    v_cvt_pk_bf16_f32 v43, v22, v23
    s_add_u32 s51, s48, 32768
    buffer_store_dwordx4 v[40:43], v7, s[20:23], s51 offen sc1
    s_barrier
    s_add_u32 m0, s45, 0x9060
    s_add_u32 s50, s83, 0x1b00c0
    buffer_load_dwordx4 v8, s[12:15], s50 offen lds
    s_add_u32 m0, s45, 0x9460
    s_add_u32 s50, s83, 0x1b00c0
    buffer_load_dwordx4 v9, s[12:15], s50 offen lds
    s_add_u32 m0, s45, 0x9860
    s_add_u32 s50, s83, 0x1b00c0
    buffer_load_dwordx4 v10, s[12:15], s50 offen lds
    s_add_u32 m0, s47, 0x10000
    s_add_u32 s50, s85, 0x180
    buffer_load_dwordx4 v11, s[8:11], s50 offen lds
    s_add_u32 m0, s47, 0x10400
    s_add_u32 s50, s85, 0x2580
    buffer_load_dwordx4 v12, s[8:11], s50 offen lds
    s_add_u32 m0, s47, 0x10800
    s_add_u32 s50, s85, 0x4980
    buffer_load_dwordx4 v11, s[8:11], s50 offen lds
    s_add_u32 m0, s47, 0x10c00
    s_add_u32 s50, s85, 0x6d80
    buffer_load_dwordx4 v12, s[8:11], s50 offen lds
    v_mul_f32 v16, s49, v196
    v_mul_f32 v17, s49, v197
    v_mul_f32 v18, s49, v198
    v_mul_f32 v19, s49, v199
    v_mul_f32 v20, s49, v228
    v_mul_f32 v21, s49, v229
    v_mul_f32 v22, s49, v230
    v_mul_f32 v23, s49, v231
    v_exp_f32 v16, v16
    v_exp_f32 v17, v17
    v_exp_f32 v18, v18
    v_exp_f32 v19, v19
    v_exp_f32 v20, v20
    v_exp_f32 v21, v21
    v_exp_f32 v22, v22
    v_exp_f32 v23, v23
    v_add_f32 v16, 1.0, v16
    v_add_f32 v17, 1.0, v17
    v_add_f32 v18, 1.0, v18
    v_add_f32 v19, 1.0, v19
    v_add_f32 v20, 1.0, v20
    v_add_f32 v21, 1.0, v21
    v_add_f32 v22, 1.0, v22
    v_add_f32 v23, 1.0, v23
    v_rcp_f32 v16, v16
    v_rcp_f32 v17, v17
    v_rcp_f32 v18, v18
    v_rcp_f32 v19, v19
    v_rcp_f32 v20, v20
    v_rcp_f32 v21, v21
    v_rcp_f32 v22, v22
    v_rcp_f32 v23, v23
    v_mul_f32 v16, v212, v16
    v_mul_f32 v17, v213, v17
    v_mul_f32 v18, v214, v18
    v_mul_f32 v19, v215, v19
    v_mul_f32 v20, v244, v20
    v_mul_f32 v21, v245, v21
    v_mul_f32 v22, v246, v22
    v_mul_f32 v23, v247, v23
    v_cvt_pk_bf16_f32 v44, v16, v17
    v_cvt_pk_bf16_f32 v45, v18, v19
    v_cvt_pk_bf16_f32 v46, v20, v21
    v_cvt_pk_bf16_f32 v47, v22, v23
    s_add_u32 s51, s48, 33792
    buffer_store_dwordx4 v[44:47], v7, s[20:23], s51 offen sc1
    v_mul_f32 v16, s49, v200
    v_mul_f32 v17, s49, v201
    v_mul_f32 v18, s49, v202
    v_mul_f32 v19, s49, v203
    v_mul_f32 v20, s49, v232
    v_mul_f32 v21, s49, v233
    v_mul_f32 v22, s49, v234
    v_mul_f32 v23, s49, v235
    v_exp_f32 v16, v16
    v_exp_f32 v17, v17
    v_exp_f32 v18, v18
    v_exp_f32 v19, v19
    v_exp_f32 v20, v20
    v_exp_f32 v21, v21
    v_exp_f32 v22, v22
    v_exp_f32 v23, v23
    v_add_f32 v16, 1.0, v16
    v_add_f32 v17, 1.0, v17
    v_add_f32 v18, 1.0, v18
    v_add_f32 v19, 1.0, v19
    v_add_f32 v20, 1.0, v20
    v_add_f32 v21, 1.0, v21
    v_add_f32 v22, 1.0, v22
    v_add_f32 v23, 1.0, v23
    v_rcp_f32 v16, v16
    v_rcp_f32 v17, v17
    v_rcp_f32 v18, v18
    v_rcp_f32 v19, v19
    v_rcp_f32 v20, v20
    v_rcp_f32 v21, v21
    v_rcp_f32 v22, v22
    v_rcp_f32 v23, v23
    v_mul_f32 v16, v216, v16
    v_mul_f32 v17, v217, v17
    v_mul_f32 v18, v218, v18
    v_mul_f32 v19, v219, v19
    v_mul_f32 v20, v248, v20
    v_mul_f32 v21, v249, v21
    v_mul_f32 v22, v250, v22
    v_mul_f32 v23, v251, v23
    v_cvt_pk_bf16_f32 v48, v16, v17
    v_cvt_pk_bf16_f32 v49, v18, v19
    v_cvt_pk_bf16_f32 v50, v20, v21
    v_cvt_pk_bf16_f32 v51, v22, v23
    s_add_u32 s51, s48, 34816
    buffer_store_dwordx4 v[48:51], v7, s[20:23], s51 offen sc1
    s_waitcnt vmcnt(10)
    s_barrier
    s_add_u32 m0, s45, 0xc080
    s_add_u32 s50, s83, 0x1f80c0
    buffer_load_dwordx4 v8, s[12:15], s50 offen lds
    s_add_u32 m0, s45, 0xc480
    s_add_u32 s50, s83, 0x1f80c0
    buffer_load_dwordx4 v9, s[12:15], s50 offen lds
    s_add_u32 m0, s45, 0xc880
    s_add_u32 s50, s83, 0x1f80c0
    buffer_load_dwordx4 v10, s[12:15], s50 offen lds
    s_add_u32 m0, s47, 0x14000
    s_add_u32 s50, s85, 0x24180
    buffer_load_dwordx4 v11, s[8:11], s50 offen lds
    s_add_u32 m0, s47, 0x14400
    s_add_u32 s50, s85, 0x26580
    buffer_load_dwordx4 v12, s[8:11], s50 offen lds
    s_add_u32 m0, s47, 0x14800
    s_add_u32 s50, s85, 0x28980
    buffer_load_dwordx4 v11, s[8:11], s50 offen lds
    s_add_u32 m0, s47, 0x14c00
    s_add_u32 s50, s85, 0x2ad80
    buffer_load_dwordx4 v12, s[8:11], s50 offen lds
    v_mul_f32 v16, s49, v204
    v_mul_f32 v17, s49, v205
    v_mul_f32 v18, s49, v206
    v_mul_f32 v19, s49, v207
    v_mul_f32 v20, s49, v236
    v_mul_f32 v21, s49, v237
    v_mul_f32 v22, s49, v238
    v_mul_f32 v23, s49, v239
    v_exp_f32 v16, v16
    v_exp_f32 v17, v17
    v_exp_f32 v18, v18
    v_exp_f32 v19, v19
    v_exp_f32 v20, v20
    v_exp_f32 v21, v21
    v_exp_f32 v22, v22
    v_exp_f32 v23, v23
    v_add_f32 v16, 1.0, v16
    v_add_f32 v17, 1.0, v17
    v_add_f32 v18, 1.0, v18
    v_add_f32 v19, 1.0, v19
    v_add_f32 v20, 1.0, v20
    v_add_f32 v21, 1.0, v21
    v_add_f32 v22, 1.0, v22
    v_add_f32 v23, 1.0, v23
    v_rcp_f32 v16, v16
    v_rcp_f32 v17, v17
    v_rcp_f32 v18, v18
    v_rcp_f32 v19, v19
    v_rcp_f32 v20, v20
    v_rcp_f32 v21, v21
    v_rcp_f32 v22, v22
    v_rcp_f32 v23, v23
    v_mul_f32 v16, v220, v16
    v_mul_f32 v17, v221, v17
    v_mul_f32 v18, v222, v18
    v_mul_f32 v19, v223, v19
    v_mul_f32 v20, v252, v20
    v_mul_f32 v21, v253, v21
    v_mul_f32 v22, v254, v22
    v_mul_f32 v23, v255, v23
    v_cvt_pk_bf16_f32 v52, v16, v17
    v_cvt_pk_bf16_f32 v53, v18, v19
    v_cvt_pk_bf16_f32 v54, v20, v21
    v_cvt_pk_bf16_f32 v55, v22, v23
    s_add_u32 s51, s48, 35840
    buffer_store_dwordx4 v[52:55], v7, s[20:23], s51 offen sc1
    s_barrier
    s_add_u32 m0, s45, 0x0
    s_add_u32 s50, s44, 0x3600c0
    buffer_load_dwordx4 v8, s[12:15], s50 offen lds
    s_add_u32 m0, s45, 0x400
    s_add_u32 s50, s44, 0x3600c0
    buffer_load_dwordx4 v9, s[12:15], s50 offen lds
    s_add_u32 m0, s45, 0x800
    s_add_u32 s50, s44, 0x3600c0
    buffer_load_dwordx4 v10, s[12:15], s50 offen lds
    s_add_u32 m0, s47, 0x0
    s_add_u32 s50, s46, 0x300
    buffer_load_dwordx4 v11, s[8:11], s50 offen lds
    s_add_u32 m0, s47, 0x400
    s_add_u32 s50, s46, 0x2700
    buffer_load_dwordx4 v12, s[8:11], s50 offen lds
    s_add_u32 m0, s47, 0x800
    s_add_u32 s50, s46, 0x4b00
    buffer_load_dwordx4 v11, s[8:11], s50 offen lds
    s_add_u32 m0, s47, 0xc00
    s_add_u32 s50, s46, 0x6f00
    buffer_load_dwordx4 v12, s[8:11], s50 offen lds
    v_min_u32 v49, 11, v1
    v_lshlrev_b32 v49, 7, v49
    v_bfe_u32 v56, v1, 4, 1
    v_lshlrev_b32 v56, 10, v56
    v_lshrrev_b32 v57, 5, v1
    v_lshl_add_u32 v56, v57, 8, v56
    v_and_b32 v57, 15, v1
    v_lshl_add_u32 v48, v57, 4, v56
    v_lshrrev_b32 v56, 5, v1
    v_lshlrev_b32 v56, 2, v56
    v_bfe_u32 v57, v1, 2, 2
    v_add_u32 v56, v56, v57
    s_mov_b32 s50, 384
    v_mul_u32_u24 v56, s50, v56
    v_bfe_u32 v57, v1, 4, 1
    v_lshl_add_u32 v56, v57, 5, v56
    v_and_b32 v57, 3, v1
    v_lshl_add_u32 v56, v57, 3, v56
    v_bfe_u32 v57, v1, 3, 1
    v_lshlrev_b32 v57, 6, v57
    v_add_u32 v2, v56, v57
    v_sub_u32 v3, v56, v57
    v_add_u32 v4, 49152, v2
    v_add_u32 v5, 49152, v3
    v_add_u32 v6, 98304, v2
    v_add_u32 v0, 98304, v3
    buffer_load_dword v58, v59, s[28:31], 0 offen sc1
    s_waitcnt vmcnt(9)
    s_barrier
    s_add_u32 m0, s45, 0x3020
    s_add_u32 s50, s44, 0x3a80c0
    buffer_load_dwordx4 v8, s[12:15], s50 offen lds
    s_add_u32 m0, s45, 0x3420
    s_add_u32 s50, s44, 0x3a80c0
    buffer_load_dwordx4 v9, s[12:15], s50 offen lds
    s_add_u32 m0, s45, 0x3820
    s_add_u32 s50, s44, 0x3a80c0
    buffer_load_dwordx4 v10, s[12:15], s50 offen lds
    s_add_u32 m0, s47, 0x4000
    s_add_u32 s50, s46, 0x24300
    buffer_load_dwordx4 v11, s[8:11], s50 offen lds
    s_add_u32 m0, s47, 0x4400
    s_add_u32 s50, s46, 0x26700
    buffer_load_dwordx4 v12, s[8:11], s50 offen lds
    s_add_u32 m0, s47, 0x4800
    s_add_u32 s50, s46, 0x28b00
    buffer_load_dwordx4 v11, s[8:11], s50 offen lds
    s_add_u32 m0, s47, 0x4c00
    s_add_u32 s50, s46, 0x2af00
    buffer_load_dwordx4 v12, s[8:11], s50 offen lds
    s_barrier
    s_add_u32 m0, s45, 0x6040
    s_add_u32 s50, s82, 0x3600c0
    buffer_load_dwordx4 v8, s[12:15], s50 offen lds
    s_add_u32 m0, s45, 0x6440
    s_add_u32 s50, s82, 0x3600c0
    buffer_load_dwordx4 v9, s[12:15], s50 offen lds
    s_add_u32 m0, s45, 0x6840
    s_add_u32 s50, s82, 0x3600c0
    buffer_load_dwordx4 v10, s[12:15], s50 offen lds
    s_add_u32 m0, s47, 0x8000
    s_add_u32 s50, s84, 0x300
    buffer_load_dwordx4 v11, s[8:11], s50 offen lds
    s_add_u32 m0, s47, 0x8400
    s_add_u32 s50, s84, 0x2700
    buffer_load_dwordx4 v12, s[8:11], s50 offen lds
    s_add_u32 m0, s47, 0x8800
    s_add_u32 s50, s84, 0x4b00
    buffer_load_dwordx4 v11, s[8:11], s50 offen lds
    s_add_u32 m0, s47, 0x8c00
    s_add_u32 s50, s84, 0x6f00
    buffer_load_dwordx4 v12, s[8:11], s50 offen lds
    s_waitcnt vmcnt(22)
    v_mov_b32 v60, 1
    v_mov_b32 v61, 1
    v_mov_b32 v62, 1
    v_mov_b32 v63, 1
    s_add_u32 s51, s99, 0
    s_mov_b64 exec, 0xff
    buffer_store_dwordx4 v[60:63], v7, s[20:23], s51 offen sc1
    s_mov_b64 exec, -1
    s_nop 0
    s_waitcnt vmcnt(15)
    s_mov_b32 s100, 0x8000
L_spin_3:
    v_cmp_gt_u32 vcc, 8, v58
    s_and_b32 s50, vcc_hi, 0xffffffff
    s_cbranch_scc0 L_ok_2
    s_sub_u32 s100, s100, 1
    s_cbranch_scc1 L_ok_2
    s_sleep 1
    buffer_load_dword v58, v59, s[28:31], 0 offen sc1
    s_waitcnt vmcnt(0)
    s_branch L_spin_3
L_ok_2:
    s_waitcnt vmcnt(8)
    s_barrier
    s_add_u32 m0, s45, 0x9060
    s_add_u32 s50, s82, 0x3a80c0
    buffer_load_dwordx4 v8, s[12:15], s50 offen lds
    s_add_u32 m0, s45, 0x9460
    s_add_u32 s50, s82, 0x3a80c0
    buffer_load_dwordx4 v9, s[12:15], s50 offen lds
    s_add_u32 m0, s45, 0x9860
    s_add_u32 s50, s82, 0x3a80c0
    buffer_load_dwordx4 v10, s[12:15], s50 offen lds
    s_add_u32 m0, s47, 0xc000
    s_add_u32 s50, s84, 0x24300
    buffer_load_dwordx4 v11, s[8:11], s50 offen lds
    s_add_u32 m0, s47, 0xc400
    s_add_u32 s50, s84, 0x26700
    buffer_load_dwordx4 v12, s[8:11], s50 offen lds
    s_add_u32 m0, s47, 0xc800
    s_add_u32 s50, s84, 0x28b00
    buffer_load_dwordx4 v11, s[8:11], s50 offen lds
    s_add_u32 m0, s47, 0xcc00
    s_add_u32 s50, s84, 0x2af00
    buffer_load_dwordx4 v12, s[8:11], s50 offen lds
    s_barrier
    s_add_u32 m0, s45, 0xc080
    s_add_u32 s50, s83, 0x3600c0
    buffer_load_dwordx4 v8, s[12:15], s50 offen lds
    s_add_u32 m0, s45, 0xc480
    s_add_u32 s50, s83, 0x3600c0
    buffer_load_dwordx4 v9, s[12:15], s50 offen lds
    s_add_u32 m0, s45, 0xc880
    s_add_u32 s50, s83, 0x3600c0
    buffer_load_dwordx4 v10, s[12:15], s50 offen lds
    s_add_u32 m0, s47, 0x10000
    s_add_u32 s50, s85, 0x300
    buffer_load_dwordx4 v11, s[8:11], s50 offen lds
    s_add_u32 m0, s47, 0x10400
    s_add_u32 s50, s85, 0x2700
    buffer_load_dwordx4 v12, s[8:11], s50 offen lds
    s_add_u32 m0, s47, 0x10800
    s_add_u32 s50, s85, 0x4b00
    buffer_load_dwordx4 v11, s[8:11], s50 offen lds
    s_add_u32 m0, s47, 0x10c00
    s_add_u32 s50, s85, 0x6f00
    buffer_load_dwordx4 v12, s[8:11], s50 offen lds
    s_add_u32 s4, s98, 0
    buffer_load_dword v58, v49, s[20:23], s4 offen sc1
    s_waitcnt vmcnt(8)
    s_barrier
    s_add_u32 m0, s45, 0x0
    s_add_u32 s50, s83, 0x3a80c0
    buffer_load_dwordx4 v8, s[12:15], s50 offen lds
    s_add_u32 m0, s45, 0x400
    s_add_u32 s50, s83, 0x3a80c0
    buffer_load_dwordx4 v9, s[12:15], s50 offen lds
    s_add_u32 m0, s45, 0x800
    s_add_u32 s50, s83, 0x3a80c0
    buffer_load_dwordx4 v10, s[12:15], s50 offen lds
    s_add_u32 m0, s47, 0x14000
    s_add_u32 s50, s85, 0x24300
    buffer_load_dwordx4 v11, s[8:11], s50 offen lds
    s_add_u32 m0, s47, 0x14400
    s_add_u32 s50, s85, 0x26700
    buffer_load_dwordx4 v12, s[8:11], s50 offen lds
    s_add_u32 m0, s47, 0x14800
    s_add_u32 s50, s85, 0x28b00
    buffer_load_dwordx4 v11, s[8:11], s50 offen lds
    s_add_u32 m0, s47, 0x14c00
    s_add_u32 s50, s85, 0x2af00
    buffer_load_dwordx4 v12, s[8:11], s50 offen lds
    s_waitcnt vmcnt(7)
    s_mov_b32 s100, 0x8000
L_spin_5:
    v_cmp_gt_u32 vcc, 1, v58
    s_and_b32 s50, vcc_lo, 0xfff
    s_cbranch_scc0 L_ok_4
    s_sub_u32 s100, s100, 1
    s_cbranch_scc1 L_ok_4
    s_sleep 1
    buffer_load_dword v58, v49, s[20:23], s4 offen sc1
    s_waitcnt vmcnt(0)
    s_branch L_spin_5
L_ok_4:
    s_add_u32 s50, s91, 0
    buffer_load_dwordx4 v[160:163], v48, s[20:23], s50 offen sc1
    s_add_u32 s50, s91, 512
    buffer_load_dwordx4 v[164:167], v48, s[20:23], s50 offen sc1
    s_add_u32 s50, s92, 0
    buffer_load_dwordx4 v[168:171], v48, s[20:23], s50 offen sc1
    s_add_u32 s50, s92, 512
    buffer_load_dwordx4 v[172:175], v48, s[20:23], s50 offen sc1
    s_add_u32 s50, s93, 0
    buffer_load_dwordx4 v[176:179], v48, s[20:23], s50 offen sc1
    s_barrier
    s_add_u32 m0, s58, 0x0
    s_add_u32 s50, s88, 0x0
    buffer_load_dwordx4 v13, s[16:19], s50 offen lds
    s_add_u32 m0, s58, 0x400
    s_add_u32 s50, s88, 0x0
    buffer_load_dwordx4 v14, s[16:19], s50 offen lds
    s_add_u32 m0, s58, 0x800
    s_add_u32 s50, s88, 0x0
    buffer_load_dwordx4 v15, s[16:19], s50 offen lds
    s_add_u32 m0, s58, 0xc00
    s_add_u32 s50, s88, 0x2400
    buffer_load_dwordx4 v13, s[16:19], s50 offen lds
    s_add_u32 m0, s58, 0x1000
    s_add_u32 s50, s88, 0x2400
    buffer_load_dwordx4 v14, s[16:19], s50 offen lds
    s_add_u32 m0, s58, 0x1400
    s_add_u32 s50, s88, 0x2400
    buffer_load_dwordx4 v15, s[16:19], s50 offen lds
    s_add_u32 s50, s93, 512
    buffer_load_dwordx4 v[180:183], v48, s[20:23], s50 offen sc1
    s_add_u32 s50, s94, 0
    buffer_load_dwordx4 v[184:187], v48, s[20:23], s50 offen sc1
    s_add_u32 s50, s94, 512
    buffer_load_dwordx4 v[188:191], v48, s[20:23], s50 offen sc1
    s_add_u32 s50, s95, 0
    buffer_load_dwordx4 v[192:195], v48, s[20:23], s50 offen sc1
    s_add_u32 s50, s95, 512
    buffer_load_dwordx4 v[196:199], v48, s[20:23], s50 offen sc1
    s_waitcnt vmcnt(16)
    s_barrier
    s_add_u32 s50, s96, 0
    buffer_load_dwordx4 v[200:203], v48, s[20:23], s50 offen sc1
    s_add_u32 s50, s96, 512
    buffer_load_dwordx4 v[204:207], v48, s[20:23], s50 offen sc1
    s_add_u32 s50, s91, 16384
    buffer_load_dwordx4 v[208:211], v48, s[20:23], s50 offen sc1
    s_add_u32 s50, s91, 16896
    buffer_load_dwordx4 v[212:215], v48, s[20:23], s50 offen sc1
    s_add_u32 s50, s92, 16384
    buffer_load_dwordx4 v[216:219], v48, s[20:23], s50 offen sc1
    s_barrier
    s_add_u32 m0, s58, 0x6000
    s_add_u32 s50, s89, 0x0
    buffer_load_dwordx4 v13, s[16:19], s50 offen lds
    s_add_u32 m0, s58, 0x6400
    s_add_u32 s50, s89, 0x0
    buffer_load_dwordx4 v14, s[16:19], s50 offen lds
    s_add_u32 m0, s58, 0x6800
    s_add_u32 s50, s89, 0x0
    buffer_load_dwordx4 v15, s[16:19], s50 offen lds
    s_add_u32 m0, s58, 0x6c00
    s_add_u32 s50, s89, 0x2400
    buffer_load_dwordx4 v13, s[16:19], s50 offen lds
    s_add_u32 m0, s58, 0x7000
    s_add_u32 s50, s89, 0x2400
    buffer_load_dwordx4 v14, s[16:19], s50 offen lds
    s_add_u32 m0, s58, 0x7400
    s_add_u32 s50, s89, 0x2400
    buffer_load_dwordx4 v15, s[16:19], s50 offen lds
    s_add_u32 m0, s58, 0x1e000
    s_add_u32 s50, s90, 0x0
    buffer_load_dwordx4 v13, s[16:19], s50 offen lds
    s_add_u32 m0, s58, 0x1e400
    s_add_u32 s50, s90, 0x0
    buffer_load_dwordx4 v14, s[16:19], s50 offen lds
    s_add_u32 m0, s58, 0x1e800
    s_add_u32 s50, s90, 0x0
    buffer_load_dwordx4 v15, s[16:19], s50 offen lds
    s_add_u32 m0, s58, 0x1ec00
    s_add_u32 s50, s90, 0x2400
    buffer_load_dwordx4 v13, s[16:19], s50 offen lds
    s_add_u32 m0, s58, 0x1f000
    s_add_u32 s50, s90, 0x2400
    buffer_load_dwordx4 v14, s[16:19], s50 offen lds
    s_add_u32 m0, s58, 0x1f400
    s_add_u32 s50, s90, 0x2400
    buffer_load_dwordx4 v15, s[16:19], s50 offen lds
    s_add_u32 s50, s92, 16896
    buffer_load_dwordx4 v[220:223], v48, s[20:23], s50 offen sc1
    s_add_u32 s50, s93, 16384
    buffer_load_dwordx4 v[224:227], v48, s[20:23], s50 offen sc1
    s_add_u32 s50, s93, 16896
    buffer_load_dwordx4 v[228:231], v48, s[20:23], s50 offen sc1
    s_add_u32 s50, s94, 16384
    buffer_load_dwordx4 v[232:235], v48, s[20:23], s50 offen sc1
    s_add_u32 s50, s94, 16896
    buffer_load_dwordx4 v[236:239], v48, s[20:23], s50 offen sc1
    s_waitcnt vmcnt(27)
    s_barrier
    s_add_u32 s50, s95, 16384
    buffer_load_dwordx4 v[240:243], v48, s[20:23], s50 offen sc1
    s_add_u32 s50, s95, 16896
    buffer_load_dwordx4 v[244:247], v48, s[20:23], s50 offen sc1
    s_add_u32 s50, s96, 16384
    buffer_load_dwordx4 v[248:251], v48, s[20:23], s50 offen sc1
    s_add_u32 s50, s96, 16896
    buffer_load_dwordx4 v[252:255], v48, s[20:23], s50 offen sc1
    s_waitcnt vmcnt(15)
    ds_read_b64_tr_b16 v[16:17], v2 offset:0
    ds_read_b64_tr_b16 v[18:19], v2 offset:6144
    ds_read_b64_tr_b16 v[20:21], v3 offset:64
    ds_read_b64_tr_b16 v[22:23], v3 offset:6208
    ds_read_b64_tr_b16 v[24:25], v2 offset:128
    ds_read_b64_tr_b16 v[26:27], v2 offset:6272
    ds_read_b64_tr_b16 v[28:29], v3 offset:192
    ds_read_b64_tr_b16 v[30:31], v3 offset:6336
    ds_read_b64_tr_b16 v[32:33], v2 offset:256
    ds_read_b64_tr_b16 v[34:35], v2 offset:6400
    ds_read_b64_tr_b16 v[36:37], v3 offset:320
    ds_read_b64_tr_b16 v[38:39], v3 offset:6464
    ds_read_b64_tr_b16 v[40:41], v2 offset:3072
    ds_read_b64_tr_b16 v[42:43], v2 offset:9216
    s_barrier
    s_waitcnt lgkmcnt(12)
    v_mfma_f32_32x32x16_bf16 v[64:79], v[16:19], v[160:163], 0
    ds_read_b64_tr_b16 v[44:45], v3 offset:3136
    ds_read_b64_tr_b16 v[46:47], v3 offset:9280
    s_add_u32 m0, s58, 0xc000
    s_add_u32 s50, s88, 0x9000
    buffer_load_dwordx4 v13, s[16:19], s50 offen lds
    s_waitcnt lgkmcnt(12)
    v_mfma_f32_32x32x16_bf16 v[80:95], v[20:23], v[160:163], 0
    ds_read_b64_tr_b16 v[16:17], v2 offset:3200
    ds_read_b64_tr_b16 v[18:19], v2 offset:9344
    s_add_u32 m0, s58, 0xc400
    s_add_u32 s50, s88, 0x9000
    buffer_load_dwordx4 v14, s[16:19], s50 offen lds
    s_waitcnt lgkmcnt(12)
    v_mfma_f32_32x32x16_bf16 v[96:111], v[24:27], v[160:163], 0
    ds_read_b64_tr_b16 v[20:21], v3 offset:3264
    ds_read_b64_tr_b16 v[22:23], v3 offset:9408
    s_add_u32 m0, s58, 0xc800
    s_add_u32 s50, s88, 0x9000
    buffer_load_dwordx4 v15, s[16:19], s50 offen lds
    s_waitcnt lgkmcnt(12)
    v_mfma_f32_32x32x16_bf16 v[112:127], v[28:31], v[160:163], 0
    ds_read_b64_tr_b16 v[24:25], v2 offset:3328
    ds_read_b64_tr_b16 v[26:27], v2 offset:9472
    s_add_u32 m0, s58, 0xcc00
    s_add_u32 s50, s88, 0xb400
    buffer_load_dwordx4 v13, s[16:19], s50 offen lds
    s_waitcnt lgkmcnt(12)
    v_mfma_f32_32x32x16_bf16 v[128:143], v[32:35], v[160:163], 0
    ds_read_b64_tr_b16 v[28:29], v3 offset:3392
    ds_read_b64_tr_b16 v[30:31], v3 offset:9536
    s_add_u32 m0, s58, 0xd000
    s_add_u32 s50, s88, 0xb400
    buffer_load_dwordx4 v14, s[16:19], s50 offen lds
    s_waitcnt lgkmcnt(12)
    v_mfma_f32_32x32x16_bf16 v[144:159], v[36:39], v[160:163], 0
    ds_read_b64_tr_b16 v[32:33], v2 offset:12288
    ds_read_b64_tr_b16 v[34:35], v2 offset:18432
    s_add_u32 m0, s58, 0xd400
    s_add_u32 s50, s88, 0xb400
    buffer_load_dwordx4 v15, s[16:19], s50 offen lds
    s_waitcnt lgkmcnt(12)
    v_mfma_f32_32x32x16_bf16 v[64:79], v[40:43], v[164:167], v[64:79]
    ds_read_b64_tr_b16 v[36:37], v3 offset:12352
    ds_read_b64_tr_b16 v[38:39], v3 offset:18496
    s_add_u32 m0, s58, 0x12000
    s_add_u32 s50, s89, 0x9000
    buffer_load_dwordx4 v13, s[16:19], s50 offen lds
    s_add_u32 s50, s91, 32768
    buffer_load_dwordx4 v[160:163], v48, s[20:23], s50 offen sc1
    s_waitcnt lgkmcnt(12)
    v_mfma_f32_32x32x16_bf16 v[80:95], v[44:47], v[164:167], v[80:95]
    ds_read_b64_tr_b16 v[40:41], v2 offset:12416
    ds_read_b64_tr_b16 v[42:43], v2 offset:18560
    s_add_u32 m0, s58, 0x12400
    s_add_u32 s50, s89, 0x9000
    buffer_load_dwordx4 v14, s[16:19], s50 offen lds
    s_waitcnt lgkmcnt(12)
    v_mfma_f32_32x32x16_bf16 v[96:111], v[16:19], v[164:167], v[96:111]
    ds_read_b64_tr_b16 v[44:45], v3 offset:12480
    ds_read_b64_tr_b16 v[46:47], v3 offset:18624
    s_add_u32 m0, s58, 0x12800
    s_add_u32 s50, s89, 0x9000
    buffer_load_dwordx4 v15, s[16:19], s50 offen lds
    s_waitcnt lgkmcnt(12)
    v_mfma_f32_32x32x16_bf16 v[112:127], v[20:23], v[164:167], v[112:127]
    ds_read_b64_tr_b16 v[16:17], v2 offset:12544
    ds_read_b64_tr_b16 v[18:19], v2 offset:18688
    s_add_u32 m0, s58, 0x12c00
    s_add_u32 s50, s89, 0xb400
    buffer_load_dwordx4 v13, s[16:19], s50 offen lds
    s_waitcnt lgkmcnt(12)
    v_mfma_f32_32x32x16_bf16 v[128:143], v[24:27], v[164:167], v[128:143]
    ds_read_b64_tr_b16 v[20:21], v3 offset:12608
    ds_read_b64_tr_b16 v[22:23], v3 offset:18752
    s_add_u32 m0, s58, 0x13000
    s_add_u32 s50, s89, 0xb400
    buffer_load_dwordx4 v14, s[16:19], s50 offen lds
    s_waitcnt lgkmcnt(12)
    v_mfma_f32_32x32x16_bf16 v[144:159], v[28:31], v[164:167], v[144:159]
    ds_read_b64_tr_b16 v[24:25], v2 offset:15360
    ds_read_b64_tr_b16 v[26:27], v2 offset:21504
    s_add_u32 m0, s58, 0x13400
    s_add_u32 s50, s89, 0xb400
    buffer_load_dwordx4 v15, s[16:19], s50 offen lds
    s_waitcnt lgkmcnt(12)
    v_mfma_f32_32x32x16_bf16 v[64:79], v[32:35], v[168:171], v[64:79]
    ds_read_b64_tr_b16 v[28:29], v3 offset:15424
    ds_read_b64_tr_b16 v[30:31], v3 offset:21568
    s_add_u32 s50, s91, 33280
    buffer_load_dwordx4 v[164:167], v48, s[20:23], s50 offen sc1
    s_waitcnt lgkmcnt(12)
    v_mfma_f32_32x32x16_bf16 v[80:95], v[36:39], v[168:171], v[80:95]
    ds_read_b64_tr_b16 v[32:33], v2 offset:15488
    ds_read_b64_tr_b16 v[34:35], v2 offset:21632
    s_waitcnt lgkmcnt(12)
    v_mfma_f32_32x32x16_bf16 v[96:111], v[40:43], v[168:171], v[96:111]
    ds_read_b64_tr_b16 v[36:37], v3 offset:15552
    ds_read_b64_tr_b16 v[38:39], v3 offset:21696
    s_waitcnt lgkmcnt(12)
    v_mfma_f32_32x32x16_bf16 v[112:127], v[44:47], v[168:171], v[112:127]
    ds_read_b64_tr_b16 v[40:41], v2 offset:15616
    ds_read_b64_tr_b16 v[42:43], v2 offset:21760
    s_waitcnt lgkmcnt(12)
    v_mfma_f32_32x32x16_bf16 v[128:143], v[16:19], v[168:171], v[128:143]
    ds_read_b64_tr_b16 v[44:45], v3 offset:15680
    ds_read_b64_tr_b16 v[46:47], v3 offset:21824
    s_waitcnt lgkmcnt(12)
    v_mfma_f32_32x32x16_bf16 v[144:159], v[20:23], v[168:171], v[144:159]
    ds_read_b64_tr_b16 v[16:17], v2 offset:24576
    ds_read_b64_tr_b16 v[18:19], v2 offset:30720
    s_waitcnt lgkmcnt(12)
    v_mfma_f32_32x32x16_bf16 v[64:79], v[24:27], v[172:175], v[64:79]
    ds_read_b64_tr_b16 v[20:21], v3 offset:24640
    ds_read_b64_tr_b16 v[22:23], v3 offset:30784
    s_add_u32 s50, s92, 32768
    buffer_load_dwordx4 v[168:171], v48, s[20:23], s50 offen sc1
    s_waitcnt lgkmcnt(12)
    v_mfma_f32_32x32x16_bf16 v[80:95], v[28:31], v[172:175], v[80:95]
    ds_read_b64_tr_b16 v[24:25], v2 offset:24704
    ds_read_b64_tr_b16 v[26:27], v2 offset:30848
    s_waitcnt lgkmcnt(12)
    v_mfma_f32_32x32x16_bf16 v[96:111], v[32:35], v[172:175], v[96:111]
    ds_read_b64_tr_b16 v[28:29], v3 offset:24768
    ds_read_b64_tr_b16 v[30:31], v3 offset:30912
    s_waitcnt lgkmcnt(12)
    v_mfma_f32_32x32x16_bf16 v[112:127], v[36:39], v[172:175], v[112:127]
    ds_read_b64_tr_b16 v[32:33], v2 offset:24832
    ds_read_b64_tr_b16 v[34:35], v2 offset:30976
    s_waitcnt lgkmcnt(12)
    v_mfma_f32_32x32x16_bf16 v[128:143], v[40:43], v[172:175], v[128:143]
    ds_read_b64_tr_b16 v[36:37], v3 offset:24896
    ds_read_b64_tr_b16 v[38:39], v3 offset:31040
    s_waitcnt lgkmcnt(12)
    v_mfma_f32_32x32x16_bf16 v[144:159], v[44:47], v[172:175], v[144:159]
    ds_read_b64_tr_b16 v[40:41], v2 offset:27648
    ds_read_b64_tr_b16 v[42:43], v2 offset:33792
    s_waitcnt vmcnt(24)
    s_barrier
    s_waitcnt lgkmcnt(12)
    v_mfma_f32_32x32x16_bf16 v[64:79], v[16:19], v[176:179], v[64:79]
    ds_read_b64_tr_b16 v[44:45], v3 offset:27712
    ds_read_b64_tr_b16 v[46:47], v3 offset:33856
    s_add_u32 m0, s58, 0x18000
    s_add_u32 s50, s90, 0x9000
    buffer_load_dwordx4 v13, s[16:19], s50 offen lds
    s_add_u32 s50, s92, 33280
    buffer_load_dwordx4 v[172:175], v48, s[20:23], s50 offen sc1
    s_waitcnt lgkmcnt(12)
    v_mfma_f32_32x32x16_bf16 v[80:95], v[20:23], v[176:179], v[80:95]
    ds_read_b64_tr_b16 v[16:17], v2 offset:27776
    ds_read_b64_tr_b16 v[18:19], v2 offset:33920
    s_add_u32 m0, s58, 0x18400
    s_add_u32 s50, s90, 0x9000
    buffer_load_dwordx4 v14, s[16:19], s50 offen lds
    s_waitcnt lgkmcnt(12)
    v_mfma_f32_32x32x16_bf16 v[96:111], v[24:27], v[176:179], v[96:111]
    ds_read_b64_tr_b16 v[20:21], v3 offset:27840
    ds_read_b64_tr_b16 v[22:23], v3 offset:33984
    s_add_u32 m0, s58, 0x18800
    s_add_u32 s50, s90, 0x9000
    buffer_load_dwordx4 v15, s[16:19], s50 offen lds
    s_waitcnt lgkmcnt(12)
    v_mfma_f32_32x32x16_bf16 v[112:127], v[28:31], v[176:179], v[112:127]
    ds_read_b64_tr_b16 v[24:25], v2 offset:27904
    ds_read_b64_tr_b16 v[26:27], v2 offset:34048
    s_add_u32 m0, s58, 0x18c00
    s_add_u32 s50, s90, 0xb400
    buffer_load_dwordx4 v13, s[16:19], s50 offen lds
    s_waitcnt lgkmcnt(12)
    v_mfma_f32_32x32x16_bf16 v[128:143], v[32:35], v[176:179], v[128:143]
    ds_read_b64_tr_b16 v[28:29], v3 offset:27968
    ds_read_b64_tr_b16 v[30:31], v3 offset:34112
    s_add_u32 m0, s58, 0x19000
    s_add_u32 s50, s90, 0xb400
    buffer_load_dwordx4 v14, s[16:19], s50 offen lds
    s_waitcnt lgkmcnt(12)
    v_mfma_f32_32x32x16_bf16 v[144:159], v[36:39], v[176:179], v[144:159]
    ds_read_b64_tr_b16 v[32:33], v2 offset:36864
    ds_read_b64_tr_b16 v[34:35], v2 offset:43008
    s_add_u32 m0, s58, 0x19400
    s_add_u32 s50, s90, 0xb400
    buffer_load_dwordx4 v15, s[16:19], s50 offen lds
    s_waitcnt lgkmcnt(12)
    v_mfma_f32_32x32x16_bf16 v[64:79], v[40:43], v[180:183], v[64:79]
    ds_read_b64_tr_b16 v[36:37], v3 offset:36928
    ds_read_b64_tr_b16 v[38:39], v3 offset:43072
    s_add_u32 m0, s58, 0x0
    s_add_u32 s50, s88, 0x12000
    buffer_load_dwordx4 v13, s[16:19], s50 offen lds
    s_add_u32 s50, s93, 32768
    buffer_load_dwordx4 v[176:179], v48, s[20:23], s50 offen sc1
    s_waitcnt lgkmcnt(12)
    v_mfma_f32_32x32x16_bf16 v[80:95], v[44:47], v[180:183], v[80:95]
    ds_read_b64_tr_b16 v[40:41], v2 offset:36992
    ds_read_b64_tr_b16 v[42:43], v2 offset:43136
    s_add_u32 m0, s58, 0x400
    s_add_u32 s50, s88, 0x12000
    buffer_load_dwordx4 v14, s[16:19], s50 offen lds
    s_waitcnt lgkmcnt(12)
    v_mfma_f32_32x32x16_bf16 v[96:111], v[16:19], v[180:183], v[96:111]
    ds_read_b64_tr_b16 v[44:45], v3 offset:37056
    ds_read_b64_tr_b16 v[46:47], v3 offset:43200
    s_add_u32 m0, s58, 0x800
    s_add_u32 s50, s88, 0x12000
    buffer_load_dwordx4 v15, s[16:19], s50 offen lds
    s_waitcnt lgkmcnt(12)
    v_mfma_f32_32x32x16_bf16 v[112:127], v[20:23], v[180:183], v[112:127]
    ds_read_b64_tr_b16 v[16:17], v2 offset:37120
    ds_read_b64_tr_b16 v[18:19], v2 offset:43264
    s_add_u32 m0, s58, 0xc00
    s_add_u32 s50, s88, 0x14400
    buffer_load_dwordx4 v13, s[16:19], s50 offen lds
    s_waitcnt lgkmcnt(12)
    v_mfma_f32_32x32x16_bf16 v[128:143], v[24:27], v[180:183], v[128:143]
    ds_read_b64_tr_b16 v[20:21], v3 offset:37184
    ds_read_b64_tr_b16 v[22:23], v3 offset:43328
    s_add_u32 m0, s58, 0x1000
    s_add_u32 s50, s88, 0x14400
    buffer_load_dwordx4 v14, s[16:19], s50 offen lds
    s_waitcnt lgkmcnt(12)
    v_mfma_f32_32x32x16_bf16 v[144:159], v[28:31], v[180:183], v[144:159]
    ds_read_b64_tr_b16 v[24:25], v2 offset:39936
    ds_read_b64_tr_b16 v[26:27], v2 offset:46080
    s_add_u32 m0, s58, 0x1400
    s_add_u32 s50, s88, 0x14400
    buffer_load_dwordx4 v15, s[16:19], s50 offen lds
    s_waitcnt lgkmcnt(12)
    v_mfma_f32_32x32x16_bf16 v[64:79], v[32:35], v[184:187], v[64:79]
    ds_read_b64_tr_b16 v[28:29], v3 offset:40000
    ds_read_b64_tr_b16 v[30:31], v3 offset:46144
    s_add_u32 s50, s93, 33280
    buffer_load_dwordx4 v[180:183], v48, s[20:23], s50 offen sc1
    s_waitcnt lgkmcnt(12)
    v_mfma_f32_32x32x16_bf16 v[80:95], v[36:39], v[184:187], v[80:95]
    ds_read_b64_tr_b16 v[32:33], v2 offset:40064
    ds_read_b64_tr_b16 v[34:35], v2 offset:46208
    s_waitcnt lgkmcnt(12)
    v_mfma_f32_32x32x16_bf16 v[96:111], v[40:43], v[184:187], v[96:111]
    ds_read_b64_tr_b16 v[36:37], v3 offset:40128
    ds_read_b64_tr_b16 v[38:39], v3 offset:46272
    s_waitcnt lgkmcnt(12)
    v_mfma_f32_32x32x16_bf16 v[112:127], v[44:47], v[184:187], v[112:127]
    ds_read_b64_tr_b16 v[40:41], v2 offset:40192
    ds_read_b64_tr_b16 v[42:43], v2 offset:46336
    s_waitcnt lgkmcnt(12)
    v_mfma_f32_32x32x16_bf16 v[128:143], v[16:19], v[184:187], v[128:143]
    ds_read_b64_tr_b16 v[44:45], v3 offset:40256
    ds_read_b64_tr_b16 v[46:47], v3 offset:46400
    s_waitcnt lgkmcnt(12)
    v_mfma_f32_32x32x16_bf16 v[144:159], v[20:23], v[184:187], v[144:159]
    ds_read_b64_tr_b16 v[16:17], v6 offset:24576
    ds_read_b64_tr_b16 v[18:19], v6 offset:30720
    s_waitcnt lgkmcnt(12)
    v_mfma_f32_32x32x16_bf16 v[64:79], v[24:27], v[188:191], v[64:79]
    ds_read_b64_tr_b16 v[20:21], v0 offset:24640
    ds_read_b64_tr_b16 v[22:23], v0 offset:30784
    s_add_u32 s50, s94, 32768
    buffer_load_dwordx4 v[184:187], v48, s[20:23], s50 offen sc1
    s_waitcnt lgkmcnt(12)
    v_mfma_f32_32x32x16_bf16 v[80:95], v[28:31], v[188:191], v[80:95]
    ds_read_b64_tr_b16 v[24:25], v6 offset:24704
    ds_read_b64_tr_b16 v[26:27], v6 offset:30848
    s_waitcnt lgkmcnt(12)
    v_mfma_f32_32x32x16_bf16 v[96:111], v[32:35], v[188:191], v[96:111]
    ds_read_b64_tr_b16 v[28:29], v0 offset:24768
    ds_read_b64_tr_b16 v[30:31], v0 offset:30912
    s_waitcnt lgkmcnt(12)
    v_mfma_f32_32x32x16_bf16 v[112:127], v[36:39], v[188:191], v[112:127]
    ds_read_b64_tr_b16 v[32:33], v6 offset:24832
    ds_read_b64_tr_b16 v[34:35], v6 offset:30976
    s_waitcnt lgkmcnt(12)
    v_mfma_f32_32x32x16_bf16 v[128:143], v[40:43], v[188:191], v[128:143]
    ds_read_b64_tr_b16 v[36:37], v0 offset:24896
    ds_read_b64_tr_b16 v[38:39], v0 offset:31040
    s_waitcnt lgkmcnt(12)
    v_mfma_f32_32x32x16_bf16 v[144:159], v[44:47], v[188:191], v[144:159]
    ds_read_b64_tr_b16 v[40:41], v6 offset:27648
    ds_read_b64_tr_b16 v[42:43], v6 offset:33792
    s_waitcnt vmcnt(25)
    s_barrier
    s_waitcnt lgkmcnt(12)
    v_mfma_f32_32x32x16_bf16 v[64:79], v[16:19], v[192:195], v[64:79]
    ds_read_b64_tr_b16 v[44:45], v0 offset:27712
    ds_read_b64_tr_b16 v[46:47], v0 offset:33856
    s_add_u32 s50, s94, 33280
    buffer_load_dwordx4 v[188:191], v48, s[20:23], s50 offen sc1
    s_waitcnt lgkmcnt(12)
    v_mfma_f32_32x32x16_bf16 v[80:95], v[20:23], v[192:195], v[80:95]
    ds_read_b64_tr_b16 v[16:17], v6 offset:27776
    ds_read_b64_tr_b16 v[18:19], v6 offset:33920
    s_waitcnt lgkmcnt(12)
    v_mfma_f32_32x32x16_bf16 v[96:111], v[24:27], v[192:195], v[96:111]
    ds_read_b64_tr_b16 v[20:21], v0 offset:27840
    ds_read_b64_tr_b16 v[22:23], v0 offset:33984
    s_waitcnt lgkmcnt(12)
    v_mfma_f32_32x32x16_bf16 v[112:127], v[28:31], v[192:195], v[112:127]
    ds_read_b64_tr_b16 v[24:25], v6 offset:27904
    ds_read_b64_tr_b16 v[26:27], v6 offset:34048
    s_waitcnt lgkmcnt(12)
    v_mfma_f32_32x32x16_bf16 v[128:143], v[32:35], v[192:195], v[128:143]
    ds_read_b64_tr_b16 v[28:29], v0 offset:27968
    ds_read_b64_tr_b16 v[30:31], v0 offset:34112
    s_waitcnt lgkmcnt(12)
    v_mfma_f32_32x32x16_bf16 v[144:159], v[36:39], v[192:195], v[144:159]
    ds_read_b64_tr_b16 v[32:33], v6 offset:36864
    ds_read_b64_tr_b16 v[34:35], v6 offset:43008
    s_waitcnt lgkmcnt(12)
    v_mfma_f32_32x32x16_bf16 v[64:79], v[40:43], v[196:199], v[64:79]
    ds_read_b64_tr_b16 v[36:37], v0 offset:36928
    ds_read_b64_tr_b16 v[38:39], v0 offset:43072
    s_add_u32 s50, s95, 32768
    buffer_load_dwordx4 v[192:195], v48, s[20:23], s50 offen sc1
    s_waitcnt lgkmcnt(12)
    v_mfma_f32_32x32x16_bf16 v[80:95], v[44:47], v[196:199], v[80:95]
    ds_read_b64_tr_b16 v[40:41], v6 offset:36992
    ds_read_b64_tr_b16 v[42:43], v6 offset:43136
    s_waitcnt lgkmcnt(12)
    v_mfma_f32_32x32x16_bf16 v[96:111], v[16:19], v[196:199], v[96:111]
    ds_read_b64_tr_b16 v[44:45], v0 offset:37056
    ds_read_b64_tr_b16 v[46:47], v0 offset:43200
    s_waitcnt lgkmcnt(12)
    v_mfma_f32_32x32x16_bf16 v[112:127], v[20:23], v[196:199], v[112:127]
    ds_read_b64_tr_b16 v[16:17], v6 offset:37120
    ds_read_b64_tr_b16 v[18:19], v6 offset:43264
    s_waitcnt lgkmcnt(12)
    v_mfma_f32_32x32x16_bf16 v[128:143], v[24:27], v[196:199], v[128:143]
    ds_read_b64_tr_b16 v[20:21], v0 offset:37184
    ds_read_b64_tr_b16 v[22:23], v0 offset:43328
    s_waitcnt lgkmcnt(12)
    v_mfma_f32_32x32x16_bf16 v[144:159], v[28:31], v[196:199], v[144:159]
    ds_read_b64_tr_b16 v[24:25], v6 offset:39936
    ds_read_b64_tr_b16 v[26:27], v6 offset:46080
    s_waitcnt lgkmcnt(12)
    v_mfma_f32_32x32x16_bf16 v[64:79], v[32:35], v[200:203], v[64:79]
    ds_read_b64_tr_b16 v[28:29], v0 offset:40000
    ds_read_b64_tr_b16 v[30:31], v0 offset:46144
    s_add_u32 s50, s95, 33280
    buffer_load_dwordx4 v[196:199], v48, s[20:23], s50 offen sc1
    s_waitcnt lgkmcnt(12)
    v_mfma_f32_32x32x16_bf16 v[80:95], v[36:39], v[200:203], v[80:95]
    ds_read_b64_tr_b16 v[32:33], v6 offset:40064
    ds_read_b64_tr_b16 v[34:35], v6 offset:46208
    s_waitcnt lgkmcnt(12)
    v_mfma_f32_32x32x16_bf16 v[96:111], v[40:43], v[200:203], v[96:111]
    ds_read_b64_tr_b16 v[36:37], v0 offset:40128
    ds_read_b64_tr_b16 v[38:39], v0 offset:46272
    s_waitcnt lgkmcnt(12)
    v_mfma_f32_32x32x16_bf16 v[112:127], v[44:47], v[200:203], v[112:127]
    ds_read_b64_tr_b16 v[40:41], v6 offset:40192
    ds_read_b64_tr_b16 v[42:43], v6 offset:46336
    s_waitcnt lgkmcnt(12)
    v_mfma_f32_32x32x16_bf16 v[128:143], v[16:19], v[200:203], v[128:143]
    ds_read_b64_tr_b16 v[44:45], v0 offset:40256
    ds_read_b64_tr_b16 v[46:47], v0 offset:46400
    s_waitcnt lgkmcnt(12)
    v_mfma_f32_32x32x16_bf16 v[144:159], v[20:23], v[200:203], v[144:159]
    ds_read_b64_tr_b16 v[16:17], v4 offset:0
    ds_read_b64_tr_b16 v[18:19], v4 offset:6144
    s_waitcnt lgkmcnt(12)
    v_mfma_f32_32x32x16_bf16 v[64:79], v[24:27], v[204:207], v[64:79]
    ds_read_b64_tr_b16 v[20:21], v5 offset:64
    ds_read_b64_tr_b16 v[22:23], v5 offset:6208
    s_add_u32 s50, s96, 32768
    buffer_load_dwordx4 v[200:203], v48, s[20:23], s50 offen sc1
    s_waitcnt lgkmcnt(12)
    v_mfma_f32_32x32x16_bf16 v[80:95], v[28:31], v[204:207], v[80:95]
    ds_read_b64_tr_b16 v[24:25], v4 offset:128
    ds_read_b64_tr_b16 v[26:27], v4 offset:6272
    s_waitcnt lgkmcnt(12)
    v_mfma_f32_32x32x16_bf16 v[96:111], v[32:35], v[204:207], v[96:111]
    ds_read_b64_tr_b16 v[28:29], v5 offset:192
    ds_read_b64_tr_b16 v[30:31], v5 offset:6336
    s_waitcnt lgkmcnt(12)
    v_mfma_f32_32x32x16_bf16 v[112:127], v[36:39], v[204:207], v[112:127]
    ds_read_b64_tr_b16 v[32:33], v4 offset:256
    ds_read_b64_tr_b16 v[34:35], v4 offset:6400
    s_waitcnt lgkmcnt(12)
    v_mfma_f32_32x32x16_bf16 v[128:143], v[40:43], v[204:207], v[128:143]
    ds_read_b64_tr_b16 v[36:37], v5 offset:320
    ds_read_b64_tr_b16 v[38:39], v5 offset:6464
    s_waitcnt lgkmcnt(12)
    v_mfma_f32_32x32x16_bf16 v[144:159], v[44:47], v[204:207], v[144:159]
    ds_read_b64_tr_b16 v[40:41], v4 offset:3072
    ds_read_b64_tr_b16 v[42:43], v4 offset:9216
    s_waitcnt vmcnt(22)
    s_barrier
    s_waitcnt lgkmcnt(12)
    v_mfma_f32_32x32x16_bf16 v[64:79], v[16:19], v[208:211], v[64:79]
    ds_read_b64_tr_b16 v[44:45], v5 offset:3136
    ds_read_b64_tr_b16 v[46:47], v5 offset:9280
    s_add_u32 s50, s96, 33280
    buffer_load_dwordx4 v[204:207], v48, s[20:23], s50 offen sc1
    s_waitcnt lgkmcnt(12)
    v_mfma_f32_32x32x16_bf16 v[80:95], v[20:23], v[208:211], v[80:95]
    ds_read_b64_tr_b16 v[16:17], v4 offset:3200
    ds_read_b64_tr_b16 v[18:19], v4 offset:9344
    s_waitcnt lgkmcnt(12)
    v_mfma_f32_32x32x16_bf16 v[96:111], v[24:27], v[208:211], v[96:111]
    ds_read_b64_tr_b16 v[20:21], v5 offset:3264
    ds_read_b64_tr_b16 v[22:23], v5 offset:9408
    s_waitcnt lgkmcnt(12)
    v_mfma_f32_32x32x16_bf16 v[112:127], v[28:31], v[208:211], v[112:127]
    ds_read_b64_tr_b16 v[24:25], v4 offset:3328
    ds_read_b64_tr_b16 v[26:27], v4 offset:9472
    s_waitcnt lgkmcnt(12)
    v_mfma_f32_32x32x16_bf16 v[128:143], v[32:35], v[208:211], v[128:143]
    ds_read_b64_tr_b16 v[28:29], v5 offset:3392
    ds_read_b64_tr_b16 v[30:31], v5 offset:9536
    s_waitcnt lgkmcnt(12)
    v_mfma_f32_32x32x16_bf16 v[144:159], v[36:39], v[208:211], v[144:159]
    ds_read_b64_tr_b16 v[32:33], v4 offset:12288
    ds_read_b64_tr_b16 v[34:35], v4 offset:18432
    s_waitcnt lgkmcnt(12)
    v_mfma_f32_32x32x16_bf16 v[64:79], v[40:43], v[212:215], v[64:79]
    ds_read_b64_tr_b16 v[36:37], v5 offset:12352
    ds_read_b64_tr_b16 v[38:39], v5 offset:18496
    s_waitcnt lgkmcnt(12)
    v_mfma_f32_32x32x16_bf16 v[80:95], v[44:47], v[212:215], v[80:95]
    ds_read_b64_tr_b16 v[40:41], v4 offset:12416
    ds_read_b64_tr_b16 v[42:43], v4 offset:18560
    s_waitcnt lgkmcnt(12)
    v_mfma_f32_32x32x16_bf16 v[96:111], v[16:19], v[212:215], v[96:111]
    ds_read_b64_tr_b16 v[44:45], v5 offset:12480
    ds_read_b64_tr_b16 v[46:47], v5 offset:18624
    s_waitcnt lgkmcnt(12)
    v_mfma_f32_32x32x16_bf16 v[112:127], v[20:23], v[212:215], v[112:127]
    ds_read_b64_tr_b16 v[16:17], v4 offset:12544
    ds_read_b64_tr_b16 v[18:19], v4 offset:18688
    s_waitcnt lgkmcnt(12)
    v_mfma_f32_32x32x16_bf16 v[128:143], v[24:27], v[212:215], v[128:143]
    ds_read_b64_tr_b16 v[20:21], v5 offset:12608
    ds_read_b64_tr_b16 v[22:23], v5 offset:18752
    s_waitcnt lgkmcnt(12)
    v_mfma_f32_32x32x16_bf16 v[144:159], v[28:31], v[212:215], v[144:159]
    ds_read_b64_tr_b16 v[24:25], v4 offset:15360
    ds_read_b64_tr_b16 v[26:27], v4 offset:21504
    s_waitcnt lgkmcnt(12)
    v_mfma_f32_32x32x16_bf16 v[64:79], v[32:35], v[216:219], v[64:79]
    ds_read_b64_tr_b16 v[28:29], v5 offset:15424
    ds_read_b64_tr_b16 v[30:31], v5 offset:21568
    s_waitcnt lgkmcnt(12)
    v_mfma_f32_32x32x16_bf16 v[80:95], v[36:39], v[216:219], v[80:95]
    ds_read_b64_tr_b16 v[32:33], v4 offset:15488
    ds_read_b64_tr_b16 v[34:35], v4 offset:21632
    s_waitcnt lgkmcnt(12)
    v_mfma_f32_32x32x16_bf16 v[96:111], v[40:43], v[216:219], v[96:111]
    ds_read_b64_tr_b16 v[36:37], v5 offset:15552
    ds_read_b64_tr_b16 v[38:39], v5 offset:21696
    s_waitcnt lgkmcnt(12)
    v_mfma_f32_32x32x16_bf16 v[112:127], v[44:47], v[216:219], v[112:127]
    ds_read_b64_tr_b16 v[40:41], v4 offset:15616
    ds_read_b64_tr_b16 v[42:43], v4 offset:21760
    s_waitcnt lgkmcnt(12)
    v_mfma_f32_32x32x16_bf16 v[128:143], v[16:19], v[216:219], v[128:143]
    ds_read_b64_tr_b16 v[44:45], v5 offset:15680
    ds_read_b64_tr_b16 v[46:47], v5 offset:21824
    s_waitcnt lgkmcnt(12)
    v_mfma_f32_32x32x16_bf16 v[144:159], v[20:23], v[216:219], v[144:159]
    ds_read_b64_tr_b16 v[16:17], v4 offset:24576
    ds_read_b64_tr_b16 v[18:19], v4 offset:30720
    s_waitcnt lgkmcnt(12)
    v_mfma_f32_32x32x16_bf16 v[64:79], v[24:27], v[220:223], v[64:79]
    ds_read_b64_tr_b16 v[20:21], v5 offset:24640
    ds_read_b64_tr_b16 v[22:23], v5 offset:30784
    s_waitcnt lgkmcnt(12)
    v_mfma_f32_32x32x16_bf16 v[80:95], v[28:31], v[220:223], v[80:95]
    ds_read_b64_tr_b16 v[24:25], v4 offset:24704
    ds_read_b64_tr_b16 v[26:27], v4 offset:30848
    s_waitcnt lgkmcnt(12)
    v_mfma_f32_32x32x16_bf16 v[96:111], v[32:35], v[220:223], v[96:111]
    ds_read_b64_tr_b16 v[28:29], v5 offset:24768
    ds_read_b64_tr_b16 v[30:31], v5 offset:30912
    s_waitcnt lgkmcnt(12)
    v_mfma_f32_32x32x16_bf16 v[112:127], v[36:39], v[220:223], v[112:127]
    ds_read_b64_tr_b16 v[32:33], v4 offset:24832
    ds_read_b64_tr_b16 v[34:35], v4 offset:30976
    s_waitcnt lgkmcnt(12)
    v_mfma_f32_32x32x16_bf16 v[128:143], v[40:43], v[220:223], v[128:143]
    ds_read_b64_tr_b16 v[36:37], v5 offset:24896
    ds_read_b64_tr_b16 v[38:39], v5 offset:31040
    s_waitcnt lgkmcnt(12)
    v_mfma_f32_32x32x16_bf16 v[144:159], v[44:47], v[220:223], v[144:159]
    ds_read_b64_tr_b16 v[40:41], v4 offset:27648
    ds_read_b64_tr_b16 v[42:43], v4 offset:33792
    s_waitcnt vmcnt(14)
    s_barrier
    s_waitcnt lgkmcnt(12)
    v_mfma_f32_32x32x16_bf16 v[64:79], v[16:19], v[224:227], v[64:79]
    ds_read_b64_tr_b16 v[44:45], v5 offset:27712
    ds_read_b64_tr_b16 v[46:47], v5 offset:33856
    s_waitcnt lgkmcnt(12)
    v_mfma_f32_32x32x16_bf16 v[80:95], v[20:23], v[224:227], v[80:95]
    ds_read_b64_tr_b16 v[16:17], v4 offset:27776
    ds_read_b64_tr_b16 v[18:19], v4 offset:33920
    s_waitcnt lgkmcnt(12)
    v_mfma_f32_32x32x16_bf16 v[96:111], v[24:27], v[224:227], v[96:111]
    ds_read_b64_tr_b16 v[20:21], v5 offset:27840
    ds_read_b64_tr_b16 v[22:23], v5 offset:33984
    s_waitcnt lgkmcnt(12)
    v_mfma_f32_32x32x16_bf16 v[112:127], v[28:31], v[224:227], v[112:127]
    ds_read_b64_tr_b16 v[24:25], v4 offset:27904
    ds_read_b64_tr_b16 v[26:27], v4 offset:34048
    s_waitcnt lgkmcnt(12)
    v_mfma_f32_32x32x16_bf16 v[128:143], v[32:35], v[224:227], v[128:143]
    ds_read_b64_tr_b16 v[28:29], v5 offset:27968
    ds_read_b64_tr_b16 v[30:31], v5 offset:34112
    s_waitcnt lgkmcnt(12)
    v_mfma_f32_32x32x16_bf16 v[144:159], v[36:39], v[224:227], v[144:159]
    ds_read_b64_tr_b16 v[32:33], v4 offset:36864
    ds_read_b64_tr_b16 v[34:35], v4 offset:43008
    s_waitcnt lgkmcnt(12)
    v_mfma_f32_32x32x16_bf16 v[64:79], v[40:43], v[228:231], v[64:79]
    ds_read_b64_tr_b16 v[36:37], v5 offset:36928
    ds_read_b64_tr_b16 v[38:39], v5 offset:43072
    s_waitcnt lgkmcnt(12)
    v_mfma_f32_32x32x16_bf16 v[80:95], v[44:47], v[228:231], v[80:95]
    ds_read_b64_tr_b16 v[40:41], v4 offset:36992
    ds_read_b64_tr_b16 v[42:43], v4 offset:43136
    s_waitcnt lgkmcnt(12)
    v_mfma_f32_32x32x16_bf16 v[96:111], v[16:19], v[228:231], v[96:111]
    ds_read_b64_tr_b16 v[44:45], v5 offset:37056
    ds_read_b64_tr_b16 v[46:47], v5 offset:43200
    s_waitcnt lgkmcnt(12)
    v_mfma_f32_32x32x16_bf16 v[112:127], v[20:23], v[228:231], v[112:127]
    ds_read_b64_tr_b16 v[16:17], v4 offset:37120
    ds_read_b64_tr_b16 v[18:19], v4 offset:43264
    s_waitcnt lgkmcnt(12)
    v_mfma_f32_32x32x16_bf16 v[128:143], v[24:27], v[228:231], v[128:143]
    ds_read_b64_tr_b16 v[20:21], v5 offset:37184
    ds_read_b64_tr_b16 v[22:23], v5 offset:43328
    s_waitcnt lgkmcnt(12)
    v_mfma_f32_32x32x16_bf16 v[144:159], v[28:31], v[228:231], v[144:159]
    ds_read_b64_tr_b16 v[24:25], v4 offset:39936
    ds_read_b64_tr_b16 v[26:27], v4 offset:46080
    s_waitcnt lgkmcnt(12)
    v_mfma_f32_32x32x16_bf16 v[64:79], v[32:35], v[232:235], v[64:79]
    ds_read_b64_tr_b16 v[28:29], v5 offset:40000
    ds_read_b64_tr_b16 v[30:31], v5 offset:46144
    s_waitcnt lgkmcnt(12)
    v_mfma_f32_32x32x16_bf16 v[80:95], v[36:39], v[232:235], v[80:95]
    ds_read_b64_tr_b16 v[32:33], v4 offset:40064
    ds_read_b64_tr_b16 v[34:35], v4 offset:46208
    s_waitcnt lgkmcnt(12)
    v_mfma_f32_32x32x16_bf16 v[96:111], v[40:43], v[232:235], v[96:111]
    ds_read_b64_tr_b16 v[36:37], v5 offset:40128
    ds_read_b64_tr_b16 v[38:39], v5 offset:46272
    s_waitcnt lgkmcnt(12)
    v_mfma_f32_32x32x16_bf16 v[112:127], v[44:47], v[232:235], v[112:127]
    ds_read_b64_tr_b16 v[40:41], v4 offset:40192
    ds_read_b64_tr_b16 v[42:43], v4 offset:46336
    s_waitcnt lgkmcnt(12)
    v_mfma_f32_32x32x16_bf16 v[128:143], v[16:19], v[232:235], v[128:143]
    ds_read_b64_tr_b16 v[44:45], v5 offset:40256
    ds_read_b64_tr_b16 v[46:47], v5 offset:46400
    s_waitcnt lgkmcnt(12)
    v_mfma_f32_32x32x16_bf16 v[144:159], v[20:23], v[232:235], v[144:159]
    ds_read_b64_tr_b16 v[16:17], v6 offset:0
    ds_read_b64_tr_b16 v[18:19], v6 offset:6144
    s_waitcnt lgkmcnt(12)
    v_mfma_f32_32x32x16_bf16 v[64:79], v[24:27], v[236:239], v[64:79]
    ds_read_b64_tr_b16 v[20:21], v0 offset:64
    ds_read_b64_tr_b16 v[22:23], v0 offset:6208
    s_waitcnt lgkmcnt(12)
    v_mfma_f32_32x32x16_bf16 v[80:95], v[28:31], v[236:239], v[80:95]
    ds_read_b64_tr_b16 v[24:25], v6 offset:128
    ds_read_b64_tr_b16 v[26:27], v6 offset:6272
    s_waitcnt lgkmcnt(12)
    v_mfma_f32_32x32x16_bf16 v[96:111], v[32:35], v[236:239], v[96:111]
    ds_read_b64_tr_b16 v[28:29], v0 offset:192
    ds_read_b64_tr_b16 v[30:31], v0 offset:6336
    s_waitcnt lgkmcnt(12)
    v_mfma_f32_32x32x16_bf16 v[112:127], v[36:39], v[236:239], v[112:127]
    ds_read_b64_tr_b16 v[32:33], v6 offset:256
    ds_read_b64_tr_b16 v[34:35], v6 offset:6400
    s_waitcnt lgkmcnt(12)
    v_mfma_f32_32x32x16_bf16 v[128:143], v[40:43], v[236:239], v[128:143]
    ds_read_b64_tr_b16 v[36:37], v0 offset:320
    ds_read_b64_tr_b16 v[38:39], v0 offset:6464
    s_waitcnt lgkmcnt(12)
    v_mfma_f32_32x32x16_bf16 v[144:159], v[44:47], v[236:239], v[144:159]
    ds_read_b64_tr_b16 v[40:41], v6 offset:3072
    ds_read_b64_tr_b16 v[42:43], v6 offset:9216
    s_waitcnt vmcnt(7)
    s_barrier
    s_waitcnt lgkmcnt(12)
    v_mfma_f32_32x32x16_bf16 v[64:79], v[16:19], v[240:243], v[64:79]
    ds_read_b64_tr_b16 v[44:45], v0 offset:3136
    ds_read_b64_tr_b16 v[46:47], v0 offset:9280
    s_waitcnt lgkmcnt(12)
    v_mfma_f32_32x32x16_bf16 v[80:95], v[20:23], v[240:243], v[80:95]
    ds_read_b64_tr_b16 v[16:17], v6 offset:3200
    ds_read_b64_tr_b16 v[18:19], v6 offset:9344
    s_waitcnt lgkmcnt(12)
    v_mfma_f32_32x32x16_bf16 v[96:111], v[24:27], v[240:243], v[96:111]
    ds_read_b64_tr_b16 v[20:21], v0 offset:3264
    ds_read_b64_tr_b16 v[22:23], v0 offset:9408
    s_waitcnt lgkmcnt(12)
    v_mfma_f32_32x32x16_bf16 v[112:127], v[28:31], v[240:243], v[112:127]
    ds_read_b64_tr_b16 v[24:25], v6 offset:3328
    ds_read_b64_tr_b16 v[26:27], v6 offset:9472
    s_waitcnt lgkmcnt(12)
    v_mfma_f32_32x32x16_bf16 v[128:143], v[32:35], v[240:243], v[128:143]
    ds_read_b64_tr_b16 v[28:29], v0 offset:3392
    ds_read_b64_tr_b16 v[30:31], v0 offset:9536
    s_waitcnt lgkmcnt(12)
    v_mfma_f32_32x32x16_bf16 v[144:159], v[36:39], v[240:243], v[144:159]
    ds_read_b64_tr_b16 v[32:33], v6 offset:12288
    ds_read_b64_tr_b16 v[34:35], v6 offset:18432
    s_waitcnt lgkmcnt(12)
    v_mfma_f32_32x32x16_bf16 v[64:79], v[40:43], v[244:247], v[64:79]
    ds_read_b64_tr_b16 v[36:37], v0 offset:12352
    ds_read_b64_tr_b16 v[38:39], v0 offset:18496
    s_waitcnt lgkmcnt(12)
    v_mfma_f32_32x32x16_bf16 v[80:95], v[44:47], v[244:247], v[80:95]
    ds_read_b64_tr_b16 v[40:41], v6 offset:12416
    ds_read_b64_tr_b16 v[42:43], v6 offset:18560
    s_waitcnt lgkmcnt(12)
    v_mfma_f32_32x32x16_bf16 v[96:111], v[16:19], v[244:247], v[96:111]
    ds_read_b64_tr_b16 v[44:45], v0 offset:12480
    ds_read_b64_tr_b16 v[46:47], v0 offset:18624
    s_waitcnt lgkmcnt(12)
    v_mfma_f32_32x32x16_bf16 v[112:127], v[20:23], v[244:247], v[112:127]
    ds_read_b64_tr_b16 v[16:17], v6 offset:12544
    ds_read_b64_tr_b16 v[18:19], v6 offset:18688
    s_waitcnt lgkmcnt(12)
    v_mfma_f32_32x32x16_bf16 v[128:143], v[24:27], v[244:247], v[128:143]
    ds_read_b64_tr_b16 v[20:21], v0 offset:12608
    ds_read_b64_tr_b16 v[22:23], v0 offset:18752
    s_waitcnt lgkmcnt(12)
    v_mfma_f32_32x32x16_bf16 v[144:159], v[28:31], v[244:247], v[144:159]
    ds_read_b64_tr_b16 v[24:25], v6 offset:15360
    ds_read_b64_tr_b16 v[26:27], v6 offset:21504
    s_waitcnt lgkmcnt(12)
    v_mfma_f32_32x32x16_bf16 v[64:79], v[32:35], v[248:251], v[64:79]
    ds_read_b64_tr_b16 v[28:29], v0 offset:15424
    ds_read_b64_tr_b16 v[30:31], v0 offset:21568
    s_waitcnt lgkmcnt(12)
    v_mfma_f32_32x32x16_bf16 v[80:95], v[36:39], v[248:251], v[80:95]
    ds_read_b64_tr_b16 v[32:33], v6 offset:15488
    ds_read_b64_tr_b16 v[34:35], v6 offset:21632
    s_waitcnt lgkmcnt(12)
    v_mfma_f32_32x32x16_bf16 v[96:111], v[40:43], v[248:251], v[96:111]
    ds_read_b64_tr_b16 v[36:37], v0 offset:15552
    ds_read_b64_tr_b16 v[38:39], v0 offset:21696
    s_waitcnt lgkmcnt(12)
    v_mfma_f32_32x32x16_bf16 v[112:127], v[44:47], v[248:251], v[112:127]
    ds_read_b64_tr_b16 v[40:41], v6 offset:15616
    ds_read_b64_tr_b16 v[42:43], v6 offset:21760
    s_waitcnt lgkmcnt(12)
    v_mfma_f32_32x32x16_bf16 v[128:143], v[16:19], v[248:251], v[128:143]
    ds_read_b64_tr_b16 v[44:45], v0 offset:15680
    ds_read_b64_tr_b16 v[46:47], v0 offset:21824
    s_waitcnt lgkmcnt(12)
    v_mfma_f32_32x32x16_bf16 v[144:159], v[20:23], v[248:251], v[144:159]
    ds_read_b64_tr_b16 v[16:17], v2 offset:0
    ds_read_b64_tr_b16 v[18:19], v2 offset:6144
    s_waitcnt lgkmcnt(12)
    v_mfma_f32_32x32x16_bf16 v[64:79], v[24:27], v[252:255], v[64:79]
    ds_read_b64_tr_b16 v[20:21], v3 offset:64
    ds_read_b64_tr_b16 v[22:23], v3 offset:6208
    s_waitcnt lgkmcnt(12)
    v_mfma_f32_32x32x16_bf16 v[80:95], v[28:31], v[252:255], v[80:95]
    ds_read_b64_tr_b16 v[24:25], v2 offset:128
    ds_read_b64_tr_b16 v[26:27], v2 offset:6272
    s_waitcnt lgkmcnt(12)
    v_mfma_f32_32x32x16_bf16 v[96:111], v[32:35], v[252:255], v[96:111]
    ds_read_b64_tr_b16 v[28:29], v3 offset:192
    ds_read_b64_tr_b16 v[30:31], v3 offset:6336
    s_waitcnt lgkmcnt(12)
    v_mfma_f32_32x32x16_bf16 v[112:127], v[36:39], v[252:255], v[112:127]
    ds_read_b64_tr_b16 v[32:33], v2 offset:256
    ds_read_b64_tr_b16 v[34:35], v2 offset:6400
    s_waitcnt lgkmcnt(12)
    v_mfma_f32_32x32x16_bf16 v[128:143], v[40:43], v[252:255], v[128:143]
    ds_read_b64_tr_b16 v[36:37], v3 offset:320
    ds_read_b64_tr_b16 v[38:39], v3 offset:6464
    s_waitcnt lgkmcnt(12)
    v_mfma_f32_32x32x16_bf16 v[144:159], v[44:47], v[252:255], v[144:159]
    ds_read_b64_tr_b16 v[40:41], v2 offset:3072
    ds_read_b64_tr_b16 v[42:43], v2 offset:9216
    s_barrier
    s_waitcnt lgkmcnt(12)
    v_mfma_f32_32x32x16_bf16 v[64:79], v[16:19], v[160:163], v[64:79]
    ds_read_b64_tr_b16 v[44:45], v3 offset:3136
    ds_read_b64_tr_b16 v[46:47], v3 offset:9280
    s_waitcnt lgkmcnt(12)
    v_mfma_f32_32x32x16_bf16 v[80:95], v[20:23], v[160:163], v[80:95]
    ds_read_b64_tr_b16 v[16:17], v2 offset:3200
    ds_read_b64_tr_b16 v[18:19], v2 offset:9344
    s_waitcnt lgkmcnt(12)
    v_mfma_f32_32x32x16_bf16 v[96:111], v[24:27], v[160:163], v[96:111]
    ds_read_b64_tr_b16 v[20:21], v3 offset:3264
    ds_read_b64_tr_b16 v[22:23], v3 offset:9408
    s_waitcnt lgkmcnt(12)
    v_mfma_f32_32x32x16_bf16 v[112:127], v[28:31], v[160:163], v[112:127]
    ds_read_b64_tr_b16 v[24:25], v2 offset:3328
    ds_read_b64_tr_b16 v[26:27], v2 offset:9472
    s_waitcnt lgkmcnt(12)
    v_mfma_f32_32x32x16_bf16 v[128:143], v[32:35], v[160:163], v[128:143]
    ds_read_b64_tr_b16 v[28:29], v3 offset:3392
    ds_read_b64_tr_b16 v[30:31], v3 offset:9536
    s_waitcnt lgkmcnt(12)
    v_mfma_f32_32x32x16_bf16 v[144:159], v[36:39], v[160:163], v[144:159]
    ds_read_b64_tr_b16 v[32:33], v2 offset:12288
    ds_read_b64_tr_b16 v[34:35], v2 offset:18432
    s_add_u32 s4, s98, 1536
    buffer_load_dword v58, v49, s[20:23], s4 offen sc1
    s_waitcnt lgkmcnt(12)
    v_mfma_f32_32x32x16_bf16 v[64:79], v[40:43], v[164:167], v[64:79]
    ds_read_b64_tr_b16 v[36:37], v3 offset:12352
    ds_read_b64_tr_b16 v[38:39], v3 offset:18496
    s_waitcnt lgkmcnt(12)
    v_mfma_f32_32x32x16_bf16 v[80:95], v[44:47], v[164:167], v[80:95]
    ds_read_b64_tr_b16 v[40:41], v2 offset:12416
    ds_read_b64_tr_b16 v[42:43], v2 offset:18560
    s_waitcnt lgkmcnt(12)
    v_mfma_f32_32x32x16_bf16 v[96:111], v[16:19], v[164:167], v[96:111]
    ds_read_b64_tr_b16 v[44:45], v3 offset:12480
    ds_read_b64_tr_b16 v[46:47], v3 offset:18624
    s_waitcnt lgkmcnt(12)
    v_mfma_f32_32x32x16_bf16 v[112:127], v[20:23], v[164:167], v[112:127]
    ds_read_b64_tr_b16 v[16:17], v2 offset:12544
    ds_read_b64_tr_b16 v[18:19], v2 offset:18688
    s_waitcnt lgkmcnt(12)
    v_mfma_f32_32x32x16_bf16 v[128:143], v[24:27], v[164:167], v[128:143]
    ds_read_b64_tr_b16 v[20:21], v3 offset:12608
    ds_read_b64_tr_b16 v[22:23], v3 offset:18752
    s_waitcnt lgkmcnt(12)
    v_mfma_f32_32x32x16_bf16 v[144:159], v[28:31], v[164:167], v[144:159]
    ds_read_b64_tr_b16 v[24:25], v2 offset:15360
    ds_read_b64_tr_b16 v[26:27], v2 offset:21504
    s_waitcnt lgkmcnt(12)
    v_mfma_f32_32x32x16_bf16 v[64:79], v[32:35], v[168:171], v[64:79]
    ds_read_b64_tr_b16 v[28:29], v3 offset:15424
    ds_read_b64_tr_b16 v[30:31], v3 offset:21568
    s_waitcnt lgkmcnt(12)
    v_mfma_f32_32x32x16_bf16 v[80:95], v[36:39], v[168:171], v[80:95]
    ds_read_b64_tr_b16 v[32:33], v2 offset:15488
    ds_read_b64_tr_b16 v[34:35], v2 offset:21632
    s_waitcnt lgkmcnt(12)
    v_mfma_f32_32x32x16_bf16 v[96:111], v[40:43], v[168:171], v[96:111]
    ds_read_b64_tr_b16 v[36:37], v3 offset:15552
    ds_read_b64_tr_b16 v[38:39], v3 offset:21696
    s_waitcnt lgkmcnt(12)
    v_mfma_f32_32x32x16_bf16 v[112:127], v[44:47], v[168:171], v[112:127]
    ds_read_b64_tr_b16 v[40:41], v2 offset:15616
    ds_read_b64_tr_b16 v[42:43], v2 offset:21760
    s_waitcnt lgkmcnt(12)
    v_mfma_f32_32x32x16_bf16 v[128:143], v[16:19], v[168:171], v[128:143]
    ds_read_b64_tr_b16 v[44:45], v3 offset:15680
    ds_read_b64_tr_b16 v[46:47], v3 offset:21824
    s_waitcnt lgkmcnt(12)
    v_mfma_f32_32x32x16_bf16 v[144:159], v[20:23], v[168:171], v[144:159]
    ds_read_b64_tr_b16 v[16:17], v2 offset:24576
    ds_read_b64_tr_b16 v[18:19], v2 offset:30720
    s_waitcnt lgkmcnt(12)
    v_mfma_f32_32x32x16_bf16 v[64:79], v[24:27], v[172:175], v[64:79]
    ds_read_b64_tr_b16 v[20:21], v3 offset:24640
    ds_read_b64_tr_b16 v[22:23], v3 offset:30784
    s_waitcnt lgkmcnt(12)
    v_mfma_f32_32x32x16_bf16 v[80:95], v[28:31], v[172:175], v[80:95]
    ds_read_b64_tr_b16 v[24:25], v2 offset:24704
    ds_read_b64_tr_b16 v[26:27], v2 offset:30848
    s_waitcnt lgkmcnt(12)
    v_mfma_f32_32x32x16_bf16 v[96:111], v[32:35], v[172:175], v[96:111]
    ds_read_b64_tr_b16 v[28:29], v3 offset:24768
    ds_read_b64_tr_b16 v[30:31], v3 offset:30912
    s_waitcnt lgkmcnt(12)
    v_mfma_f32_32x32x16_bf16 v[112:127], v[36:39], v[172:175], v[112:127]
    ds_read_b64_tr_b16 v[32:33], v2 offset:24832
    ds_read_b64_tr_b16 v[34:35], v2 offset:30976
    s_waitcnt lgkmcnt(12)
    v_mfma_f32_32x32x16_bf16 v[128:143], v[40:43], v[172:175], v[128:143]
    ds_read_b64_tr_b16 v[36:37], v3 offset:24896
    ds_read_b64_tr_b16 v[38:39], v3 offset:31040
    s_waitcnt lgkmcnt(12)
    v_mfma_f32_32x32x16_bf16 v[144:159], v[44:47], v[172:175], v[144:159]
    ds_read_b64_tr_b16 v[40:41], v2 offset:27648
    ds_read_b64_tr_b16 v[42:43], v2 offset:33792
    s_barrier
    s_waitcnt lgkmcnt(12)
    v_mfma_f32_32x32x16_bf16 v[64:79], v[16:19], v[176:179], v[64:79]
    ds_read_b64_tr_b16 v[44:45], v3 offset:27712
    ds_read_b64_tr_b16 v[46:47], v3 offset:33856
    s_waitcnt lgkmcnt(12)
    v_mfma_f32_32x32x16_bf16 v[80:95], v[20:23], v[176:179], v[80:95]
    ds_read_b64_tr_b16 v[16:17], v2 offset:27776
    ds_read_b64_tr_b16 v[18:19], v2 offset:33920
    s_waitcnt lgkmcnt(12)
    v_mfma_f32_32x32x16_bf16 v[96:111], v[24:27], v[176:179], v[96:111]
    ds_read_b64_tr_b16 v[20:21], v3 offset:27840
    ds_read_b64_tr_b16 v[22:23], v3 offset:33984
    s_waitcnt lgkmcnt(12)
    v_mfma_f32_32x32x16_bf16 v[112:127], v[28:31], v[176:179], v[112:127]
    ds_read_b64_tr_b16 v[24:25], v2 offset:27904
    ds_read_b64_tr_b16 v[26:27], v2 offset:34048
    s_waitcnt lgkmcnt(12)
    v_mfma_f32_32x32x16_bf16 v[128:143], v[32:35], v[176:179], v[128:143]
    ds_read_b64_tr_b16 v[28:29], v3 offset:27968
    ds_read_b64_tr_b16 v[30:31], v3 offset:34112
    s_waitcnt lgkmcnt(12)
    v_mfma_f32_32x32x16_bf16 v[144:159], v[36:39], v[176:179], v[144:159]
    ds_read_b64_tr_b16 v[32:33], v2 offset:36864
    ds_read_b64_tr_b16 v[34:35], v2 offset:43008
    s_waitcnt vmcnt(7)
    s_waitcnt lgkmcnt(12)
    v_mfma_f32_32x32x16_bf16 v[64:79], v[40:43], v[180:183], v[64:79]
    ds_read_b64_tr_b16 v[36:37], v3 offset:36928
    ds_read_b64_tr_b16 v[38:39], v3 offset:43072
    s_waitcnt lgkmcnt(12)
    v_mfma_f32_32x32x16_bf16 v[80:95], v[44:47], v[180:183], v[80:95]
    ds_read_b64_tr_b16 v[40:41], v2 offset:36992
    ds_read_b64_tr_b16 v[42:43], v2 offset:43136
    s_waitcnt lgkmcnt(12)
    v_mfma_f32_32x32x16_bf16 v[96:111], v[16:19], v[180:183], v[96:111]
    ds_read_b64_tr_b16 v[44:45], v3 offset:37056
    ds_read_b64_tr_b16 v[46:47], v3 offset:43200
    s_waitcnt lgkmcnt(12)
    v_mfma_f32_32x32x16_bf16 v[112:127], v[20:23], v[180:183], v[112:127]
    ds_read_b64_tr_b16 v[16:17], v2 offset:37120
    ds_read_b64_tr_b16 v[18:19], v2 offset:43264
    s_waitcnt lgkmcnt(12)
    v_mfma_f32_32x32x16_bf16 v[128:143], v[24:27], v[180:183], v[128:143]
    ds_read_b64_tr_b16 v[20:21], v3 offset:37184
    ds_read_b64_tr_b16 v[22:23], v3 offset:43328
    s_waitcnt lgkmcnt(12)
    v_mfma_f32_32x32x16_bf16 v[144:159], v[28:31], v[180:183], v[144:159]
    ds_read_b64_tr_b16 v[24:25], v2 offset:39936
    ds_read_b64_tr_b16 v[26:27], v2 offset:46080
    s_waitcnt vmcnt(0)
    s_mov_b32 s100, 0x8000
L_spin_7:
    v_cmp_gt_u32 vcc, 1, v58
    s_and_b32 s50, vcc_lo, 0xfff
    s_cbranch_scc0 L_ok_6
    s_sub_u32 s100, s100, 1
    s_cbranch_scc1 L_ok_6
    s_sleep 1
    buffer_load_dword v58, v49, s[20:23], s4 offen sc1
    s_waitcnt vmcnt(0)
    s_branch L_spin_7
L_ok_6:
    s_waitcnt lgkmcnt(12)
    v_mfma_f32_32x32x16_bf16 v[64:79], v[32:35], v[184:187], v[64:79]
    ds_read_b64_tr_b16 v[28:29], v3 offset:40000
    ds_read_b64_tr_b16 v[30:31], v3 offset:46144
    s_add_u32 s50, s91, 49152
    buffer_load_dwordx4 v[208:211], v48, s[20:23], s50 offen sc1
    s_waitcnt lgkmcnt(12)
    v_mfma_f32_32x32x16_bf16 v[80:95], v[36:39], v[184:187], v[80:95]
    ds_read_b64_tr_b16 v[32:33], v2 offset:40064
    ds_read_b64_tr_b16 v[34:35], v2 offset:46208
    s_waitcnt lgkmcnt(12)
    v_mfma_f32_32x32x16_bf16 v[96:111], v[40:43], v[184:187], v[96:111]
    ds_read_b64_tr_b16 v[36:37], v3 offset:40128
    ds_read_b64_tr_b16 v[38:39], v3 offset:46272
    s_waitcnt lgkmcnt(12)
    v_mfma_f32_32x32x16_bf16 v[112:127], v[44:47], v[184:187], v[112:127]
    ds_read_b64_tr_b16 v[40:41], v2 offset:40192
    ds_read_b64_tr_b16 v[42:43], v2 offset:46336
    s_add_u32 s50, s91, 49664
    buffer_load_dwordx4 v[212:215], v48, s[20:23], s50 offen sc1
    s_waitcnt lgkmcnt(12)
    v_mfma_f32_32x32x16_bf16 v[128:143], v[16:19], v[184:187], v[128:143]
    ds_read_b64_tr_b16 v[44:45], v3 offset:40256
    ds_read_b64_tr_b16 v[46:47], v3 offset:46400
    s_waitcnt lgkmcnt(12)
    v_mfma_f32_32x32x16_bf16 v[144:159], v[20:23], v[184:187], v[144:159]
    ds_read_b64_tr_b16 v[16:17], v6 offset:24576
    ds_read_b64_tr_b16 v[18:19], v6 offset:30720
    s_waitcnt lgkmcnt(12)
    v_mfma_f32_32x32x16_bf16 v[64:79], v[24:27], v[188:191], v[64:79]
    ds_read_b64_tr_b16 v[20:21], v0 offset:24640
    ds_read_b64_tr_b16 v[22:23], v0 offset:30784
    s_add_u32 s50, s92, 49152
    buffer_load_dwordx4 v[216:219], v48, s[20:23], s50 offen sc1
    s_waitcnt lgkmcnt(12)
    v_mfma_f32_32x32x16_bf16 v[80:95], v[28:31], v[188:191], v[80:95]
    ds_read_b64_tr_b16 v[24:25], v6 offset:24704
    ds_read_b64_tr_b16 v[26:27], v6 offset:30848
    s_waitcnt lgkmcnt(12)
    v_mfma_f32_32x32x16_bf16 v[96:111], v[32:35], v[188:191], v[96:111]
    ds_read_b64_tr_b16 v[28:29], v0 offset:24768
    ds_read_b64_tr_b16 v[30:31], v0 offset:30912
    s_waitcnt lgkmcnt(12)
    v_mfma_f32_32x32x16_bf16 v[112:127], v[36:39], v[188:191], v[112:127]
    ds_read_b64_tr_b16 v[32:33], v6 offset:24832
    ds_read_b64_tr_b16 v[34:35], v6 offset:30976
    s_add_u32 s50, s92, 49664
    buffer_load_dwordx4 v[220:223], v48, s[20:23], s50 offen sc1
    s_waitcnt lgkmcnt(12)
    v_mfma_f32_32x32x16_bf16 v[128:143], v[40:43], v[188:191], v[128:143]
    ds_read_b64_tr_b16 v[36:37], v0 offset:24896
    ds_read_b64_tr_b16 v[38:39], v0 offset:31040
    s_waitcnt lgkmcnt(12)
    v_mfma_f32_32x32x16_bf16 v[144:159], v[44:47], v[188:191], v[144:159]
    ds_read_b64_tr_b16 v[40:41], v6 offset:27648
    ds_read_b64_tr_b16 v[42:43], v6 offset:33792
    s_barrier
    s_waitcnt lgkmcnt(12)
    v_mfma_f32_32x32x16_bf16 v[64:79], v[16:19], v[192:195], v[64:79]
    ds_read_b64_tr_b16 v[44:45], v0 offset:27712
    ds_read_b64_tr_b16 v[46:47], v0 offset:33856
    s_add_u32 s50, s93, 49152
    buffer_load_dwordx4 v[224:227], v48, s[20:23], s50 offen sc1
    s_waitcnt lgkmcnt(12)
    v_mfma_f32_32x32x16_bf16 v[80:95], v[20:23], v[192:195], v[80:95]
    ds_read_b64_tr_b16 v[16:17], v6 offset:27776
    ds_read_b64_tr_b16 v[18:19], v6 offset:33920
    s_waitcnt lgkmcnt(12)
    v_mfma_f32_32x32x16_bf16 v[96:111], v[24:27], v[192:195], v[96:111]
    ds_read_b64_tr_b16 v[20:21], v0 offset:27840
    ds_read_b64_tr_b16 v[22:23], v0 offset:33984
    s_waitcnt lgkmcnt(12)
    v_mfma_f32_32x32x16_bf16 v[112:127], v[28:31], v[192:195], v[112:127]
    ds_read_b64_tr_b16 v[24:25], v6 offset:27904
    ds_read_b64_tr_b16 v[26:27], v6 offset:34048
    s_add_u32 s50, s93, 49664
    buffer_load_dwordx4 v[228:231], v48, s[20:23], s50 offen sc1
    s_waitcnt lgkmcnt(12)
    v_mfma_f32_32x32x16_bf16 v[128:143], v[32:35], v[192:195], v[128:143]
    ds_read_b64_tr_b16 v[28:29], v0 offset:27968
    ds_read_b64_tr_b16 v[30:31], v0 offset:34112
    s_waitcnt lgkmcnt(12)
    v_mfma_f32_32x32x16_bf16 v[144:159], v[36:39], v[192:195], v[144:159]
    ds_read_b64_tr_b16 v[32:33], v6 offset:36864
    ds_read_b64_tr_b16 v[34:35], v6 offset:43008
    s_add_u32 s4, s98, 3072
    buffer_load_dword v58, v49, s[20:23], s4 offen sc1
    s_waitcnt lgkmcnt(12)
    v_mfma_f32_32x32x16_bf16 v[64:79], v[40:43], v[196:199], v[64:79]
    ds_read_b64_tr_b16 v[36:37], v0 offset:36928
    ds_read_b64_tr_b16 v[38:39], v0 offset:43072
    s_add_u32 s50, s94, 49152
    buffer_load_dwordx4 v[232:235], v48, s[20:23], s50 offen sc1
    s_waitcnt lgkmcnt(12)
    v_mfma_f32_32x32x16_bf16 v[80:95], v[44:47], v[196:199], v[80:95]
    ds_read_b64_tr_b16 v[40:41], v6 offset:36992
    ds_read_b64_tr_b16 v[42:43], v6 offset:43136
    s_waitcnt lgkmcnt(12)
    v_mfma_f32_32x32x16_bf16 v[96:111], v[16:19], v[196:199], v[96:111]
    ds_read_b64_tr_b16 v[44:45], v0 offset:37056
    ds_read_b64_tr_b16 v[46:47], v0 offset:43200
    s_waitcnt lgkmcnt(12)
    v_mfma_f32_32x32x16_bf16 v[112:127], v[20:23], v[196:199], v[112:127]
    ds_read_b64_tr_b16 v[16:17], v6 offset:37120
    ds_read_b64_tr_b16 v[18:19], v6 offset:43264
    s_add_u32 s50, s94, 49664
    buffer_load_dwordx4 v[236:239], v48, s[20:23], s50 offen sc1
    s_waitcnt lgkmcnt(12)
    v_mfma_f32_32x32x16_bf16 v[128:143], v[24:27], v[196:199], v[128:143]
    ds_read_b64_tr_b16 v[20:21], v0 offset:37184
    ds_read_b64_tr_b16 v[22:23], v0 offset:43328
    s_waitcnt lgkmcnt(12)
    v_mfma_f32_32x32x16_bf16 v[144:159], v[28:31], v[196:199], v[144:159]
    ds_read_b64_tr_b16 v[24:25], v6 offset:39936
    ds_read_b64_tr_b16 v[26:27], v6 offset:46080
    s_waitcnt lgkmcnt(12)
    v_mfma_f32_32x32x16_bf16 v[64:79], v[32:35], v[200:203], v[64:79]
    ds_read_b64_tr_b16 v[28:29], v0 offset:40000
    ds_read_b64_tr_b16 v[30:31], v0 offset:46144
    s_add_u32 s50, s95, 49152
    buffer_load_dwordx4 v[240:243], v48, s[20:23], s50 offen sc1
    s_waitcnt lgkmcnt(12)
    v_mfma_f32_32x32x16_bf16 v[80:95], v[36:39], v[200:203], v[80:95]
    ds_read_b64_tr_b16 v[32:33], v6 offset:40064
    ds_read_b64_tr_b16 v[34:35], v6 offset:46208
    s_waitcnt lgkmcnt(12)
    v_mfma_f32_32x32x16_bf16 v[96:111], v[40:43], v[200:203], v[96:111]
    ds_read_b64_tr_b16 v[36:37], v0 offset:40128
    ds_read_b64_tr_b16 v[38:39], v0 offset:46272
    s_waitcnt lgkmcnt(12)
    v_mfma_f32_32x32x16_bf16 v[112:127], v[44:47], v[200:203], v[112:127]
    ds_read_b64_tr_b16 v[40:41], v6 offset:40192
    ds_read_b64_tr_b16 v[42:43], v6 offset:46336
    s_add_u32 s50, s95, 49664
    buffer_load_dwordx4 v[244:247], v48, s[20:23], s50 offen sc1
    s_waitcnt lgkmcnt(12)
    v_mfma_f32_32x32x16_bf16 v[128:143], v[16:19], v[200:203], v[128:143]
    ds_read_b64_tr_b16 v[44:45], v0 offset:40256
    ds_read_b64_tr_b16 v[46:47], v0 offset:46400
    s_waitcnt lgkmcnt(12)
    v_mfma_f32_32x32x16_bf16 v[144:159], v[20:23], v[200:203], v[144:159]
    ds_read_b64_tr_b16 v[16:17], v4 offset:0
    ds_read_b64_tr_b16 v[18:19], v4 offset:6144
    s_waitcnt lgkmcnt(12)
    v_mfma_f32_32x32x16_bf16 v[64:79], v[24:27], v[204:207], v[64:79]
    ds_read_b64_tr_b16 v[20:21], v5 offset:64
    ds_read_b64_tr_b16 v[22:23], v5 offset:6208
    s_add_u32 s50, s96, 49152
    buffer_load_dwordx4 v[248:251], v48, s[20:23], s50 offen sc1
    s_waitcnt lgkmcnt(12)
    v_mfma_f32_32x32x16_bf16 v[80:95], v[28:31], v[204:207], v[80:95]
    ds_read_b64_tr_b16 v[24:25], v4 offset:128
    ds_read_b64_tr_b16 v[26:27], v4 offset:6272
    s_waitcnt lgkmcnt(12)
    v_mfma_f32_32x32x16_bf16 v[96:111], v[32:35], v[204:207], v[96:111]
    ds_read_b64_tr_b16 v[28:29], v5 offset:192
    ds_read_b64_tr_b16 v[30:31], v5 offset:6336
    s_waitcnt lgkmcnt(12)
    v_mfma_f32_32x32x16_bf16 v[112:127], v[36:39], v[204:207], v[112:127]
    ds_read_b64_tr_b16 v[32:33], v4 offset:256
    ds_read_b64_tr_b16 v[34:35], v4 offset:6400
    s_add_u32 s50, s96, 49664
    buffer_load_dwordx4 v[252:255], v48, s[20:23], s50 offen sc1
    s_waitcnt lgkmcnt(12)
    v_mfma_f32_32x32x16_bf16 v[128:143], v[40:43], v[204:207], v[128:143]
    ds_read_b64_tr_b16 v[36:37], v5 offset:320
    ds_read_b64_tr_b16 v[38:39], v5 offset:6464
    s_waitcnt lgkmcnt(12)
    v_mfma_f32_32x32x16_bf16 v[144:159], v[44:47], v[204:207], v[144:159]
    ds_read_b64_tr_b16 v[40:41], v4 offset:3072
    ds_read_b64_tr_b16 v[42:43], v4 offset:9216
    s_barrier
    s_waitcnt vmcnt(12)
    s_waitcnt lgkmcnt(12)
    v_mfma_f32_32x32x16_bf16 v[64:79], v[16:19], v[208:211], v[64:79]
    ds_read_b64_tr_b16 v[44:45], v5 offset:3136
    ds_read_b64_tr_b16 v[46:47], v5 offset:9280
    s_waitcnt lgkmcnt(12)
    v_mfma_f32_32x32x16_bf16 v[80:95], v[20:23], v[208:211], v[80:95]
    ds_read_b64_tr_b16 v[16:17], v4 offset:3200
    ds_read_b64_tr_b16 v[18:19], v4 offset:9344
    s_waitcnt lgkmcnt(12)
    v_mfma_f32_32x32x16_bf16 v[96:111], v[24:27], v[208:211], v[96:111]
    ds_read_b64_tr_b16 v[20:21], v5 offset:3264
    ds_read_b64_tr_b16 v[22:23], v5 offset:9408
    s_waitcnt lgkmcnt(12)
    v_mfma_f32_32x32x16_bf16 v[112:127], v[28:31], v[208:211], v[112:127]
    ds_read_b64_tr_b16 v[24:25], v4 offset:3328
    ds_read_b64_tr_b16 v[26:27], v4 offset:9472
    s_waitcnt lgkmcnt(12)
    v_mfma_f32_32x32x16_bf16 v[128:143], v[32:35], v[208:211], v[128:143]
    ds_read_b64_tr_b16 v[28:29], v5 offset:3392
    ds_read_b64_tr_b16 v[30:31], v5 offset:9536
    s_waitcnt lgkmcnt(12)
    v_mfma_f32_32x32x16_bf16 v[144:159], v[36:39], v[208:211], v[144:159]
    ds_read_b64_tr_b16 v[32:33], v4 offset:12288
    ds_read_b64_tr_b16 v[34:35], v4 offset:18432
    s_waitcnt vmcnt(11)
    s_waitcnt lgkmcnt(12)
    v_mfma_f32_32x32x16_bf16 v[64:79], v[40:43], v[212:215], v[64:79]
    ds_read_b64_tr_b16 v[36:37], v5 offset:12352
    ds_read_b64_tr_b16 v[38:39], v5 offset:18496
    s_waitcnt lgkmcnt(12)
    v_mfma_f32_32x32x16_bf16 v[80:95], v[44:47], v[212:215], v[80:95]
    ds_read_b64_tr_b16 v[40:41], v4 offset:12416
    ds_read_b64_tr_b16 v[42:43], v4 offset:18560
    s_waitcnt lgkmcnt(12)
    v_mfma_f32_32x32x16_bf16 v[96:111], v[16:19], v[212:215], v[96:111]
    ds_read_b64_tr_b16 v[44:45], v5 offset:12480
    ds_read_b64_tr_b16 v[46:47], v5 offset:18624
    s_waitcnt lgkmcnt(12)
    v_mfma_f32_32x32x16_bf16 v[112:127], v[20:23], v[212:215], v[112:127]
    ds_read_b64_tr_b16 v[16:17], v4 offset:12544
    ds_read_b64_tr_b16 v[18:19], v4 offset:18688
    s_waitcnt lgkmcnt(12)
    v_mfma_f32_32x32x16_bf16 v[128:143], v[24:27], v[212:215], v[128:143]
    ds_read_b64_tr_b16 v[20:21], v5 offset:12608
    ds_read_b64_tr_b16 v[22:23], v5 offset:18752
    s_waitcnt lgkmcnt(12)
    v_mfma_f32_32x32x16_bf16 v[144:159], v[28:31], v[212:215], v[144:159]
    ds_read_b64_tr_b16 v[24:25], v4 offset:15360
    ds_read_b64_tr_b16 v[26:27], v4 offset:21504
    s_waitcnt vmcnt(6)
    s_mov_b32 s100, 0x8000
L_spin_9:
    v_cmp_gt_u32 vcc, 1, v58
    s_and_b32 s50, vcc_lo, 0xfff
    s_cbranch_scc0 L_ok_8
    s_sub_u32 s100, s100, 1
    s_cbranch_scc1 L_ok_8
    s_sleep 1
    buffer_load_dword v58, v49, s[20:23], s4 offen sc1
    s_waitcnt vmcnt(0)
    s_branch L_spin_9
L_ok_8:
    s_waitcnt lgkmcnt(12)
    v_mfma_f32_32x32x16_bf16 v[64:79], v[32:35], v[216:219], v[64:79]
    ds_read_b64_tr_b16 v[28:29], v5 offset:15424
    ds_read_b64_tr_b16 v[30:31], v5 offset:21568
    s_add_u32 s50, s91, 65536
    buffer_load_dwordx4 v[160:163], v48, s[20:23], s50 offen sc1
    s_waitcnt lgkmcnt(12)
    v_mfma_f32_32x32x16_bf16 v[80:95], v[36:39], v[216:219], v[80:95]
    ds_read_b64_tr_b16 v[32:33], v4 offset:15488
    ds_read_b64_tr_b16 v[34:35], v4 offset:21632
    s_waitcnt lgkmcnt(12)
    v_mfma_f32_32x32x16_bf16 v[96:111], v[40:43], v[216:219], v[96:111]
    ds_read_b64_tr_b16 v[36:37], v5 offset:15552
    ds_read_b64_tr_b16 v[38:39], v5 offset:21696
    s_waitcnt lgkmcnt(12)
    v_mfma_f32_32x32x16_bf16 v[112:127], v[44:47], v[216:219], v[112:127]
    ds_read_b64_tr_b16 v[40:41], v4 offset:15616
    ds_read_b64_tr_b16 v[42:43], v4 offset:21760
    s_add_u32 s50, s91, 66048
    buffer_load_dwordx4 v[164:167], v48, s[20:23], s50 offen sc1
    s_waitcnt lgkmcnt(12)
    v_mfma_f32_32x32x16_bf16 v[128:143], v[16:19], v[216:219], v[128:143]
    ds_read_b64_tr_b16 v[44:45], v5 offset:15680
    ds_read_b64_tr_b16 v[46:47], v5 offset:21824
    s_waitcnt lgkmcnt(12)
    v_mfma_f32_32x32x16_bf16 v[144:159], v[20:23], v[216:219], v[144:159]
    ds_read_b64_tr_b16 v[16:17], v4 offset:24576
    ds_read_b64_tr_b16 v[18:19], v4 offset:30720
    s_add_u32 s4, s98, 4608
    buffer_load_dword v58, v49, s[20:23], s4 offen sc1
    s_waitcnt lgkmcnt(12)
    v_mfma_f32_32x32x16_bf16 v[64:79], v[24:27], v[220:223], v[64:79]
    ds_read_b64_tr_b16 v[20:21], v5 offset:24640
    ds_read_b64_tr_b16 v[22:23], v5 offset:30784
    s_add_u32 s50, s92, 65536
    buffer_load_dwordx4 v[168:171], v48, s[20:23], s50 offen sc1
    s_waitcnt lgkmcnt(12)
    v_mfma_f32_32x32x16_bf16 v[80:95], v[28:31], v[220:223], v[80:95]
    ds_read_b64_tr_b16 v[24:25], v4 offset:24704
    ds_read_b64_tr_b16 v[26:27], v4 offset:30848
    s_waitcnt lgkmcnt(12)
    v_mfma_f32_32x32x16_bf16 v[96:111], v[32:35], v[220:223], v[96:111]
    ds_read_b64_tr_b16 v[28:29], v5 offset:24768
    ds_read_b64_tr_b16 v[30:31], v5 offset:30912
    s_waitcnt lgkmcnt(12)
    v_mfma_f32_32x32x16_bf16 v[112:127], v[36:39], v[220:223], v[112:127]
    ds_read_b64_tr_b16 v[32:33], v4 offset:24832
    ds_read_b64_tr_b16 v[34:35], v4 offset:30976
    s_add_u32 s50, s92, 66048
    buffer_load_dwordx4 v[172:175], v48, s[20:23], s50 offen sc1
    s_waitcnt lgkmcnt(12)
    v_mfma_f32_32x32x16_bf16 v[128:143], v[40:43], v[220:223], v[128:143]
    ds_read_b64_tr_b16 v[36:37], v5 offset:24896
    ds_read_b64_tr_b16 v[38:39], v5 offset:31040
    s_waitcnt lgkmcnt(12)
    v_mfma_f32_32x32x16_bf16 v[144:159], v[44:47], v[220:223], v[144:159]
    ds_read_b64_tr_b16 v[40:41], v4 offset:27648
    ds_read_b64_tr_b16 v[42:43], v4 offset:33792
    s_barrier
    s_waitcnt lgkmcnt(12)
    v_mfma_f32_32x32x16_bf16 v[64:79], v[16:19], v[224:227], v[64:79]
    ds_read_b64_tr_b16 v[44:45], v5 offset:27712
    ds_read_b64_tr_b16 v[46:47], v5 offset:33856
    s_add_u32 s50, s93, 65536
    buffer_load_dwordx4 v[176:179], v48, s[20:23], s50 offen sc1
    s_waitcnt lgkmcnt(12)
    v_mfma_f32_32x32x16_bf16 v[80:95], v[20:23], v[224:227], v[80:95]
    ds_read_b64_tr_b16 v[16:17], v4 offset:27776
    ds_read_b64_tr_b16 v[18:19], v4 offset:33920
    s_waitcnt lgkmcnt(12)
    v_mfma_f32_32x32x16_bf16 v[96:111], v[24:27], v[224:227], v[96:111]
    ds_read_b64_tr_b16 v[20:21], v5 offset:27840
    ds_read_b64_tr_b16 v[22:23], v5 offset:33984
    s_waitcnt lgkmcnt(12)
    v_mfma_f32_32x32x16_bf16 v[112:127], v[28:31], v[224:227], v[112:127]
    ds_read_b64_tr_b16 v[24:25], v4 offset:27904
    ds_read_b64_tr_b16 v[26:27], v4 offset:34048
    s_add_u32 s50, s93, 66048
    buffer_load_dwordx4 v[180:183], v48, s[20:23], s50 offen sc1
    s_waitcnt lgkmcnt(12)
    v_mfma_f32_32x32x16_bf16 v[128:143], v[32:35], v[224:227], v[128:143]
    ds_read_b64_tr_b16 v[28:29], v5 offset:27968
    ds_read_b64_tr_b16 v[30:31], v5 offset:34112
    s_waitcnt lgkmcnt(12)
    v_mfma_f32_32x32x16_bf16 v[144:159], v[36:39], v[224:227], v[144:159]
    ds_read_b64_tr_b16 v[32:33], v4 offset:36864
    ds_read_b64_tr_b16 v[34:35], v4 offset:43008
    s_waitcnt lgkmcnt(12)
    v_mfma_f32_32x32x16_bf16 v[64:79], v[40:43], v[228:231], v[64:79]
    ds_read_b64_tr_b16 v[36:37], v5 offset:36928
    ds_read_b64_tr_b16 v[38:39], v5 offset:43072
    s_add_u32 s50, s94, 65536
    buffer_load_dwordx4 v[184:187], v48, s[20:23], s50 offen sc1
    s_waitcnt lgkmcnt(12)
    v_mfma_f32_32x32x16_bf16 v[80:95], v[44:47], v[228:231], v[80:95]
    ds_read_b64_tr_b16 v[40:41], v4 offset:36992
    ds_read_b64_tr_b16 v[42:43], v4 offset:43136
    s_waitcnt lgkmcnt(12)
    v_mfma_f32_32x32x16_bf16 v[96:111], v[16:19], v[228:231], v[96:111]
    ds_read_b64_tr_b16 v[44:45], v5 offset:37056
    ds_read_b64_tr_b16 v[46:47], v5 offset:43200
    s_waitcnt lgkmcnt(12)
    v_mfma_f32_32x32x16_bf16 v[112:127], v[20:23], v[228:231], v[112:127]
    ds_read_b64_tr_b16 v[16:17], v4 offset:37120
    ds_read_b64_tr_b16 v[18:19], v4 offset:43264
    s_add_u32 s50, s94, 66048
    buffer_load_dwordx4 v[188:191], v48, s[20:23], s50 offen sc1
    s_waitcnt lgkmcnt(12)
    v_mfma_f32_32x32x16_bf16 v[128:143], v[24:27], v[228:231], v[128:143]
    ds_read_b64_tr_b16 v[20:21], v5 offset:37184
    ds_read_b64_tr_b16 v[22:23], v5 offset:43328
    s_waitcnt lgkmcnt(12)
    v_mfma_f32_32x32x16_bf16 v[144:159], v[28:31], v[228:231], v[144:159]
    ds_read_b64_tr_b16 v[24:25], v4 offset:39936
    ds_read_b64_tr_b16 v[26:27], v4 offset:46080
    s_waitcnt vmcnt(14)
    s_waitcnt lgkmcnt(12)
    v_mfma_f32_32x32x16_bf16 v[64:79], v[32:35], v[232:235], v[64:79]
    ds_read_b64_tr_b16 v[28:29], v5 offset:40000
    ds_read_b64_tr_b16 v[30:31], v5 offset:46144
    s_add_u32 s50, s95, 65536
    buffer_load_dwordx4 v[192:195], v48, s[20:23], s50 offen sc1
    s_waitcnt lgkmcnt(12)
    v_mfma_f32_32x32x16_bf16 v[80:95], v[36:39], v[232:235], v[80:95]
    ds_read_b64_tr_b16 v[32:33], v4 offset:40064
    ds_read_b64_tr_b16 v[34:35], v4 offset:46208
    s_waitcnt lgkmcnt(12)
    v_mfma_f32_32x32x16_bf16 v[96:111], v[40:43], v[232:235], v[96:111]
    ds_read_b64_tr_b16 v[36:37], v5 offset:40128
    ds_read_b64_tr_b16 v[38:39], v5 offset:46272
    s_waitcnt lgkmcnt(12)
    v_mfma_f32_32x32x16_bf16 v[112:127], v[44:47], v[232:235], v[112:127]
    ds_read_b64_tr_b16 v[40:41], v4 offset:40192
    ds_read_b64_tr_b16 v[42:43], v4 offset:46336
    s_add_u32 s50, s95, 66048
    buffer_load_dwordx4 v[196:199], v48, s[20:23], s50 offen sc1
    s_waitcnt lgkmcnt(12)
    v_mfma_f32_32x32x16_bf16 v[128:143], v[16:19], v[232:235], v[128:143]
    ds_read_b64_tr_b16 v[44:45], v5 offset:40256
    ds_read_b64_tr_b16 v[46:47], v5 offset:46400
    s_waitcnt lgkmcnt(12)
    v_mfma_f32_32x32x16_bf16 v[144:159], v[20:23], v[232:235], v[144:159]
    ds_read_b64_tr_b16 v[16:17], v6 offset:0
    ds_read_b64_tr_b16 v[18:19], v6 offset:6144
    s_waitcnt vmcnt(15)
    s_waitcnt lgkmcnt(12)
    v_mfma_f32_32x32x16_bf16 v[64:79], v[24:27], v[236:239], v[64:79]
    ds_read_b64_tr_b16 v[20:21], v0 offset:64
    ds_read_b64_tr_b16 v[22:23], v0 offset:6208
    s_add_u32 s50, s96, 65536
    buffer_load_dwordx4 v[200:203], v48, s[20:23], s50 offen sc1
    s_waitcnt lgkmcnt(12)
    v_mfma_f32_32x32x16_bf16 v[80:95], v[28:31], v[236:239], v[80:95]
    ds_read_b64_tr_b16 v[24:25], v6 offset:128
    ds_read_b64_tr_b16 v[26:27], v6 offset:6272
    s_waitcnt lgkmcnt(12)
    v_mfma_f32_32x32x16_bf16 v[96:111], v[32:35], v[236:239], v[96:111]
    ds_read_b64_tr_b16 v[28:29], v0 offset:192
    ds_read_b64_tr_b16 v[30:31], v0 offset:6336
    s_waitcnt lgkmcnt(12)
    v_mfma_f32_32x32x16_bf16 v[112:127], v[36:39], v[236:239], v[112:127]
    ds_read_b64_tr_b16 v[32:33], v6 offset:256
    ds_read_b64_tr_b16 v[34:35], v6 offset:6400
    s_add_u32 s50, s96, 66048
    buffer_load_dwordx4 v[204:207], v48, s[20:23], s50 offen sc1
    s_waitcnt lgkmcnt(12)
    v_mfma_f32_32x32x16_bf16 v[128:143], v[40:43], v[236:239], v[128:143]
    ds_read_b64_tr_b16 v[36:37], v0 offset:320
    ds_read_b64_tr_b16 v[38:39], v0 offset:6464
    s_waitcnt lgkmcnt(12)
    v_mfma_f32_32x32x16_bf16 v[144:159], v[44:47], v[236:239], v[144:159]
    ds_read_b64_tr_b16 v[40:41], v6 offset:3072
    ds_read_b64_tr_b16 v[42:43], v6 offset:9216
    s_barrier
    s_waitcnt vmcnt(10)
    s_mov_b32 s100, 0x8000
L_spin_11:
    v_cmp_gt_u32 vcc, 1, v58
    s_and_b32 s50, vcc_lo, 0xfff
    s_cbranch_scc0 L_ok_10
    s_sub_u32 s100, s100, 1
    s_cbranch_scc1 L_ok_10
    s_sleep 1
    buffer_load_dword v58, v49, s[20:23], s4 offen sc1
    s_waitcnt vmcnt(0)
    s_branch L_spin_11
L_ok_10:
    s_waitcnt lgkmcnt(12)
    v_mfma_f32_32x32x16_bf16 v[64:79], v[16:19], v[240:243], v[64:79]
    ds_read_b64_tr_b16 v[44:45], v0 offset:3136
    ds_read_b64_tr_b16 v[46:47], v0 offset:9280
    s_add_u32 s50, s91, 81920
    buffer_load_dwordx4 v[208:211], v48, s[20:23], s50 offen sc1
    s_waitcnt lgkmcnt(12)
    v_mfma_f32_32x32x16_bf16 v[80:95], v[20:23], v[240:243], v[80:95]
    ds_read_b64_tr_b16 v[16:17], v6 offset:3200
    ds_read_b64_tr_b16 v[18:19], v6 offset:9344
    s_waitcnt lgkmcnt(12)
    v_mfma_f32_32x32x16_bf16 v[96:111], v[24:27], v[240:243], v[96:111]
    ds_read_b64_tr_b16 v[20:21], v0 offset:3264
    ds_read_b64_tr_b16 v[22:23], v0 offset:9408
    s_waitcnt lgkmcnt(12)
    v_mfma_f32_32x32x16_bf16 v[112:127], v[28:31], v[240:243], v[112:127]
    ds_read_b64_tr_b16 v[24:25], v6 offset:3328
    ds_read_b64_tr_b16 v[26:27], v6 offset:9472
    s_add_u32 s50, s91, 82432
    buffer_load_dwordx4 v[212:215], v48, s[20:23], s50 offen sc1
    s_waitcnt lgkmcnt(12)
    v_mfma_f32_32x32x16_bf16 v[128:143], v[32:35], v[240:243], v[128:143]
    ds_read_b64_tr_b16 v[28:29], v0 offset:3392
    ds_read_b64_tr_b16 v[30:31], v0 offset:9536
    s_waitcnt lgkmcnt(12)
    v_mfma_f32_32x32x16_bf16 v[144:159], v[36:39], v[240:243], v[144:159]
    ds_read_b64_tr_b16 v[32:33], v6 offset:12288
    ds_read_b64_tr_b16 v[34:35], v6 offset:18432
    s_waitcnt lgkmcnt(12)
    v_mfma_f32_32x32x16_bf16 v[64:79], v[40:43], v[244:247], v[64:79]
    ds_read_b64_tr_b16 v[36:37], v0 offset:12352
    ds_read_b64_tr_b16 v[38:39], v0 offset:18496
    s_add_u32 s50, s92, 81920
    buffer_load_dwordx4 v[216:219], v48, s[20:23], s50 offen sc1
    s_waitcnt lgkmcnt(12)
    v_mfma_f32_32x32x16_bf16 v[80:95], v[44:47], v[244:247], v[80:95]
    ds_read_b64_tr_b16 v[40:41], v6 offset:12416
    ds_read_b64_tr_b16 v[42:43], v6 offset:18560
    s_waitcnt lgkmcnt(12)
    v_mfma_f32_32x32x16_bf16 v[96:111], v[16:19], v[244:247], v[96:111]
    ds_read_b64_tr_b16 v[44:45], v0 offset:12480
    ds_read_b64_tr_b16 v[46:47], v0 offset:18624
    s_waitcnt lgkmcnt(12)
    v_mfma_f32_32x32x16_bf16 v[112:127], v[20:23], v[244:247], v[112:127]
    ds_read_b64_tr_b16 v[16:17], v6 offset:12544
    ds_read_b64_tr_b16 v[18:19], v6 offset:18688
    s_add_u32 s50, s92, 82432
    buffer_load_dwordx4 v[220:223], v48, s[20:23], s50 offen sc1
    s_waitcnt lgkmcnt(12)
    v_mfma_f32_32x32x16_bf16 v[128:143], v[24:27], v[244:247], v[128:143]
    ds_read_b64_tr_b16 v[20:21], v0 offset:12608
    ds_read_b64_tr_b16 v[22:23], v0 offset:18752
    s_waitcnt lgkmcnt(12)
    v_mfma_f32_32x32x16_bf16 v[144:159], v[28:31], v[244:247], v[144:159]
    ds_read_b64_tr_b16 v[24:25], v6 offset:15360
    ds_read_b64_tr_b16 v[26:27], v6 offset:21504
    s_waitcnt lgkmcnt(12)
    v_mfma_f32_32x32x16_bf16 v[64:79], v[32:35], v[248:251], v[64:79]
    ds_read_b64_tr_b16 v[28:29], v0 offset:15424
    ds_read_b64_tr_b16 v[30:31], v0 offset:21568
    s_add_u32 s50, s93, 81920
    buffer_load_dwordx4 v[224:227], v48, s[20:23], s50 offen sc1
    s_waitcnt lgkmcnt(12)
    v_mfma_f32_32x32x16_bf16 v[80:95], v[36:39], v[248:251], v[80:95]
    ds_read_b64_tr_b16 v[32:33], v6 offset:15488
    ds_read_b64_tr_b16 v[34:35], v6 offset:21632
    s_waitcnt lgkmcnt(12)
    v_mfma_f32_32x32x16_bf16 v[96:111], v[40:43], v[248:251], v[96:111]
    ds_read_b64_tr_b16 v[36:37], v0 offset:15552
    ds_read_b64_tr_b16 v[38:39], v0 offset:21696
    s_waitcnt lgkmcnt(12)
    v_mfma_f32_32x32x16_bf16 v[112:127], v[44:47], v[248:251], v[112:127]
    ds_read_b64_tr_b16 v[40:41], v6 offset:15616
    ds_read_b64_tr_b16 v[42:43], v6 offset:21760
    s_add_u32 s50, s93, 82432
    buffer_load_dwordx4 v[228:231], v48, s[20:23], s50 offen sc1
    s_waitcnt lgkmcnt(12)
    v_mfma_f32_32x32x16_bf16 v[128:143], v[16:19], v[248:251], v[128:143]
    ds_read_b64_tr_b16 v[44:45], v0 offset:15680
    ds_read_b64_tr_b16 v[46:47], v0 offset:21824
    s_waitcnt lgkmcnt(12)
    v_mfma_f32_32x32x16_bf16 v[144:159], v[20:23], v[248:251], v[144:159]
    ds_read_b64_tr_b16 v[16:17], v2 offset:0
    ds_read_b64_tr_b16 v[18:19], v2 offset:6144
    s_waitcnt lgkmcnt(12)
    v_mfma_f32_32x32x16_bf16 v[64:79], v[24:27], v[252:255], v[64:79]
    ds_read_b64_tr_b16 v[20:21], v3 offset:64
    ds_read_b64_tr_b16 v[22:23], v3 offset:6208
    s_add_u32 s50, s94, 81920
    buffer_load_dwordx4 v[232:235], v48, s[20:23], s50 offen sc1
    s_waitcnt lgkmcnt(12)
    v_mfma_f32_32x32x16_bf16 v[80:95], v[28:31], v[252:255], v[80:95]
    ds_read_b64_tr_b16 v[24:25], v2 offset:128
    ds_read_b64_tr_b16 v[26:27], v2 offset:6272
    s_waitcnt lgkmcnt(12)
    v_mfma_f32_32x32x16_bf16 v[96:111], v[32:35], v[252:255], v[96:111]
    ds_read_b64_tr_b16 v[28:29], v3 offset:192
    ds_read_b64_tr_b16 v[30:31], v3 offset:6336
    s_waitcnt lgkmcnt(12)
    v_mfma_f32_32x32x16_bf16 v[112:127], v[36:39], v[252:255], v[112:127]
    ds_read_b64_tr_b16 v[32:33], v2 offset:256
    ds_read_b64_tr_b16 v[34:35], v2 offset:6400
    s_add_u32 s50, s94, 82432
    buffer_load_dwordx4 v[236:239], v48, s[20:23], s50 offen sc1
    s_waitcnt lgkmcnt(12)
    v_mfma_f32_32x32x16_bf16 v[128:143], v[40:43], v[252:255], v[128:143]
    ds_read_b64_tr_b16 v[36:37], v3 offset:320
    ds_read_b64_tr_b16 v[38:39], v3 offset:6464
    s_waitcnt lgkmcnt(12)
    v_mfma_f32_32x32x16_bf16 v[144:159], v[44:47], v[252:255], v[144:159]
    ds_read_b64_tr_b16 v[40:41], v2 offset:3072
    ds_read_b64_tr_b16 v[42:43], v2 offset:9216
    s_barrier
    s_waitcnt lgkmcnt(12)
    v_mfma_f32_32x32x16_bf16 v[64:79], v[16:19], v[160:163], v[64:79]
    ds_read_b64_tr_b16 v[44:45], v3 offset:3136
    ds_read_b64_tr_b16 v[46:47], v3 offset:9280
    s_add_u32 s50, s95, 81920
    buffer_load_dwordx4 v[240:243], v48, s[20:23], s50 offen sc1
    s_waitcnt lgkmcnt(12)
    v_mfma_f32_32x32x16_bf16 v[80:95], v[20:23], v[160:163], v[80:95]
    ds_read_b64_tr_b16 v[16:17], v2 offset:3200
    ds_read_b64_tr_b16 v[18:19], v2 offset:9344
    s_waitcnt lgkmcnt(12)
    v_mfma_f32_32x32x16_bf16 v[96:111], v[24:27], v[160:163], v[96:111]
    ds_read_b64_tr_b16 v[20:21], v3 offset:3264
    ds_read_b64_tr_b16 v[22:23], v3 offset:9408
    s_waitcnt lgkmcnt(12)
    v_mfma_f32_32x32x16_bf16 v[112:127], v[28:31], v[160:163], v[112:127]
    ds_read_b64_tr_b16 v[24:25], v2 offset:3328
    ds_read_b64_tr_b16 v[26:27], v2 offset:9472
    s_add_u32 s50, s95, 82432
    buffer_load_dwordx4 v[244:247], v48, s[20:23], s50 offen sc1
    s_waitcnt lgkmcnt(12)
    v_mfma_f32_32x32x16_bf16 v[128:143], v[32:35], v[160:163], v[128:143]
    ds_read_b64_tr_b16 v[28:29], v3 offset:3392
    ds_read_b64_tr_b16 v[30:31], v3 offset:9536
    s_waitcnt lgkmcnt(12)
    v_mfma_f32_32x32x16_bf16 v[144:159], v[36:39], v[160:163], v[144:159]
    ds_read_b64_tr_b16 v[32:33], v2 offset:12288
    ds_read_b64_tr_b16 v[34:35], v2 offset:18432
    s_waitcnt lgkmcnt(12)
    v_mfma_f32_32x32x16_bf16 v[64:79], v[40:43], v[164:167], v[64:79]
    ds_read_b64_tr_b16 v[36:37], v3 offset:12352
    ds_read_b64_tr_b16 v[38:39], v3 offset:18496
    s_add_u32 s50, s96, 81920
    buffer_load_dwordx4 v[248:251], v48, s[20:23], s50 offen sc1
    s_waitcnt lgkmcnt(12)
    v_mfma_f32_32x32x16_bf16 v[80:95], v[44:47], v[164:167], v[80:95]
    ds_read_b64_tr_b16 v[40:41], v2 offset:12416
    ds_read_b64_tr_b16 v[42:43], v2 offset:18560
    s_waitcnt lgkmcnt(12)
    v_mfma_f32_32x32x16_bf16 v[96:111], v[16:19], v[164:167], v[96:111]
    ds_read_b64_tr_b16 v[44:45], v3 offset:12480
    ds_read_b64_tr_b16 v[46:47], v3 offset:18624
    s_waitcnt lgkmcnt(12)
    v_mfma_f32_32x32x16_bf16 v[112:127], v[20:23], v[164:167], v[112:127]
    ds_read_b64_tr_b16 v[16:17], v2 offset:12544
    ds_read_b64_tr_b16 v[18:19], v2 offset:18688
    s_add_u32 s50, s96, 82432
    buffer_load_dwordx4 v[252:255], v48, s[20:23], s50 offen sc1
    s_waitcnt lgkmcnt(12)
    v_mfma_f32_32x32x16_bf16 v[128:143], v[24:27], v[164:167], v[128:143]
    ds_read_b64_tr_b16 v[20:21], v3 offset:12608
    ds_read_b64_tr_b16 v[22:23], v3 offset:18752
    s_waitcnt lgkmcnt(12)
    v_mfma_f32_32x32x16_bf16 v[144:159], v[28:31], v[164:167], v[144:159]
    ds_read_b64_tr_b16 v[24:25], v2 offset:15360
    ds_read_b64_tr_b16 v[26:27], v2 offset:21504
    s_waitcnt vmcnt(21)
    s_waitcnt lgkmcnt(12)
    v_mfma_f32_32x32x16_bf16 v[64:79], v[32:35], v[168:171], v[64:79]
    ds_read_b64_tr_b16 v[28:29], v3 offset:15424
    ds_read_b64_tr_b16 v[30:31], v3 offset:21568
    s_waitcnt lgkmcnt(12)
    v_mfma_f32_32x32x16_bf16 v[80:95], v[36:39], v[168:171], v[80:95]
    ds_read_b64_tr_b16 v[32:33], v2 offset:15488
    ds_read_b64_tr_b16 v[34:35], v2 offset:21632
    s_waitcnt lgkmcnt(12)
    v_mfma_f32_32x32x16_bf16 v[96:111], v[40:43], v[168:171], v[96:111]
    ds_read_b64_tr_b16 v[36:37], v3 offset:15552
    ds_read_b64_tr_b16 v[38:39], v3 offset:21696
    s_waitcnt lgkmcnt(12)
    v_mfma_f32_32x32x16_bf16 v[112:127], v[44:47], v[168:171], v[112:127]
    ds_read_b64_tr_b16 v[40:41], v2 offset:15616
    ds_read_b64_tr_b16 v[42:43], v2 offset:21760
    s_waitcnt lgkmcnt(12)
    v_mfma_f32_32x32x16_bf16 v[128:143], v[16:19], v[168:171], v[128:143]
    ds_read_b64_tr_b16 v[44:45], v3 offset:15680
    ds_read_b64_tr_b16 v[46:47], v3 offset:21824
    s_waitcnt lgkmcnt(12)
    v_mfma_f32_32x32x16_bf16 v[144:159], v[20:23], v[168:171], v[144:159]
    ds_read_b64_tr_b16 v[16:17], v2 offset:24576
    ds_read_b64_tr_b16 v[18:19], v2 offset:30720
    s_waitcnt vmcnt(20)
    s_waitcnt lgkmcnt(12)
    v_mfma_f32_32x32x16_bf16 v[64:79], v[24:27], v[172:175], v[64:79]
    ds_read_b64_tr_b16 v[20:21], v3 offset:24640
    ds_read_b64_tr_b16 v[22:23], v3 offset:30784
    s_waitcnt lgkmcnt(12)
    v_mfma_f32_32x32x16_bf16 v[80:95], v[28:31], v[172:175], v[80:95]
    ds_read_b64_tr_b16 v[24:25], v2 offset:24704
    ds_read_b64_tr_b16 v[26:27], v2 offset:30848
    s_waitcnt lgkmcnt(12)
    v_mfma_f32_32x32x16_bf16 v[96:111], v[32:35], v[172:175], v[96:111]
    ds_read_b64_tr_b16 v[28:29], v3 offset:24768
    ds_read_b64_tr_b16 v[30:31], v3 offset:30912
    s_waitcnt lgkmcnt(12)
    v_mfma_f32_32x32x16_bf16 v[112:127], v[36:39], v[172:175], v[112:127]
    ds_read_b64_tr_b16 v[32:33], v2 offset:24832
    ds_read_b64_tr_b16 v[34:35], v2 offset:30976
    s_waitcnt lgkmcnt(12)
    v_mfma_f32_32x32x16_bf16 v[128:143], v[40:43], v[172:175], v[128:143]
    ds_read_b64_tr_b16 v[36:37], v3 offset:24896
    ds_read_b64_tr_b16 v[38:39], v3 offset:31040
    s_waitcnt lgkmcnt(12)
    v_mfma_f32_32x32x16_bf16 v[144:159], v[44:47], v[172:175], v[144:159]
    ds_read_b64_tr_b16 v[40:41], v2 offset:27648
    ds_read_b64_tr_b16 v[42:43], v2 offset:33792
    s_barrier
    s_waitcnt vmcnt(19)
    s_waitcnt lgkmcnt(12)
    v_mfma_f32_32x32x16_bf16 v[64:79], v[16:19], v[176:179], v[64:79]
    ds_read_b64_tr_b16 v[44:45], v3 offset:27712
    ds_read_b64_tr_b16 v[46:47], v3 offset:33856
    s_waitcnt lgkmcnt(12)
    v_mfma_f32_32x32x16_bf16 v[80:95], v[20:23], v[176:179], v[80:95]
    ds_read_b64_tr_b16 v[16:17], v2 offset:27776
    ds_read_b64_tr_b16 v[18:19], v2 offset:33920
    s_waitcnt lgkmcnt(12)
    v_mfma_f32_32x32x16_bf16 v[96:111], v[24:27], v[176:179], v[96:111]
    ds_read_b64_tr_b16 v[20:21], v3 offset:27840
    ds_read_b64_tr_b16 v[22:23], v3 offset:33984
    s_waitcnt lgkmcnt(12)
    v_mfma_f32_32x32x16_bf16 v[112:127], v[28:31], v[176:179], v[112:127]
    ds_read_b64_tr_b16 v[24:25], v2 offset:27904
    ds_read_b64_tr_b16 v[26:27], v2 offset:34048
    s_waitcnt lgkmcnt(12)
    v_mfma_f32_32x32x16_bf16 v[128:143], v[32:35], v[176:179], v[128:143]
    ds_read_b64_tr_b16 v[28:29], v3 offset:27968
    ds_read_b64_tr_b16 v[30:31], v3 offset:34112
    s_waitcnt lgkmcnt(12)
    v_mfma_f32_32x32x16_bf16 v[144:159], v[36:39], v[176:179], v[144:159]
    ds_read_b64_tr_b16 v[32:33], v2 offset:36864
    ds_read_b64_tr_b16 v[34:35], v2 offset:43008
    s_waitcnt vmcnt(18)
    s_waitcnt lgkmcnt(12)
    v_mfma_f32_32x32x16_bf16 v[64:79], v[40:43], v[180:183], v[64:79]
    ds_read_b64_tr_b16 v[36:37], v3 offset:36928
    ds_read_b64_tr_b16 v[38:39], v3 offset:43072
    s_waitcnt lgkmcnt(12)
    v_mfma_f32_32x32x16_bf16 v[80:95], v[44:47], v[180:183], v[80:95]
    ds_read_b64_tr_b16 v[40:41], v2 offset:36992
    ds_read_b64_tr_b16 v[42:43], v2 offset:43136
    s_waitcnt lgkmcnt(12)
    v_mfma_f32_32x32x16_bf16 v[96:111], v[16:19], v[180:183], v[96:111]
    ds_read_b64_tr_b16 v[44:45], v3 offset:37056
    ds_read_b64_tr_b16 v[46:47], v3 offset:43200
    s_waitcnt lgkmcnt(12)
    v_mfma_f32_32x32x16_bf16 v[112:127], v[20:23], v[180:183], v[112:127]
    ds_read_b64_tr_b16 v[16:17], v2 offset:37120
    ds_read_b64_tr_b16 v[18:19], v2 offset:43264
    s_waitcnt lgkmcnt(12)
    v_mfma_f32_32x32x16_bf16 v[128:143], v[24:27], v[180:183], v[128:143]
    ds_read_b64_tr_b16 v[20:21], v3 offset:37184
    ds_read_b64_tr_b16 v[22:23], v3 offset:43328
    s_waitcnt lgkmcnt(12)
    v_mfma_f32_32x32x16_bf16 v[144:159], v[28:31], v[180:183], v[144:159]
    ds_read_b64_tr_b16 v[24:25], v2 offset:39936
    ds_read_b64_tr_b16 v[26:27], v2 offset:46080
    s_waitcnt vmcnt(17)
    s_waitcnt lgkmcnt(12)
    v_mfma_f32_32x32x16_bf16 v[64:79], v[32:35], v[184:187], v[64:79]
    ds_read_b64_tr_b16 v[28:29], v3 offset:40000
    ds_read_b64_tr_b16 v[30:31], v3 offset:46144
    s_waitcnt lgkmcnt(12)
    v_mfma_f32_32x32x16_bf16 v[80:95], v[36:39], v[184:187], v[80:95]
    ds_read_b64_tr_b16 v[32:33], v2 offset:40064
    ds_read_b64_tr_b16 v[34:35], v2 offset:46208
    s_waitcnt lgkmcnt(12)
    v_mfma_f32_32x32x16_bf16 v[96:111], v[40:43], v[184:187], v[96:111]
    ds_read_b64_tr_b16 v[36:37], v3 offset:40128
    ds_read_b64_tr_b16 v[38:39], v3 offset:46272
    s_waitcnt lgkmcnt(12)
    v_mfma_f32_32x32x16_bf16 v[112:127], v[44:47], v[184:187], v[112:127]
    ds_read_b64_tr_b16 v[40:41], v2 offset:40192
    ds_read_b64_tr_b16 v[42:43], v2 offset:46336
    s_waitcnt lgkmcnt(12)
    v_mfma_f32_32x32x16_bf16 v[128:143], v[16:19], v[184:187], v[128:143]
    ds_read_b64_tr_b16 v[44:45], v3 offset:40256
    ds_read_b64_tr_b16 v[46:47], v3 offset:46400
    s_waitcnt lgkmcnt(12)
    v_mfma_f32_32x32x16_bf16 v[144:159], v[20:23], v[184:187], v[144:159]
    ds_read_b64_tr_b16 v[16:17], v6 offset:24576
    ds_read_b64_tr_b16 v[18:19], v6 offset:30720
    s_waitcnt vmcnt(16)
    s_waitcnt lgkmcnt(12)
    v_mfma_f32_32x32x16_bf16 v[64:79], v[24:27], v[188:191], v[64:79]
    ds_read_b64_tr_b16 v[20:21], v6 offset:27648
    ds_read_b64_tr_b16 v[22:23], v6 offset:33792
    s_waitcnt lgkmcnt(12)
    v_mfma_f32_32x32x16_bf16 v[80:95], v[28:31], v[188:191], v[80:95]
    ds_read_b64_tr_b16 v[24:25], v6 offset:36864
    ds_read_b64_tr_b16 v[26:27], v6 offset:43008
    s_waitcnt lgkmcnt(12)
    v_mfma_f32_32x32x16_bf16 v[96:111], v[32:35], v[188:191], v[96:111]
    ds_read_b64_tr_b16 v[28:29], v6 offset:39936
    ds_read_b64_tr_b16 v[30:31], v6 offset:46080
    s_waitcnt lgkmcnt(12)
    v_mfma_f32_32x32x16_bf16 v[112:127], v[36:39], v[188:191], v[112:127]
    ds_read_b64_tr_b16 v[32:33], v4 offset:0
    ds_read_b64_tr_b16 v[34:35], v4 offset:6144
    s_waitcnt lgkmcnt(12)
    v_mfma_f32_32x32x16_bf16 v[128:143], v[40:43], v[188:191], v[128:143]
    ds_read_b64_tr_b16 v[36:37], v4 offset:3072
    ds_read_b64_tr_b16 v[38:39], v4 offset:9216
    s_waitcnt lgkmcnt(12)
    v_mfma_f32_32x32x16_bf16 v[144:159], v[44:47], v[188:191], v[144:159]
    ds_read_b64_tr_b16 v[40:41], v4 offset:12288
    ds_read_b64_tr_b16 v[42:43], v4 offset:18432
    s_barrier
    s_waitcnt vmcnt(15)
    s_mul_i32 s55, s38, 12288
    s_add_u32 s55, s55, s101
    s_add_u32 s55, s55, 3072
    s_waitcnt lgkmcnt(12)
    v_mfma_f32_32x32x16_bf16 v[64:79], v[16:19], v[192:195], v[64:79]
    ds_read_b64_tr_b16 v[44:45], v4 offset:15360
    ds_read_b64_tr_b16 v[46:47], v4 offset:21504
    s_waitcnt vmcnt(14)
    s_waitcnt lgkmcnt(12)
    v_mfma_f32_32x32x16_bf16 v[64:79], v[20:23], v[196:199], v[64:79]
    ds_read_b64_tr_b16 v[16:17], v4 offset:24576
    ds_read_b64_tr_b16 v[18:19], v4 offset:30720
    s_waitcnt vmcnt(13)
    s_waitcnt lgkmcnt(12)
    v_mfma_f32_32x32x16_bf16 v[64:79], v[24:27], v[200:203], v[64:79]
    ds_read_b64_tr_b16 v[20:21], v4 offset:27648
    ds_read_b64_tr_b16 v[22:23], v4 offset:33792
    s_waitcnt vmcnt(12)
    s_waitcnt lgkmcnt(12)
    v_mfma_f32_32x32x16_bf16 v[64:79], v[28:31], v[204:207], v[64:79]
    ds_read_b64_tr_b16 v[24:25], v4 offset:36864
    ds_read_b64_tr_b16 v[26:27], v4 offset:43008
    s_waitcnt vmcnt(11)
    s_waitcnt lgkmcnt(12)
    v_mfma_f32_32x32x16_bf16 v[64:79], v[32:35], v[208:211], v[64:79]
    ds_read_b64_tr_b16 v[28:29], v4 offset:39936
    ds_read_b64_tr_b16 v[30:31], v4 offset:46080
    s_waitcnt vmcnt(10)
    s_waitcnt lgkmcnt(12)
    v_mfma_f32_32x32x16_bf16 v[64:79], v[36:39], v[212:215], v[64:79]
    ds_read_b64_tr_b16 v[32:33], v6 offset:0
    ds_read_b64_tr_b16 v[34:35], v6 offset:6144
    s_waitcnt vmcnt(9)
    s_waitcnt lgkmcnt(12)
    v_mfma_f32_32x32x16_bf16 v[64:79], v[40:43], v[216:219], v[64:79]
    ds_read_b64_tr_b16 v[36:37], v6 offset:3072
    ds_read_b64_tr_b16 v[38:39], v6 offset:9216
    s_waitcnt vmcnt(8)
    s_waitcnt lgkmcnt(12)
    v_mfma_f32_32x32x16_bf16 v[64:79], v[44:47], v[220:223], v[64:79]
    ds_read_b64_tr_b16 v[40:41], v6 offset:12288
    ds_read_b64_tr_b16 v[42:43], v6 offset:18432
    s_waitcnt vmcnt(7)
    s_waitcnt lgkmcnt(12)
    v_mfma_f32_32x32x16_bf16 v[64:79], v[16:19], v[224:227], v[64:79]
    ds_read_b64_tr_b16 v[44:45], v6 offset:15360
    ds_read_b64_tr_b16 v[46:47], v6 offset:21504
    s_waitcnt vmcnt(6)
    s_waitcnt lgkmcnt(12)
    v_mfma_f32_32x32x16_bf16 v[64:79], v[20:23], v[228:231], v[64:79]
    ds_read_b64_tr_b16 v[16:17], v0 offset:24640
    ds_read_b64_tr_b16 v[18:19], v0 offset:30784
    s_waitcnt vmcnt(5)
    s_waitcnt lgkmcnt(12)
    v_mfma_f32_32x32x16_bf16 v[64:79], v[24:27], v[232:235], v[64:79]
    ds_read_b64_tr_b16 v[20:21], v0 offset:27712
    ds_read_b64_tr_b16 v[22:23], v0 offset:33856
    s_waitcnt vmcnt(4)
    s_waitcnt lgkmcnt(12)
    v_mfma_f32_32x32x16_bf16 v[64:79], v[28:31], v[236:239], v[64:79]
    ds_read_b64_tr_b16 v[24:25], v0 offset:36928
    ds_read_b64_tr_b16 v[26:27], v0 offset:43072
    s_waitcnt vmcnt(3)
    s_waitcnt lgkmcnt(12)
    v_mfma_f32_32x32x16_bf16 v[64:79], v[32:35], v[240:243], v[64:79]
    ds_read_b64_tr_b16 v[28:29], v0 offset:40000
    ds_read_b64_tr_b16 v[30:31], v0 offset:46144
    s_waitcnt vmcnt(2)
    s_waitcnt lgkmcnt(12)
    v_mfma_f32_32x32x16_bf16 v[64:79], v[36:39], v[244:247], v[64:79]
    ds_read_b64_tr_b16 v[32:33], v5 offset:64
    ds_read_b64_tr_b16 v[34:35], v5 offset:6208
    s_waitcnt vmcnt(1)
    s_waitcnt lgkmcnt(12)
    v_mfma_f32_32x32x16_bf16 v[64:79], v[40:43], v[248:251], v[64:79]
    ds_read_b64_tr_b16 v[36:37], v5 offset:3136
    ds_read_b64_tr_b16 v[38:39], v5 offset:9280
    s_waitcnt vmcnt(0)
    s_waitcnt lgkmcnt(12)
    v_mfma_f32_32x32x16_bf16 v[64:79], v[44:47], v[252:255], v[64:79]
    ds_read_b64_tr_b16 v[40:41], v5 offset:12352
    ds_read_b64_tr_b16 v[42:43], v5 offset:18496
    s_waitcnt lgkmcnt(12)
    v_mfma_f32_32x32x16_bf16 v[80:95], v[16:19], v[192:195], v[80:95]
    ds_read_b64_tr_b16 v[44:45], v5 offset:15424
    ds_read_b64_tr_b16 v[46:47], v5 offset:21568
    s_waitcnt lgkmcnt(12)
    v_mfma_f32_32x32x16_bf16 v[80:95], v[20:23], v[196:199], v[80:95]
    ds_read_b64_tr_b16 v[16:17], v5 offset:24640
    ds_read_b64_tr_b16 v[18:19], v5 offset:30784
    s_waitcnt lgkmcnt(12)
    v_mfma_f32_32x32x16_bf16 v[80:95], v[24:27], v[200:203], v[80:95]
    ds_read_b64_tr_b16 v[20:21], v5 offset:27712
    ds_read_b64_tr_b16 v[22:23], v5 offset:33856
    s_waitcnt lgkmcnt(12)
    v_mfma_f32_32x32x16_bf16 v[80:95], v[28:31], v[204:207], v[80:95]
    ds_read_b64_tr_b16 v[24:25], v5 offset:36928
    ds_read_b64_tr_b16 v[26:27], v5 offset:43072
    v_cvt_pk_bf16_f32 v160, v64, v65
    v_cvt_pk_bf16_f32 v161, v66, v67
    v_cvt_pk_bf16_f32 v162, v68, v69
    v_cvt_pk_bf16_f32 v163, v70, v71
    s_add_u32 s51, s55, 0
    buffer_store_dwordx4 v[160:163], v7, s[20:23], s51 offen sc1
    v_cvt_pk_bf16_f32 v164, v72, v73
    v_cvt_pk_bf16_f32 v165, v74, v75
    v_cvt_pk_bf16_f32 v166, v76, v77
    v_cvt_pk_bf16_f32 v167, v78, v79
    s_add_u32 s51, s55, 1024
    buffer_store_dwordx4 v[164:167], v7, s[20:23], s51 offen sc1
    s_waitcnt lgkmcnt(12)
    v_mfma_f32_32x32x16_bf16 v[80:95], v[32:35], v[208:211], v[80:95]
    ds_read_b64_tr_b16 v[28:29], v5 offset:40000
    ds_read_b64_tr_b16 v[30:31], v5 offset:46144
    s_waitcnt lgkmcnt(12)
    v_mfma_f32_32x32x16_bf16 v[80:95], v[36:39], v[212:215], v[80:95]
    ds_read_b64_tr_b16 v[32:33], v0 offset:64
    ds_read_b64_tr_b16 v[34:35], v0 offset:6208
    s_waitcnt lgkmcnt(12)
    v_mfma_f32_32x32x16_bf16 v[80:95], v[40:43], v[216:219], v[80:95]
    ds_read_b64_tr_b16 v[36:37], v0 offset:3136
    ds_read_b64_tr_b16 v[38:39], v0 offset:9280
    s_waitcnt lgkmcnt(12)
    v_mfma_f32_32x32x16_bf16 v[80:95], v[44:47], v[220:223], v[80:95]
    ds_read_b64_tr_b16 v[40:41], v0 offset:12352
    ds_read_b64_tr_b16 v[42:43], v0 offset:18496
    s_waitcnt lgkmcnt(12)
    v_mfma_f32_32x32x16_bf16 v[80:95], v[16:19], v[224:227], v[80:95]
    ds_read_b64_tr_b16 v[44:45], v0 offset:15424
    ds_read_b64_tr_b16 v[46:47], v0 offset:21568
    s_waitcnt lgkmcnt(12)
    v_mfma_f32_32x32x16_bf16 v[80:95], v[20:23], v[228:231], v[80:95]
    ds_read_b64_tr_b16 v[16:17], v6 offset:24704
    ds_read_b64_tr_b16 v[18:19], v6 offset:30848
    s_waitcnt lgkmcnt(12)
    v_mfma_f32_32x32x16_bf16 v[80:95], v[24:27], v[232:235], v[80:95]
    ds_read_b64_tr_b16 v[20:21], v6 offset:27776
    ds_read_b64_tr_b16 v[22:23], v6 offset:33920
    s_waitcnt lgkmcnt(12)
    v_mfma_f32_32x32x16_bf16 v[80:95], v[28:31], v[236:239], v[80:95]
    ds_read_b64_tr_b16 v[24:25], v6 offset:36992
    ds_read_b64_tr_b16 v[26:27], v6 offset:43136
    s_waitcnt lgkmcnt(12)
    v_mfma_f32_32x32x16_bf16 v[80:95], v[32:35], v[240:243], v[80:95]
    ds_read_b64_tr_b16 v[28:29], v6 offset:40064
    ds_read_b64_tr_b16 v[30:31], v6 offset:46208
    s_waitcnt lgkmcnt(12)
    v_mfma_f32_32x32x16_bf16 v[80:95], v[36:39], v[244:247], v[80:95]
    ds_read_b64_tr_b16 v[32:33], v4 offset:128
    ds_read_b64_tr_b16 v[34:35], v4 offset:6272
    s_waitcnt lgkmcnt(12)
    v_mfma_f32_32x32x16_bf16 v[80:95], v[40:43], v[248:251], v[80:95]
    ds_read_b64_tr_b16 v[36:37], v4 offset:3200
    ds_read_b64_tr_b16 v[38:39], v4 offset:9344
    s_waitcnt lgkmcnt(12)
    v_mfma_f32_32x32x16_bf16 v[80:95], v[44:47], v[252:255], v[80:95]
    ds_read_b64_tr_b16 v[40:41], v4 offset:12416
    ds_read_b64_tr_b16 v[42:43], v4 offset:18560
    s_waitcnt lgkmcnt(12)
    v_mfma_f32_32x32x16_bf16 v[96:111], v[16:19], v[192:195], v[96:111]
    ds_read_b64_tr_b16 v[44:45], v4 offset:15488
    ds_read_b64_tr_b16 v[46:47], v4 offset:21632
    s_waitcnt lgkmcnt(12)
    v_mfma_f32_32x32x16_bf16 v[96:111], v[20:23], v[196:199], v[96:111]
    ds_read_b64_tr_b16 v[16:17], v4 offset:24704
    ds_read_b64_tr_b16 v[18:19], v4 offset:30848
    s_waitcnt lgkmcnt(12)
    v_mfma_f32_32x32x16_bf16 v[96:111], v[24:27], v[200:203], v[96:111]
    ds_read_b64_tr_b16 v[20:21], v4 offset:27776
    ds_read_b64_tr_b16 v[22:23], v4 offset:33920
    s_waitcnt lgkmcnt(12)
    v_mfma_f32_32x32x16_bf16 v[96:111], v[28:31], v[204:207], v[96:111]
    ds_read_b64_tr_b16 v[24:25], v4 offset:36992
    ds_read_b64_tr_b16 v[26:27], v4 offset:43136
    v_cvt_pk_bf16_f32 v168, v80, v81
    v_cvt_pk_bf16_f32 v169, v82, v83
    v_cvt_pk_bf16_f32 v170, v84, v85
    v_cvt_pk_bf16_f32 v171, v86, v87
    s_add_u32 s51, s55, 2048
    buffer_store_dwordx4 v[168:171], v7, s[20:23], s51 offen sc1
    v_cvt_pk_bf16_f32 v172, v88, v89
    v_cvt_pk_bf16_f32 v173, v90, v91
    v_cvt_pk_bf16_f32 v174, v92, v93
    v_cvt_pk_bf16_f32 v175, v94, v95
    s_add_u32 s51, s55, 3072
    buffer_store_dwordx4 v[172:175], v7, s[20:23], s51 offen sc1
    s_waitcnt lgkmcnt(12)
    v_mfma_f32_32x32x16_bf16 v[96:111], v[32:35], v[208:211], v[96:111]
    ds_read_b64_tr_b16 v[28:29], v4 offset:40064
    ds_read_b64_tr_b16 v[30:31], v4 offset:46208
    s_waitcnt lgkmcnt(12)
    v_mfma_f32_32x32x16_bf16 v[96:111], v[36:39], v[212:215], v[96:111]
    ds_read_b64_tr_b16 v[32:33], v6 offset:128
    ds_read_b64_tr_b16 v[34:35], v6 offset:6272
    s_waitcnt lgkmcnt(12)
    v_mfma_f32_32x32x16_bf16 v[96:111], v[40:43], v[216:219], v[96:111]
    ds_read_b64_tr_b16 v[36:37], v6 offset:3200
    ds_read_b64_tr_b16 v[38:39], v6 offset:9344
    s_waitcnt lgkmcnt(12)
    v_mfma_f32_32x32x16_bf16 v[96:111], v[44:47], v[220:223], v[96:111]
    ds_read_b64_tr_b16 v[40:41], v6 offset:12416
    ds_read_b64_tr_b16 v[42:43], v6 offset:18560
    s_waitcnt lgkmcnt(12)
    v_mfma_f32_32x32x16_bf16 v[96:111], v[16:19], v[224:227], v[96:111]
    ds_read_b64_tr_b16 v[44:45], v6 offset:15488
    ds_read_b64_tr_b16 v[46:47], v6 offset:21632
    s_waitcnt lgkmcnt(12)
    v_mfma_f32_32x32x16_bf16 v[96:111], v[20:23], v[228:231], v[96:111]
    ds_read_b64_tr_b16 v[16:17], v0 offset:24768
    ds_read_b64_tr_b16 v[18:19], v0 offset:30912
    s_waitcnt lgkmcnt(12)
    v_mfma_f32_32x32x16_bf16 v[96:111], v[24:27], v[232:235], v[96:111]
    ds_read_b64_tr_b16 v[20:21], v0 offset:27840
    ds_read_b64_tr_b16 v[22:23], v0 offset:33984
    s_waitcnt lgkmcnt(12)
    v_mfma_f32_32x32x16_bf16 v[96:111], v[28:31], v[236:239], v[96:111]
    ds_read_b64_tr_b16 v[24:25], v0 offset:37056
    ds_read_b64_tr_b16 v[26:27], v0 offset:43200
    s_waitcnt lgkmcnt(12)
    v_mfma_f32_32x32x16_bf16 v[96:111], v[32:35], v[240:243], v[96:111]
    ds_read_b64_tr_b16 v[28:29], v0 offset:40128
    ds_read_b64_tr_b16 v[30:31], v0 offset:46272
    s_waitcnt lgkmcnt(12)
    v_mfma_f32_32x32x16_bf16 v[96:111], v[36:39], v[244:247], v[96:111]
    ds_read_b64_tr_b16 v[32:33], v5 offset:192
    ds_read_b64_tr_b16 v[34:35], v5 offset:6336
    s_waitcnt lgkmcnt(12)
    v_mfma_f32_32x32x16_bf16 v[96:111], v[40:43], v[248:251], v[96:111]
    ds_read_b64_tr_b16 v[36:37], v5 offset:3264
    ds_read_b64_tr_b16 v[38:39], v5 offset:9408
    s_waitcnt lgkmcnt(12)
    v_mfma_f32_32x32x16_bf16 v[96:111], v[44:47], v[252:255], v[96:111]
    ds_read_b64_tr_b16 v[40:41], v5 offset:12480
    ds_read_b64_tr_b16 v[42:43], v5 offset:18624
    s_waitcnt lgkmcnt(12)
    v_mfma_f32_32x32x16_bf16 v[112:127], v[16:19], v[192:195], v[112:127]
    ds_read_b64_tr_b16 v[44:45], v5 offset:15552
    ds_read_b64_tr_b16 v[46:47], v5 offset:21696
    s_waitcnt lgkmcnt(12)
    v_mfma_f32_32x32x16_bf16 v[112:127], v[20:23], v[196:199], v[112:127]
    ds_read_b64_tr_b16 v[16:17], v5 offset:24768
    ds_read_b64_tr_b16 v[18:19], v5 offset:30912
    s_waitcnt lgkmcnt(12)
    v_mfma_f32_32x32x16_bf16 v[112:127], v[24:27], v[200:203], v[112:127]
    ds_read_b64_tr_b16 v[20:21], v5 offset:27840
    ds_read_b64_tr_b16 v[22:23], v5 offset:33984
    s_waitcnt lgkmcnt(12)
    v_mfma_f32_32x32x16_bf16 v[112:127], v[28:31], v[204:207], v[112:127]
    ds_read_b64_tr_b16 v[24:25], v5 offset:37056
    ds_read_b64_tr_b16 v[26:27], v5 offset:43200
    v_cvt_pk_bf16_f32 v176, v96, v97
    v_cvt_pk_bf16_f32 v177, v98, v99
    v_cvt_pk_bf16_f32 v178, v100, v101
    v_cvt_pk_bf16_f32 v179, v102, v103
    s_add_u32 s51, s55, 4096
    buffer_store_dwordx4 v[176:179], v7, s[20:23], s51 offen sc1
    v_cvt_pk_bf16_f32 v180, v104, v105
    v_cvt_pk_bf16_f32 v181, v106, v107
    v_cvt_pk_bf16_f32 v182, v108, v109
    v_cvt_pk_bf16_f32 v183, v110, v111
    s_add_u32 s51, s55, 5120
    buffer_store_dwordx4 v[180:183], v7, s[20:23], s51 offen sc1
    s_waitcnt lgkmcnt(12)
    v_mfma_f32_32x32x16_bf16 v[112:127], v[32:35], v[208:211], v[112:127]
    ds_read_b64_tr_b16 v[28:29], v5 offset:40128
    ds_read_b64_tr_b16 v[30:31], v5 offset:46272
    s_waitcnt lgkmcnt(12)
    v_mfma_f32_32x32x16_bf16 v[112:127], v[36:39], v[212:215], v[112:127]
    ds_read_b64_tr_b16 v[32:33], v0 offset:192
    ds_read_b64_tr_b16 v[34:35], v0 offset:6336
    s_waitcnt lgkmcnt(12)
    v_mfma_f32_32x32x16_bf16 v[112:127], v[40:43], v[216:219], v[112:127]
    ds_read_b64_tr_b16 v[36:37], v0 offset:3264
    ds_read_b64_tr_b16 v[38:39], v0 offset:9408
    s_waitcnt lgkmcnt(12)
    v_mfma_f32_32x32x16_bf16 v[112:127], v[44:47], v[220:223], v[112:127]
    ds_read_b64_tr_b16 v[40:41], v0 offset:12480
    ds_read_b64_tr_b16 v[42:43], v0 offset:18624
    s_waitcnt lgkmcnt(12)
    v_mfma_f32_32x32x16_bf16 v[112:127], v[16:19], v[224:227], v[112:127]
    ds_read_b64_tr_b16 v[44:45], v0 offset:15552
    ds_read_b64_tr_b16 v[46:47], v0 offset:21696
    s_waitcnt lgkmcnt(12)
    v_mfma_f32_32x32x16_bf16 v[112:127], v[20:23], v[228:231], v[112:127]
    ds_read_b64_tr_b16 v[16:17], v6 offset:24832
    ds_read_b64_tr_b16 v[18:19], v6 offset:30976
    s_waitcnt lgkmcnt(12)
    v_mfma_f32_32x32x16_bf16 v[112:127], v[24:27], v[232:235], v[112:127]
    ds_read_b64_tr_b16 v[20:21], v6 offset:27904
    ds_read_b64_tr_b16 v[22:23], v6 offset:34048
    s_waitcnt lgkmcnt(12)
    v_mfma_f32_32x32x16_bf16 v[112:127], v[28:31], v[236:239], v[112:127]
    ds_read_b64_tr_b16 v[24:25], v6 offset:37120
    ds_read_b64_tr_b16 v[26:27], v6 offset:43264
    s_waitcnt lgkmcnt(12)
    v_mfma_f32_32x32x16_bf16 v[112:127], v[32:35], v[240:243], v[112:127]
    ds_read_b64_tr_b16 v[28:29], v6 offset:40192
    ds_read_b64_tr_b16 v[30:31], v6 offset:46336
    s_waitcnt lgkmcnt(12)
    v_mfma_f32_32x32x16_bf16 v[112:127], v[36:39], v[244:247], v[112:127]
    ds_read_b64_tr_b16 v[32:33], v4 offset:256
    ds_read_b64_tr_b16 v[34:35], v4 offset:6400
    s_waitcnt lgkmcnt(12)
    v_mfma_f32_32x32x16_bf16 v[112:127], v[40:43], v[248:251], v[112:127]
    ds_read_b64_tr_b16 v[36:37], v4 offset:3328
    ds_read_b64_tr_b16 v[38:39], v4 offset:9472
    s_waitcnt lgkmcnt(12)
    v_mfma_f32_32x32x16_bf16 v[112:127], v[44:47], v[252:255], v[112:127]
    ds_read_b64_tr_b16 v[40:41], v4 offset:12544
    ds_read_b64_tr_b16 v[42:43], v4 offset:18688
    s_waitcnt lgkmcnt(12)
    v_mfma_f32_32x32x16_bf16 v[128:143], v[16:19], v[192:195], v[128:143]
    ds_read_b64_tr_b16 v[44:45], v4 offset:15616
    ds_read_b64_tr_b16 v[46:47], v4 offset:21760
    s_waitcnt lgkmcnt(12)
    v_mfma_f32_32x32x16_bf16 v[128:143], v[20:23], v[196:199], v[128:143]
    ds_read_b64_tr_b16 v[16:17], v4 offset:24832
    ds_read_b64_tr_b16 v[18:19], v4 offset:30976
    s_waitcnt lgkmcnt(12)
    v_mfma_f32_32x32x16_bf16 v[128:143], v[24:27], v[200:203], v[128:143]
    ds_read_b64_tr_b16 v[20:21], v4 offset:27904
    ds_read_b64_tr_b16 v[22:23], v4 offset:34048
    s_waitcnt lgkmcnt(12)
    v_mfma_f32_32x32x16_bf16 v[128:143], v[28:31], v[204:207], v[128:143]
    ds_read_b64_tr_b16 v[24:25], v4 offset:37120
    ds_read_b64_tr_b16 v[26:27], v4 offset:43264
    v_cvt_pk_bf16_f32 v184, v112, v113
    v_cvt_pk_bf16_f32 v185, v114, v115
    v_cvt_pk_bf16_f32 v186, v116, v117
    v_cvt_pk_bf16_f32 v187, v118, v119
    s_add_u32 s51, s55, 6144
    buffer_store_dwordx4 v[184:187], v7, s[20:23], s51 offen sc1
    v_cvt_pk_bf16_f32 v188, v120, v121
    v_cvt_pk_bf16_f32 v189, v122, v123
    v_cvt_pk_bf16_f32 v190, v124, v125
    v_cvt_pk_bf16_f32 v191, v126, v127
    s_add_u32 s51, s55, 7168
    buffer_store_dwordx4 v[188:191], v7, s[20:23], s51 offen sc1
    s_waitcnt lgkmcnt(12)
    v_mfma_f32_32x32x16_bf16 v[128:143], v[32:35], v[208:211], v[128:143]
    ds_read_b64_tr_b16 v[28:29], v4 offset:40192
    ds_read_b64_tr_b16 v[30:31], v4 offset:46336
    s_waitcnt lgkmcnt(12)
    v_mfma_f32_32x32x16_bf16 v[128:143], v[36:39], v[212:215], v[128:143]
    ds_read_b64_tr_b16 v[32:33], v6 offset:256
    ds_read_b64_tr_b16 v[34:35], v6 offset:6400
    s_waitcnt lgkmcnt(12)
    v_mfma_f32_32x32x16_bf16 v[128:143], v[40:43], v[216:219], v[128:143]
    ds_read_b64_tr_b16 v[36:37], v6 offset:3328
    ds_read_b64_tr_b16 v[38:39], v6 offset:9472
    s_waitcnt lgkmcnt(12)
    v_mfma_f32_32x32x16_bf16 v[128:143], v[44:47], v[220:223], v[128:143]
    ds_read_b64_tr_b16 v[40:41], v6 offset:12544
    ds_read_b64_tr_b16 v[42:43], v6 offset:18688
    s_waitcnt lgkmcnt(12)
    v_mfma_f32_32x32x16_bf16 v[128:143], v[16:19], v[224:227], v[128:143]
    ds_read_b64_tr_b16 v[44:45], v6 offset:15616
    ds_read_b64_tr_b16 v[46:47], v6 offset:21760
    s_waitcnt vmcnt(4)
    v_mov_b32 v60, 1
    v_mov_b32 v61, 1
    v_mov_b32 v62, 1
    v_mov_b32 v63, 1
    s_add_u32 s51, s97, 0
    s_mov_b64 exec, 0xff
    buffer_store_dwordx4 v[60:63], v7, s[20:23], s51 offen sc1
    s_mov_b64 exec, -1
    s_nop 0
    s_waitcnt lgkmcnt(12)
    v_mfma_f32_32x32x16_bf16 v[128:143], v[20:23], v[228:231], v[128:143]
    ds_read_b64_tr_b16 v[16:17], v0 offset:24896
    ds_read_b64_tr_b16 v[18:19], v0 offset:31040
    s_waitcnt lgkmcnt(12)
    v_mfma_f32_32x32x16_bf16 v[128:143], v[24:27], v[232:235], v[128:143]
    ds_read_b64_tr_b16 v[20:21], v0 offset:27968
    ds_read_b64_tr_b16 v[22:23], v0 offset:34112
    s_waitcnt lgkmcnt(12)
    v_mfma_f32_32x32x16_bf16 v[128:143], v[28:31], v[236:239], v[128:143]
    ds_read_b64_tr_b16 v[24:25], v0 offset:37184
    ds_read_b64_tr_b16 v[26:27], v0 offset:43328
    s_waitcnt lgkmcnt(12)
    v_mfma_f32_32x32x16_bf16 v[128:143], v[32:35], v[240:243], v[128:143]
    ds_read_b64_tr_b16 v[28:29], v0 offset:40256
    ds_read_b64_tr_b16 v[30:31], v0 offset:46400
    s_waitcnt lgkmcnt(12)
    v_mfma_f32_32x32x16_bf16 v[128:143], v[36:39], v[244:247], v[128:143]
    ds_read_b64_tr_b16 v[32:33], v5 offset:320
    ds_read_b64_tr_b16 v[34:35], v5 offset:6464
    s_waitcnt lgkmcnt(12)
    v_mfma_f32_32x32x16_bf16 v[128:143], v[40:43], v[248:251], v[128:143]
    ds_read_b64_tr_b16 v[36:37], v5 offset:3392
    ds_read_b64_tr_b16 v[38:39], v5 offset:9536
    s_waitcnt lgkmcnt(12)
    v_mfma_f32_32x32x16_bf16 v[128:143], v[44:47], v[252:255], v[128:143]
    ds_read_b64_tr_b16 v[40:41], v5 offset:12608
    ds_read_b64_tr_b16 v[42:43], v5 offset:18752
    s_waitcnt lgkmcnt(12)
    v_mfma_f32_32x32x16_bf16 v[144:159], v[16:19], v[192:195], v[144:159]
    ds_read_b64_tr_b16 v[44:45], v5 offset:15680
    ds_read_b64_tr_b16 v[46:47], v5 offset:21824
    s_waitcnt lgkmcnt(12)
    v_mfma_f32_32x32x16_bf16 v[144:159], v[20:23], v[196:199], v[144:159]
    ds_read_b64_tr_b16 v[16:17], v5 offset:24896
    ds_read_b64_tr_b16 v[18:19], v5 offset:31040
    s_waitcnt lgkmcnt(12)
    v_mfma_f32_32x32x16_bf16 v[144:159], v[24:27], v[200:203], v[144:159]
    ds_read_b64_tr_b16 v[20:21], v5 offset:27968
    ds_read_b64_tr_b16 v[22:23], v5 offset:34112
    s_waitcnt lgkmcnt(12)
    v_mfma_f32_32x32x16_bf16 v[144:159], v[28:31], v[204:207], v[144:159]
    ds_read_b64_tr_b16 v[24:25], v5 offset:37184
    ds_read_b64_tr_b16 v[26:27], v5 offset:43328
    v_cvt_pk_bf16_f32 v160, v128, v129
    v_cvt_pk_bf16_f32 v161, v130, v131
    v_cvt_pk_bf16_f32 v162, v132, v133
    v_cvt_pk_bf16_f32 v163, v134, v135
    s_add_u32 s51, s55, 8192
    buffer_store_dwordx4 v[160:163], v7, s[20:23], s51 offen sc1
    v_cvt_pk_bf16_f32 v164, v136, v137
    v_cvt_pk_bf16_f32 v165, v138, v139
    v_cvt_pk_bf16_f32 v166, v140, v141
    v_cvt_pk_bf16_f32 v167, v142, v143
    s_add_u32 s51, s55, 9216
    buffer_store_dwordx4 v[164:167], v7, s[20:23], s51 offen sc1
    s_waitcnt lgkmcnt(12)
    v_mfma_f32_32x32x16_bf16 v[144:159], v[32:35], v[208:211], v[144:159]
    ds_read_b64_tr_b16 v[28:29], v5 offset:40256
    ds_read_b64_tr_b16 v[30:31], v5 offset:46400
    s_waitcnt lgkmcnt(12)
    v_mfma_f32_32x32x16_bf16 v[144:159], v[36:39], v[212:215], v[144:159]
    ds_read_b64_tr_b16 v[32:33], v0 offset:320
    ds_read_b64_tr_b16 v[34:35], v0 offset:6464
    s_waitcnt lgkmcnt(12)
    v_mfma_f32_32x32x16_bf16 v[144:159], v[40:43], v[216:219], v[144:159]
    ds_read_b64_tr_b16 v[36:37], v0 offset:3392
    ds_read_b64_tr_b16 v[38:39], v0 offset:9536
    s_waitcnt lgkmcnt(12)
    v_mfma_f32_32x32x16_bf16 v[144:159], v[44:47], v[220:223], v[144:159]
    ds_read_b64_tr_b16 v[40:41], v0 offset:12608
    ds_read_b64_tr_b16 v[42:43], v0 offset:18752
    s_waitcnt lgkmcnt(12)
    v_mfma_f32_32x32x16_bf16 v[144:159], v[16:19], v[224:227], v[144:159]
    ds_read_b64_tr_b16 v[44:45], v0 offset:15680
    ds_read_b64_tr_b16 v[46:47], v0 offset:21824
    s_waitcnt lgkmcnt(12)
    v_mfma_f32_32x32x16_bf16 v[144:159], v[20:23], v[228:231], v[144:159]
    s_waitcnt lgkmcnt(10)
    v_mfma_f32_32x32x16_bf16 v[144:159], v[24:27], v[232:235], v[144:159]
    s_waitcnt lgkmcnt(8)
    v_mfma_f32_32x32x16_bf16 v[144:159], v[28:31], v[236:239], v[144:159]
    s_waitcnt lgkmcnt(6)
    v_mfma_f32_32x32x16_bf16 v[144:159], v[32:35], v[240:243], v[144:159]
    s_waitcnt lgkmcnt(4)
    v_mfma_f32_32x32x16_bf16 v[144:159], v[36:39], v[244:247], v[144:159]
    s_waitcnt lgkmcnt(2)
    v_mfma_f32_32x32x16_bf16 v[144:159], v[40:43], v[248:251], v[144:159]
    s_waitcnt vmcnt(3)
    v_mov_b32 v60, 1
    v_mov_b32 v61, 1
    v_mov_b32 v62, 1
    v_mov_b32 v63, 1
    s_add_u32 s51, s97, 512
    s_mov_b64 exec, 0xff
    buffer_store_dwordx4 v[60:63], v7, s[20:23], s51 offen sc1
    s_mov_b64 exec, -1
    s_nop 0
    s_waitcnt lgkmcnt(0)
    v_mfma_f32_32x32x16_bf16 v[144:159], v[44:47], v[252:255], v[144:159]
    s_nop 7
    s_nop 3
    v_cvt_pk_bf16_f32 v168, v144, v145
    v_cvt_pk_bf16_f32 v169, v146, v147
    v_cvt_pk_bf16_f32 v170, v148, v149
    v_cvt_pk_bf16_f32 v171, v150, v151
    s_add_u32 s51, s55, 10240
    buffer_store_dwordx4 v[168:171], v7, s[20:23], s51 offen sc1
    v_cvt_pk_bf16_f32 v172, v152, v153
    v_cvt_pk_bf16_f32 v173, v154, v155
    v_cvt_pk_bf16_f32 v174, v156, v157
    v_cvt_pk_bf16_f32 v175, v158, v159
    s_add_u32 s51, s55, 11264
    buffer_store_dwordx4 v[172:175], v7, s[20:23], s51 offen sc1
    s_waitcnt vmcnt(0)
    v_mov_b32 v60, 1
    v_mov_b32 v61, 1
    v_mov_b32 v62, 1
    v_mov_b32 v63, 1
    s_add_u32 s51, s97, 1024
    s_mov_b64 exec, 0xff
    buffer_store_dwordx4 v[60:63], v7, s[20:23], s51 offen sc1
    s_mov_b64 exec, -1
    s_nop 0
    s_branch L_end
L_Y2:
    v_mul_f32 v16, s49, v64
    v_mul_f32 v17, s49, v65
    v_mul_f32 v18, s49, v66
    v_mul_f32 v19, s49, v67
    v_mul_f32 v20, s49, v96
    v_mul_f32 v21, s49, v97
    v_mul_f32 v22, s49, v98
    v_mul_f32 v23, s49, v99
    v_exp_f32 v16, v16
    v_exp_f32 v17, v17
    v_exp_f32 v18, v18
    v_exp_f32 v19, v19
    v_exp_f32 v20, v20
    v_exp_f32 v21, v21
    v_exp_f32 v22, v22
    v_exp_f32 v23, v23
    v_add_f32 v16, 1.0, v16
    v_add_f32 v17, 1.0, v17
    v_add_f32 v18, 1.0, v18
    v_add_f32 v19, 1.0, v19
    v_add_f32 v20, 1.0, v20
    v_add_f32 v21, 1.0, v21
    v_add_f32 v22, 1.0, v22
    v_add_f32 v23, 1.0, v23
    v_rcp_f32 v16, v16
    v_rcp_f32 v17, v17
    v_rcp_f32 v18, v18
    v_rcp_f32 v19, v19
    v_rcp_f32 v20, v20
    v_rcp_f32 v21, v21
    v_rcp_f32 v22, v22
    v_rcp_f32 v23, v23
    v_mul_f32 v16, v80, v16
    v_mul_f32 v17, v81, v17
    v_mul_f32 v18, v82, v18
    v_mul_f32 v19, v83, v19
    v_mul_f32 v20, v112, v20
    v_mul_f32 v21, v113, v21
    v_mul_f32 v22, v114, v22
    v_mul_f32 v23, v115, v23
    v_cvt_pk_bf16_f32 v40, v16, v17
    v_cvt_pk_bf16_f32 v41, v18, v19
    v_cvt_pk_bf16_f32 v42, v20, v21
    v_cvt_pk_bf16_f32 v43, v22, v23
    s_add_u32 s51, s48, 49152
    buffer_store_dwordx4 v[40:43], v7, s[20:23], s51 offen sc1
    v_mul_f32 v16, s49, v68
    v_mul_f32 v17, s49, v69
    v_mul_f32 v18, s49, v70
    v_mul_f32 v19, s49, v71
    v_mul_f32 v20, s49, v100
    v_mul_f32 v21, s49, v101
    v_mul_f32 v22, s49, v102
    v_mul_f32 v23, s49, v103
    v_exp_f32 v16, v16
    v_exp_f32 v17, v17
    v_exp_f32 v18, v18
    v_exp_f32 v19, v19
    v_exp_f32 v20, v20
    v_exp_f32 v21, v21
    v_exp_f32 v22, v22
    v_exp_f32 v23, v23
    v_add_f32 v16, 1.0, v16
    v_add_f32 v17, 1.0, v17
    v_add_f32 v18, 1.0, v18
    v_add_f32 v19, 1.0, v19
    v_add_f32 v20, 1.0, v20
    v_add_f32 v21, 1.0, v21
    v_add_f32 v22, 1.0, v22
    v_add_f32 v23, 1.0, v23
    v_rcp_f32 v16, v16
    v_rcp_f32 v17, v17
    v_rcp_f32 v18, v18
    v_rcp_f32 v19, v19
    v_rcp_f32 v20, v20
    v_rcp_f32 v21, v21
    v_rcp_f32 v22, v22
    v_rcp_f32 v23, v23
    v_mul_f32 v16, v84, v16
    v_mul_f32 v17, v85, v17
    v_mul_f32 v18, v86, v18
    v_mul_f32 v19, v87, v19
    v_mul_f32 v20, v116, v20
    v_mul_f32 v21, v117, v21
    v_mul_f32 v22, v118, v22
    v_mul_f32 v23, v119, v23
    v_cvt_pk_bf16_f32 v44, v16, v17
    v_cvt_pk_bf16_f32 v45, v18, v19
    v_cvt_pk_bf16_f32 v46, v20, v21
    v_cvt_pk_bf16_f32 v47, v22, v23
    s_add_u32 s51, s48, 50176
    buffer_store_dwordx4 v[44:47], v7, s[20:23], s51 offen sc1
    s_barrier
    v_mul_f32 v16, s49, v72
    v_mul_f32 v17, s49, v73
    v_mul_f32 v18, s49, v74
    v_mul_f32 v19, s49, v75
    v_mul_f32 v20, s49, v104
    v_mul_f32 v21, s49, v105
    v_mul_f32 v22, s49, v106
    v_mul_f32 v23, s49, v107
    v_exp_f32 v16, v16
    v_exp_f32 v17, v17
    v_exp_f32 v18, v18
    v_exp_f32 v19, v19
    v_exp_f32 v20, v20
    v_exp_f32 v21, v21
    v_exp_f32 v22, v22
    v_exp_f32 v23, v23
    v_add_f32 v16, 1.0, v16
    v_add_f32 v17, 1.0, v17
    v_add_f32 v18, 1.0, v18
    v_add_f32 v19, 1.0, v19
    v_add_f32 v20, 1.0, v20
    v_add_f32 v21, 1.0, v21
    v_add_f32 v22, 1.0, v22
    v_add_f32 v23, 1.0, v23
    v_rcp_f32 v16, v16
    v_rcp_f32 v17, v17
    v_rcp_f32 v18, v18
    v_rcp_f32 v19, v19
    v_rcp_f32 v20, v20
    v_rcp_f32 v21, v21
    v_rcp_f32 v22, v22
    v_rcp_f32 v23, v23
    v_mul_f32 v16, v88, v16
    v_mul_f32 v17, v89, v17
    v_mul_f32 v18, v90, v18
    v_mul_f32 v19, v91, v19
    v_mul_f32 v20, v120, v20
    v_mul_f32 v21, v121, v21
    v_mul_f32 v22, v122, v22
    v_mul_f32 v23, v123, v23
    v_cvt_pk_bf16_f32 v48, v16, v17
    v_cvt_pk_bf16_f32 v49, v18, v19
    v_cvt_pk_bf16_f32 v50, v20, v21
    v_cvt_pk_bf16_f32 v51, v22, v23
    s_add_u32 s51, s48, 51200
    buffer_store_dwordx4 v[48:51], v7, s[20:23], s51 offen sc1
    v_mul_f32 v16, s49, v76
    v_mul_f32 v17, s49, v77
    v_mul_f32 v18, s49, v78
    v_mul_f32 v19, s49, v79
    v_mul_f32 v20, s49, v108
    v_mul_f32 v21, s49, v109
    v_mul_f32 v22, s49, v110
    v_mul_f32 v23, s49, v111
    v_exp_f32 v16, v16
    v_exp_f32 v17, v17
    v_exp_f32 v18, v18
    v_exp_f32 v19, v19
    v_exp_f32 v20, v20
    v_exp_f32 v21, v21
    v_exp_f32 v22, v22
    v_exp_f32 v23, v23
    v_add_f32 v16, 1.0, v16
    v_add_f32 v17, 1.0, v17
    v_add_f32 v18, 1.0, v18
    v_add_f32 v19, 1.0, v19
    v_add_f32 v20, 1.0, v20
    v_add_f32 v21, 1.0, v21
    v_add_f32 v22, 1.0, v22
    v_add_f32 v23, 1.0, v23
    v_rcp_f32 v16, v16
    v_rcp_f32 v17, v17
    v_rcp_f32 v18, v18
    v_rcp_f32 v19, v19
    v_rcp_f32 v20, v20
    v_rcp_f32 v21, v21
    v_rcp_f32 v22, v22
    v_rcp_f32 v23, v23
    v_mul_f32 v16, v92, v16
    v_mul_f32 v17, v93, v17
    v_mul_f32 v18, v94, v18
    v_mul_f32 v19, v95, v19
    v_mul_f32 v20, v124, v20
    v_mul_f32 v21, v125, v21
    v_mul_f32 v22, v126, v22
    v_mul_f32 v23, v127, v23
    v_cvt_pk_bf16_f32 v52, v16, v17
    v_cvt_pk_bf16_f32 v53, v18, v19
    v_cvt_pk_bf16_f32 v54, v20, v21
    v_cvt_pk_bf16_f32 v55, v22, v23
    s_add_u32 s51, s48, 52224
    buffer_store_dwordx4 v[52:55], v7, s[20:23], s51 offen sc1
    s_barrier
    v_lshlrev_b32 v56, 5, v1
    v_add_u32 v56, 160928, v56
    ds_read_b128 v[8:11], v56
    ds_read_b128 v[12:15], v56 offset:16
    v_lshlrev_b32 v59, 2, v1
    s_waitcnt lgkmcnt(0)
    s_add_u32 m0, s58, 0x6000
    s_add_u32 s50, s89, 0x12000
    buffer_load_dwordx4 v13, s[16:19], s50 offen lds
    s_add_u32 m0, s58, 0x6400
    s_add_u32 s50, s89, 0x12000
    buffer_load_dwordx4 v14, s[16:19], s50 offen lds
    s_add_u32 m0, s58, 0x6800
    s_add_u32 s50, s89, 0x12000
    buffer_load_dwordx4 v15, s[16:19], s50 offen lds
    s_add_u32 m0, s58, 0x6c00
    s_add_u32 s50, s89, 0x14400
    buffer_load_dwordx4 v13, s[16:19], s50 offen lds
    s_add_u32 m0, s58, 0x7000
    s_add_u32 s50, s89, 0x14400
    buffer_load_dwordx4 v14, s[16:19], s50 offen lds
    s_add_u32 m0, s58, 0x7400
    s_add_u32 s50, s89, 0x14400
    buffer_load_dwordx4 v15, s[16:19], s50 offen lds
    v_mul_f32 v16, s49, v128
    v_mul_f32 v17, s49, v129
    v_mul_f32 v18, s49, v130
    v_mul_f32 v19, s49, v131
    v_mul_f32 v20, s49, v160
    v_mul_f32 v21, s49, v161
    v_mul_f32 v22, s49, v162
    v_mul_f32 v23, s49, v163
    v_exp_f32 v16, v16
    v_exp_f32 v17, v17
    v_exp_f32 v18, v18
    v_exp_f32 v19, v19
    v_exp_f32 v20, v20
    v_exp_f32 v21, v21
    v_exp_f32 v22, v22
    v_exp_f32 v23, v23
    v_add_f32 v16, 1.0, v16
    v_add_f32 v17, 1.0, v17
    v_add_f32 v18, 1.0, v18
    v_add_f32 v19, 1.0, v19
    v_add_f32 v20, 1.0, v20
    v_add_f32 v21, 1.0, v21
    v_add_f32 v22, 1.0, v22
    v_add_f32 v23, 1.0, v23
    v_rcp_f32 v16, v16
    v_rcp_f32 v17, v17
    v_rcp_f32 v18, v18
    v_rcp_f32 v19, v19
    v_rcp_f32 v20, v20
    v_rcp_f32 v21, v21
    v_rcp_f32 v22, v22
    v_rcp_f32 v23, v23
    v_mul_f32 v16, v144, v16
    v_mul_f32 v17, v145, v17
    v_mul_f32 v18, v146, v18
    v_mul_f32 v19, v147, v19
    v_mul_f32 v20, v176, v20
    v_mul_f32 v21, v177, v21
    v_mul_f32 v22, v178, v22
    v_mul_f32 v23, v179, v23
    v_cvt_pk_bf16_f32 v40, v16, v17
    v_cvt_pk_bf16_f32 v41, v18, v19
    v_cvt_pk_bf16_f32 v42, v20, v21
    v_cvt_pk_bf16_f32 v43, v22, v23
    s_add_u32 s51, s48, 65536
    buffer_store_dwordx4 v[40:43], v7, s[20:23], s51 offen sc1
    v_mul_f32 v16, s49, v132
    v_mul_f32 v17, s49, v133
    v_mul_f32 v18, s49, v134
    v_mul_f32 v19, s49, v135
    v_mul_f32 v20, s49, v164
    v_mul_f32 v21, s49, v165
    v_mul_f32 v22, s49, v166
    v_mul_f32 v23, s49, v167
    v_exp_f32 v16, v16
    v_exp_f32 v17, v17
    v_exp_f32 v18, v18
    v_exp_f32 v19, v19
    v_exp_f32 v20, v20
    v_exp_f32 v21, v21
    v_exp_f32 v22, v22
    v_exp_f32 v23, v23
    v_add_f32 v16, 1.0, v16
    v_add_f32 v17, 1.0, v17
    v_add_f32 v18, 1.0, v18
    v_add_f32 v19, 1.0, v19
    v_add_f32 v20, 1.0, v20
    v_add_f32 v21, 1.0, v21
    v_add_f32 v22, 1.0, v22
    v_add_f32 v23, 1.0, v23
    v_rcp_f32 v16, v16
    v_rcp_f32 v17, v17
    v_rcp_f32 v18, v18
    v_rcp_f32 v19, v19
    v_rcp_f32 v20, v20
    v_rcp_f32 v21, v21
    v_rcp_f32 v22, v22
    v_rcp_f32 v23, v23
    v_mul_f32 v16, v148, v16
    v_mul_f32 v17, v149, v17
    v_mul_f32 v18, v150, v18
    v_mul_f32 v19, v151, v19
    v_mul_f32 v20, v180, v20
    v_mul_f32 v21, v181, v21
    v_mul_f32 v22, v182, v22
    v_mul_f32 v23, v183, v23
    v_cvt_pk_bf16_f32 v44, v16, v17
    v_cvt_pk_bf16_f32 v45, v18, v19
    v_cvt_pk_bf16_f32 v46, v20, v21
    v_cvt_pk_bf16_f32 v47, v22, v23
    s_add_u32 s51, s48, 66560
    buffer_store_dwordx4 v[44:47], v7, s[20:23], s51 offen sc1
    s_waitcnt vmcnt(8)
    v_mov_b32 v60, 1
    v_mov_b32 v61, 1
    v_mov_b32 v62, 1
    v_mov_b32 v63, 1
    s_add_u32 s51, s99, 1536
    s_mov_b64 exec, 0xff
    buffer_store_dwordx4 v[60:63], v7, s[20:23], s51 offen sc1
    s_mov_b64 exec, -1
    s_nop 0
    s_barrier
    s_add_u32 m0, s58, 0x1e000
    s_add_u32 s50, s90, 0x12000
    buffer_load_dwordx4 v13, s[16:19], s50 offen lds
    s_add_u32 m0, s58, 0x1e400
    s_add_u32 s50, s90, 0x12000
    buffer_load_dwordx4 v14, s[16:19], s50 offen lds
    s_add_u32 m0, s58, 0x1e800
    s_add_u32 s50, s90, 0x12000
    buffer_load_dwordx4 v15, s[16:19], s50 offen lds
    s_add_u32 m0, s58, 0x1ec00
    s_add_u32 s50, s90, 0x14400
    buffer_load_dwordx4 v13, s[16:19], s50 offen lds
    s_add_u32 m0, s58, 0x1f000
    s_add_u32 s50, s90, 0x14400
    buffer_load_dwordx4 v14, s[16:19], s50 offen lds
    s_add_u32 m0, s58, 0x1f400
    s_add_u32 s50, s90, 0x14400
    buffer_load_dwordx4 v15, s[16:19], s50 offen lds
    v_mul_f32 v16, s49, v136
    v_mul_f32 v17, s49, v137
    v_mul_f32 v18, s49, v138
    v_mul_f32 v19, s49, v139
    v_mul_f32 v20, s49, v168
    v_mul_f32 v21, s49, v169
    v_mul_f32 v22, s49, v170
    v_mul_f32 v23, s49, v171
    v_exp_f32 v16, v16
    v_exp_f32 v17, v17
    v_exp_f32 v18, v18
    v_exp_f32 v19, v19
    v_exp_f32 v20, v20
    v_exp_f32 v21, v21
    v_exp_f32 v22, v22
    v_exp_f32 v23, v23
    v_add_f32 v16, 1.0, v16
    v_add_f32 v17, 1.0, v17
    v_add_f32 v18, 1.0, v18
    v_add_f32 v19, 1.0, v19
    v_add_f32 v20, 1.0, v20
    v_add_f32 v21, 1.0, v21
    v_add_f32 v22, 1.0, v22
    v_add_f32 v23, 1.0, v23
    v_rcp_f32 v16, v16
    v_rcp_f32 v17, v17
    v_rcp_f32 v18, v18
    v_rcp_f32 v19, v19
    v_rcp_f32 v20, v20
    v_rcp_f32 v21, v21
    v_rcp_f32 v22, v22
    v_rcp_f32 v23, v23
    v_mul_f32 v16, v152, v16
    v_mul_f32 v17, v153, v17
    v_mul_f32 v18, v154, v18
    v_mul_f32 v19, v155, v19
    v_mul_f32 v20, v184, v20
    v_mul_f32 v21, v185, v21
    v_mul_f32 v22, v186, v22
    v_mul_f32 v23, v187, v23
    v_cvt_pk_bf16_f32 v48, v16, v17
    v_cvt_pk_bf16_f32 v49, v18, v19
    v_cvt_pk_bf16_f32 v50, v20, v21
    v_cvt_pk_bf16_f32 v51, v22, v23
    s_add_u32 s51, s48, 67584
    buffer_store_dwordx4 v[48:51], v7, s[20:23], s51 offen sc1
    v_mul_f32 v16, s49, v140
    v_mul_f32 v17, s49, v141
    v_mul_f32 v18, s49, v142
    v_mul_f32 v19, s49, v143
    v_mul_f32 v20, s49, v172
    v_mul_f32 v21, s49, v173
    v_mul_f32 v22, s49, v174
    v_mul_f32 v23, s49, v175
    v_exp_f32 v16, v16
    v_exp_f32 v17, v17
    v_exp_f32 v18, v18
    v_exp_f32 v19, v19
    v_exp_f32 v20, v20
    v_exp_f32 v21, v21
    v_exp_f32 v22, v22
    v_exp_f32 v23, v23
    v_add_f32 v16, 1.0, v16
    v_add_f32 v17, 1.0, v17
    v_add_f32 v18, 1.0, v18
    v_add_f32 v19, 1.0, v19
    v_add_f32 v20, 1.0, v20
    v_add_f32 v21, 1.0, v21
    v_add_f32 v22, 1.0, v22
    v_add_f32 v23, 1.0, v23
    v_rcp_f32 v16, v16
    v_rcp_f32 v17, v17
    v_rcp_f32 v18, v18
    v_rcp_f32 v19, v19
    v_rcp_f32 v20, v20
    v_rcp_f32 v21, v21
    v_rcp_f32 v22, v22
    v_rcp_f32 v23, v23
    v_mul_f32 v16, v156, v16
    v_mul_f32 v17, v157, v17
    v_mul_f32 v18, v158, v18
    v_mul_f32 v19, v159, v19
    v_mul_f32 v20, v188, v20
    v_mul_f32 v21, v189, v21
    v_mul_f32 v22, v190, v22
    v_mul_f32 v23, v191, v23
    v_cvt_pk_bf16_f32 v52, v16, v17
    v_cvt_pk_bf16_f32 v53, v18, v19
    v_cvt_pk_bf16_f32 v54, v20, v21
    v_cvt_pk_bf16_f32 v55, v22, v23
    s_add_u32 s51, s48, 68608
    buffer_store_dwordx4 v[52:55], v7, s[20:23], s51 offen sc1
    s_barrier
    s_add_u32 m0, s58, 0xc000
    s_add_u32 s50, s88, 0x1b000
    buffer_load_dwordx4 v13, s[16:19], s50 offen lds
    s_add_u32 m0, s58, 0xc400
    s_add_u32 s50, s88, 0x1b000
    buffer_load_dwordx4 v14, s[16:19], s50 offen lds
    s_add_u32 m0, s58, 0xc800
    s_add_u32 s50, s88, 0x1b000
    buffer_load_dwordx4 v15, s[16:19], s50 offen lds
    s_add_u32 m0, s58, 0xcc00
    s_add_u32 s50, s88, 0x1d400
    buffer_load_dwordx4 v13, s[16:19], s50 offen lds
    s_add_u32 m0, s58, 0xd000
    s_add_u32 s50, s88, 0x1d400
    buffer_load_dwordx4 v14, s[16:19], s50 offen lds
    s_add_u32 m0, s58, 0xd400
    s_add_u32 s50, s88, 0x1d400
    buffer_load_dwordx4 v15, s[16:19], s50 offen lds
    v_mul_f32 v16, s49, v192
    v_mul_f32 v17, s49, v193
    v_mul_f32 v18, s49, v194
    v_mul_f32 v19, s49, v195
    v_mul_f32 v20, s49, v224
    v_mul_f32 v21, s49, v225
    v_mul_f32 v22, s49, v226
    v_mul_f32 v23, s49, v227
    v_exp_f32 v16, v16
    v_exp_f32 v17, v17
    v_exp_f32 v18, v18
    v_exp_f32 v19, v19
    v_exp_f32 v20, v20
    v_exp_f32 v21, v21
    v_exp_f32 v22, v22
    v_exp_f32 v23, v23
    v_add_f32 v16, 1.0, v16
    v_add_f32 v17, 1.0, v17
    v_add_f32 v18, 1.0, v18
    v_add_f32 v19, 1.0, v19
    v_add_f32 v20, 1.0, v20
    v_add_f32 v21, 1.0, v21
    v_add_f32 v22, 1.0, v22
    v_add_f32 v23, 1.0, v23
    v_rcp_f32 v16, v16
    v_rcp_f32 v17, v17
    v_rcp_f32 v18, v18
    v_rcp_f32 v19, v19
    v_rcp_f32 v20, v20
    v_rcp_f32 v21, v21
    v_rcp_f32 v22, v22
    v_rcp_f32 v23, v23
    v_mul_f32 v16, v208, v16
    v_mul_f32 v17, v209, v17
    v_mul_f32 v18, v210, v18
    v_mul_f32 v19, v211, v19
    v_mul_f32 v20, v240, v20
    v_mul_f32 v21, v241, v21
    v_mul_f32 v22, v242, v22
    v_mul_f32 v23, v243, v23
    v_cvt_pk_bf16_f32 v40, v16, v17
    v_cvt_pk_bf16_f32 v41, v18, v19
    v_cvt_pk_bf16_f32 v42, v20, v21
    v_cvt_pk_bf16_f32 v43, v22, v23
    s_add_u32 s51, s48, 81920
    buffer_store_dwordx4 v[40:43], v7, s[20:23], s51 offen sc1
    v_mul_f32 v16, s49, v196
    v_mul_f32 v17, s49, v197
    v_mul_f32 v18, s49, v198
    v_mul_f32 v19, s49, v199
    v_mul_f32 v20, s49, v228
    v_mul_f32 v21, s49, v229
    v_mul_f32 v22, s49, v230
    v_mul_f32 v23, s49, v231
    v_exp_f32 v16, v16
    v_exp_f32 v17, v17
    v_exp_f32 v18, v18
    v_exp_f32 v19, v19
    v_exp_f32 v20, v20
    v_exp_f32 v21, v21
    v_exp_f32 v22, v22
    v_exp_f32 v23, v23
    v_add_f32 v16, 1.0, v16
    v_add_f32 v17, 1.0, v17
    v_add_f32 v18, 1.0, v18
    v_add_f32 v19, 1.0, v19
    v_add_f32 v20, 1.0, v20
    v_add_f32 v21, 1.0, v21
    v_add_f32 v22, 1.0, v22
    v_add_f32 v23, 1.0, v23
    v_rcp_f32 v16, v16
    v_rcp_f32 v17, v17
    v_rcp_f32 v18, v18
    v_rcp_f32 v19, v19
    v_rcp_f32 v20, v20
    v_rcp_f32 v21, v21
    v_rcp_f32 v22, v22
    v_rcp_f32 v23, v23
    v_mul_f32 v16, v212, v16
    v_mul_f32 v17, v213, v17
    v_mul_f32 v18, v214, v18
    v_mul_f32 v19, v215, v19
    v_mul_f32 v20, v244, v20
    v_mul_f32 v21, v245, v21
    v_mul_f32 v22, v246, v22
    v_mul_f32 v23, v247, v23
    v_cvt_pk_bf16_f32 v44, v16, v17
    v_cvt_pk_bf16_f32 v45, v18, v19
    v_cvt_pk_bf16_f32 v46, v20, v21
    v_cvt_pk_bf16_f32 v47, v22, v23
    s_add_u32 s51, s48, 82944
    buffer_store_dwordx4 v[44:47], v7, s[20:23], s51 offen sc1
    s_waitcnt vmcnt(8)
    v_mov_b32 v60, 1
    v_mov_b32 v61, 1
    v_mov_b32 v62, 1
    v_mov_b32 v63, 1
    s_add_u32 s51, s99, 3072
    s_mov_b64 exec, 0xff
    buffer_store_dwordx4 v[60:63], v7, s[20:23], s51 offen sc1
    s_mov_b64 exec, -1
    s_nop 0
    s_barrier
    s_add_u32 m0, s58, 0x12000
    s_add_u32 s50, s89, 0x1b000
    buffer_load_dwordx4 v13, s[16:19], s50 offen lds
    s_add_u32 m0, s58, 0x12400
    s_add_u32 s50, s89, 0x1b000
    buffer_load_dwordx4 v14, s[16:19], s50 offen lds
    s_add_u32 m0, s58, 0x12800
    s_add_u32 s50, s89, 0x1b000
    buffer_load_dwordx4 v15, s[16:19], s50 offen lds
    s_add_u32 m0, s58, 0x12c00
    s_add_u32 s50, s89, 0x1d400
    buffer_load_dwordx4 v13, s[16:19], s50 offen lds
    s_add_u32 m0, s58, 0x13000
    s_add_u32 s50, s89, 0x1d400
    buffer_load_dwordx4 v14, s[16:19], s50 offen lds
    s_add_u32 m0, s58, 0x13400
    s_add_u32 s50, s89, 0x1d400
    buffer_load_dwordx4 v15, s[16:19], s50 offen lds
    v_mul_f32 v16, s49, v200
    v_mul_f32 v17, s49, v201
    v_mul_f32 v18, s49, v202
    v_mul_f32 v19, s49, v203
    v_mul_f32 v20, s49, v232
    v_mul_f32 v21, s49, v233
    v_mul_f32 v22, s49, v234
    v_mul_f32 v23, s49, v235
    v_exp_f32 v16, v16
    v_exp_f32 v17, v17
    v_exp_f32 v18, v18
    v_exp_f32 v19, v19
    v_exp_f32 v20, v20
    v_exp_f32 v21, v21
    v_exp_f32 v22, v22
    v_exp_f32 v23, v23
    v_add_f32 v16, 1.0, v16
    v_add_f32 v17, 1.0, v17
    v_add_f32 v18, 1.0, v18
    v_add_f32 v19, 1.0, v19
    v_add_f32 v20, 1.0, v20
    v_add_f32 v21, 1.0, v21
    v_add_f32 v22, 1.0, v22
    v_add_f32 v23, 1.0, v23
    v_rcp_f32 v16, v16
    v_rcp_f32 v17, v17
    v_rcp_f32 v18, v18
    v_rcp_f32 v19, v19
    v_rcp_f32 v20, v20
    v_rcp_f32 v21, v21
    v_rcp_f32 v22, v22
    v_rcp_f32 v23, v23
    v_mul_f32 v16, v216, v16
    v_mul_f32 v17, v217, v17
    v_mul_f32 v18, v218, v18
    v_mul_f32 v19, v219, v19
    v_mul_f32 v20, v248, v20
    v_mul_f32 v21, v249, v21
    v_mul_f32 v22, v250, v22
    v_mul_f32 v23, v251, v23
    v_cvt_pk_bf16_f32 v48, v16, v17
    v_cvt_pk_bf16_f32 v49, v18, v19
    v_cvt_pk_bf16_f32 v50, v20, v21
    v_cvt_pk_bf16_f32 v51, v22, v23
    s_add_u32 s51, s48, 83968
    buffer_store_dwordx4 v[48:51], v7, s[20:23], s51 offen sc1
    v_mul_f32 v16, s49, v204
    v_mul_f32 v17, s49, v205
    v_mul_f32 v18, s49, v206
    v_mul_f32 v19, s49, v207
    v_mul_f32 v20, s49, v236
    v_mul_f32 v21, s49, v237
    v_mul_f32 v22, s49, v238
    v_mul_f32 v23, s49, v239
    v_exp_f32 v16, v16
    v_exp_f32 v17, v17
    v_exp_f32 v18, v18
    v_exp_f32 v19, v19
    v_exp_f32 v20, v20
    v_exp_f32 v21, v21
    v_exp_f32 v22, v22
    v_exp_f32 v23, v23
    v_add_f32 v16, 1.0, v16
    v_add_f32 v17, 1.0, v17
    v_add_f32 v18, 1.0, v18
    v_add_f32 v19, 1.0, v19
    v_add_f32 v20, 1.0, v20
    v_add_f32 v21, 1.0, v21
    v_add_f32 v22, 1.0, v22
    v_add_f32 v23, 1.0, v23
    v_rcp_f32 v16, v16
    v_rcp_f32 v17, v17
    v_rcp_f32 v18, v18
    v_rcp_f32 v19, v19
    v_rcp_f32 v20, v20
    v_rcp_f32 v21, v21
    v_rcp_f32 v22, v22
    v_rcp_f32 v23, v23
    v_mul_f32 v16, v220, v16
    v_mul_f32 v17, v221, v17
    v_mul_f32 v18, v222, v18
    v_mul_f32 v19, v223, v19
    v_mul_f32 v20, v252, v20
    v_mul_f32 v21, v253, v21
    v_mul_f32 v22, v254, v22
    v_mul_f32 v23, v255, v23
    v_cvt_pk_bf16_f32 v52, v16, v17
    v_cvt_pk_bf16_f32 v53, v18, v19
    v_cvt_pk_bf16_f32 v54, v20, v21
    v_cvt_pk_bf16_f32 v55, v22, v23
    s_add_u32 s51, s48, 84992
    buffer_store_dwordx4 v[52:55], v7, s[20:23], s51 offen sc1
    s_barrier
    s_add_u32 m0, s58, 0x18000
    s_add_u32 s50, s90, 0x1b000
    buffer_load_dwordx4 v13, s[16:19], s50 offen lds
    s_add_u32 m0, s58, 0x18400
    s_add_u32 s50, s90, 0x1b000
    buffer_load_dwordx4 v14, s[16:19], s50 offen lds
    s_add_u32 m0, s58, 0x18800
    s_add_u32 s50, s90, 0x1b000
    buffer_load_dwordx4 v15, s[16:19], s50 offen lds
    s_add_u32 m0, s58, 0x18c00
    s_add_u32 s50, s90, 0x1d400
    buffer_load_dwordx4 v13, s[16:19], s50 offen lds
    s_add_u32 m0, s58, 0x19000
    s_add_u32 s50, s90, 0x1d400
    buffer_load_dwordx4 v14, s[16:19], s50 offen lds
    s_add_u32 m0, s58, 0x19400
    s_add_u32 s50, s90, 0x1d400
    buffer_load_dwordx4 v15, s[16:19], s50 offen lds
    s_waitcnt vmcnt(6)
    v_mov_b32 v60, 1
    v_mov_b32 v61, 1
    v_mov_b32 v62, 1
    v_mov_b32 v63, 1
    s_add_u32 s51, s99, 4608
    s_mov_b64 exec, 0xff
    buffer_store_dwordx4 v[60:63], v7, s[20:23], s51 offen sc1
    s_mov_b64 exec, -1
    s_nop 0
    s_barrier
    s_add_u32 m0, s58, 0x0
    s_add_u32 s50, s88, 0x24000
    buffer_load_dwordx4 v13, s[16:19], s50 offen lds
    s_add_u32 m0, s58, 0x400
    s_add_u32 s50, s88, 0x24000
    buffer_load_dwordx4 v14, s[16:19], s50 offen lds
    s_add_u32 m0, s58, 0x800
    s_add_u32 s50, s88, 0x24000
    buffer_load_dwordx4 v15, s[16:19], s50 offen lds
    s_add_u32 m0, s58, 0xc00
    s_add_u32 s50, s88, 0x26400
    buffer_load_dwordx4 v13, s[16:19], s50 offen lds
    s_add_u32 m0, s58, 0x1000
    s_add_u32 s50, s88, 0x26400
    buffer_load_dwordx4 v14, s[16:19], s50 offen lds
    s_add_u32 m0, s58, 0x1400
    s_add_u32 s50, s88, 0x26400
    buffer_load_dwordx4 v15, s[16:19], s50 offen lds
    s_barrier
    s_add_u32 m0, s58, 0x6000
    s_add_u32 s50, s89, 0x24000
    buffer_load_dwordx4 v13, s[16:19], s50 offen lds
    s_add_u32 m0, s58, 0x6400
    s_add_u32 s50, s89, 0x24000
    buffer_load_dwordx4 v14, s[16:19], s50 offen lds
    s_add_u32 m0, s58, 0x6800
    s_add_u32 s50, s89, 0x24000
    buffer_load_dwordx4 v15, s[16:19], s50 offen lds
    s_add_u32 m0, s58, 0x6c00
    s_add_u32 s50, s89, 0x26400
    buffer_load_dwordx4 v13, s[16:19], s50 offen lds
    s_add_u32 m0, s58, 0x7000
    s_add_u32 s50, s89, 0x26400
    buffer_load_dwordx4 v14, s[16:19], s50 offen lds
    s_add_u32 m0, s58, 0x7400
    s_add_u32 s50, s89, 0x26400
    buffer_load_dwordx4 v15, s[16:19], s50 offen lds
    s_barrier
    s_add_u32 m0, s58, 0x1e000
    s_add_u32 s50, s90, 0x24000
    buffer_load_dwordx4 v13, s[16:19], s50 offen lds
    s_add_u32 m0, s58, 0x1e400
    s_add_u32 s50, s90, 0x24000
    buffer_load_dwordx4 v14, s[16:19], s50 offen lds
    s_add_u32 m0, s58, 0x1e800
    s_add_u32 s50, s90, 0x24000
    buffer_load_dwordx4 v15, s[16:19], s50 offen lds
    s_add_u32 m0, s58, 0x1ec00
    s_add_u32 s50, s90, 0x26400
    buffer_load_dwordx4 v13, s[16:19], s50 offen lds
    s_add_u32 m0, s58, 0x1f000
    s_add_u32 s50, s90, 0x26400
    buffer_load_dwordx4 v14, s[16:19], s50 offen lds
    s_add_u32 m0, s58, 0x1f400
    s_add_u32 s50, s90, 0x26400
    buffer_load_dwordx4 v15, s[16:19], s50 offen lds
    s_waitcnt vmcnt(19)
    s_barrier
    s_add_u32 m0, s58, 0xc000
    s_add_u32 s50, s88, 0x2d000
    buffer_load_dwordx4 v13, s[16:19], s50 offen lds
    s_add_u32 m0, s58, 0xc400
    s_add_u32 s50, s88, 0x2d000
    buffer_load_dwordx4 v14, s[16:19], s50 offen lds
    s_add_u32 m0, s58, 0xc800
    s_add_u32 s50, s88, 0x2d000
    buffer_load_dwordx4 v15, s[16:19], s50 offen lds
    s_add_u32 m0, s58, 0xcc00
    s_add_u32 s50, s88, 0x2f400
    buffer_load_dwordx4 v13, s[16:19], s50 offen lds
    s_add_u32 m0, s58, 0xd000
    s_add_u32 s50, s88, 0x2f400
    buffer_load_dwordx4 v14, s[16:19], s50 offen lds
    s_add_u32 m0, s58, 0xd400
    s_add_u32 s50, s88, 0x2f400
    buffer_load_dwordx4 v15, s[16:19], s50 offen lds
    s_waitcnt vmcnt(18)
    s_barrier
    s_add_u32 m0, s58, 0x12000
    s_add_u32 s50, s89, 0x2d000
    buffer_load_dwordx4 v13, s[16:19], s50 offen lds
    s_add_u32 m0, s58, 0x12400
    s_add_u32 s50, s89, 0x2d000
    buffer_load_dwordx4 v14, s[16:19], s50 offen lds
    s_add_u32 m0, s58, 0x12800
    s_add_u32 s50, s89, 0x2d000
    buffer_load_dwordx4 v15, s[16:19], s50 offen lds
    s_add_u32 m0, s58, 0x12c00
    s_add_u32 s50, s89, 0x2f400
    buffer_load_dwordx4 v13, s[16:19], s50 offen lds
    s_add_u32 m0, s58, 0x13000
    s_add_u32 s50, s89, 0x2f400
    buffer_load_dwordx4 v14, s[16:19], s50 offen lds
    s_add_u32 m0, s58, 0x13400
    s_add_u32 s50, s89, 0x2f400
    buffer_load_dwordx4 v15, s[16:19], s50 offen lds
    buffer_load_dword v58, v59, s[28:31], 0 offen sc1
    s_waitcnt vmcnt(19)
    s_barrier
    s_add_u32 m0, s58, 0x18000
    s_add_u32 s50, s90, 0x2d000
    buffer_load_dwordx4 v13, s[16:19], s50 offen lds
    s_add_u32 m0, s58, 0x18400
    s_add_u32 s50, s90, 0x2d000
    buffer_load_dwordx4 v14, s[16:19], s50 offen lds
    s_add_u32 m0, s58, 0x18800
    s_add_u32 s50, s90, 0x2d000
    buffer_load_dwordx4 v15, s[16:19], s50 offen lds
    s_add_u32 m0, s58, 0x18c00
    s_add_u32 s50, s90, 0x2f400
    buffer_load_dwordx4 v13, s[16:19], s50 offen lds
    s_add_u32 m0, s58, 0x19000
    s_add_u32 s50, s90, 0x2f400
    buffer_load_dwordx4 v14, s[16:19], s50 offen lds
    s_add_u32 m0, s58, 0x19400
    s_add_u32 s50, s90, 0x2f400
    buffer_load_dwordx4 v15, s[16:19], s50 offen lds
    s_waitcnt vmcnt(13)
    s_barrier
    s_waitcnt vmcnt(6)
    s_mov_b32 s100, 0x8000
L_spin_13:
    v_cmp_gt_u32 vcc, 8, v58
    s_and_b32 s50, vcc_hi, 0xffffffff
    s_cbranch_scc0 L_ok_12
    s_sub_u32 s100, s100, 1
    s_cbranch_scc1 L_ok_12
    s_sleep 1
    buffer_load_dword v58, v59, s[28:31], 0 offen sc1
    s_waitcnt vmcnt(0)
    s_branch L_spin_13
L_ok_12:
    s_waitcnt vmcnt(0)
    s_barrier
    v_and_b32 v56, 31, v1
    v_lshlrev_b32 v56, 2, v56
    v_add_u32 v56, 159904, v56
    ds_read2_b32 v[16:17], v56 offset0:0 offset1:32
    ds_read2_b32 v[18:19], v56 offset0:64 offset1:96
    ds_read2_b32 v[20:21], v56 offset0:128 offset1:160
    ds_read2_b32 v[22:23], v56 offset0:192 offset1:224
    s_waitcnt lgkmcnt(0)
    v_add_f32 v16, v16, v17
    v_add_f32 v18, v18, v19
    v_add_f32 v20, v20, v21
    v_add_f32 v22, v22, v23
    v_add_f32 v16, v16, v18
    v_add_f32 v20, v20, v22
    v_add_f32 v16, v16, v20
    v_mul_f32 v17, s49, v16
    v_exp_f32 v17, v17
    v_sub_f32 v18, 0, v16
    v_mul_f32 v18, s49, v18
    v_exp_f32 v18, v18
    v_add_f32 v17, 1.0, v17
    v_rcp_f32 v16, v17
    v_add_f32 v18, 1.0, v18
    v_rcp_f32 v17, v18
    s_lshl_b32 s55, s37, 10
    s_add_u32 s97, s101, s55
    s_mul_i32 s55, s43, 405504
    s_sub_u32 s55, s101, s55
    v_min_u32 v49, 7, v1
    v_lshlrev_b32 v49, 7, v49
    s_add_u32 s4, s55, 1536
    buffer_load_dword v58, v49, s[20:23], s4 offen sc1
    s_waitcnt vmcnt(0)
    s_mov_b32 s100, 0x8000
L_spin_15:
    v_cmp_gt_u32 vcc, 1, v58
    s_and_b32 s50, vcc_lo, 0xff
    s_cbranch_scc0 L_ok_14
    s_sub_u32 s100, s100, 1
    s_cbranch_scc1 L_ok_14
    s_sleep 1
    buffer_load_dword v58, v49, s[20:23], s4 offen sc1
    s_waitcnt vmcnt(0)
    s_branch L_spin_15
L_ok_14:
    v_min_u32 v49, 11, v1
    v_lshlrev_b32 v49, 7, v49
    s_add_u32 s51, s97, 52224
    buffer_load_dwordx4 v[128:131], v7, s[20:23], s51 offen sc1
    s_add_u32 s51, s97, 56320
    buffer_load_dwordx4 v[132:135], v7, s[20:23], s51 offen sc1
    s_add_u32 s51, s97, 60416
    buffer_load_dwordx4 v[136:139], v7, s[20:23], s51 offen sc1
    s_add_u32 s51, s97, 64512
    buffer_load_dwordx4 v[140:143], v7, s[20:23], s51 offen sc1
    s_add_u32 s51, s97, 68608
    buffer_load_dwordx4 v[144:147], v7, s[20:23], s51 offen sc1
    s_add_u32 s51, s97, 72704
    buffer_load_dwordx4 v[148:151], v7, s[20:23], s51 offen sc1
    s_add_u32 s51, s97, 76800
    buffer_load_dwordx4 v[152:155], v7, s[20:23], s51 offen sc1
    s_add_u32 s51, s97, 80896
    buffer_load_dwordx4 v[156:159], v7, s[20:23], s51 offen sc1
    s_add_u32 s51, s97, 84992
    buffer_load_dwordx4 v[160:163], v7, s[20:23], s51 offen sc1
    s_add_u32 s51, s97, 89088
    buffer_load_dwordx4 v[164:167], v7, s[20:23], s51 offen sc1
    s_add_u32 s51, s97, 93184
    buffer_load_dwordx4 v[168:171], v7, s[20:23], s51 offen sc1
    s_add_u32 s51, s97, 97280
    buffer_load_dwordx4 v[172:175], v7, s[20:23], s51 offen sc1
    s_waitcnt vmcnt(9)
    v_lshlrev_b32 v64, 16, v128
    v_and_b32 v65, 0xffff0000, v128
    v_lshlrev_b32 v66, 16, v129
    v_and_b32 v67, 0xffff0000, v129
    v_lshlrev_b32 v68, 16, v130
    v_and_b32 v69, 0xffff0000, v130
    v_lshlrev_b32 v70, 16, v131
    v_and_b32 v71, 0xffff0000, v131
    v_lshlrev_b32 v72, 16, v132
    v_and_b32 v73, 0xffff0000, v132
    v_lshlrev_b32 v74, 16, v133
    v_and_b32 v75, 0xffff0000, v133
    v_lshlrev_b32 v76, 16, v134
    v_and_b32 v77, 0xffff0000, v134
    v_lshlrev_b32 v78, 16, v135
    v_and_b32 v79, 0xffff0000, v135
    v_lshlrev_b32 v80, 16, v136
    v_and_b32 v81, 0xffff0000, v136
    v_lshlrev_b32 v82, 16, v137
    v_and_b32 v83, 0xffff0000, v137
    v_lshlrev_b32 v84, 16, v138
    v_and_b32 v85, 0xffff0000, v138
    v_lshlrev_b32 v86, 16, v139
    v_and_b32 v87, 0xffff0000, v139
    s_waitcnt vmcnt(6)
    v_lshlrev_b32 v56, 16, v140
    v_and_b32 v57, 0xffff0000, v140
    v_add_f32 v64, v64, v56
    v_add_f32 v65, v65, v57
    v_lshlrev_b32 v56, 16, v141
    v_and_b32 v57, 0xffff0000, v141
    v_add_f32 v66, v66, v56
    v_add_f32 v67, v67, v57
    v_lshlrev_b32 v56, 16, v142
    v_and_b32 v57, 0xffff0000, v142
    v_add_f32 v68, v68, v56
    v_add_f32 v69, v69, v57
    v_lshlrev_b32 v56, 16, v143
    v_and_b32 v57, 0xffff0000, v143
    v_add_f32 v70, v70, v56
    v_add_f32 v71, v71, v57
    v_lshlrev_b32 v56, 16, v144
    v_and_b32 v57, 0xffff0000, v144
    v_add_f32 v72, v72, v56
    v_add_f32 v73, v73, v57
    v_lshlrev_b32 v56, 16, v145
    v_and_b32 v57, 0xffff0000, v145
    v_add_f32 v74, v74, v56
    v_add_f32 v75, v75, v57
    v_lshlrev_b32 v56, 16, v146
    v_and_b32 v57, 0xffff0000, v146
    v_add_f32 v76, v76, v56
    v_add_f32 v77, v77, v57
    v_lshlrev_b32 v56, 16, v147
    v_and_b32 v57, 0xffff0000, v147
    v_add_f32 v78, v78, v56
    v_add_f32 v79, v79, v57
    v_lshlrev_b32 v56, 16, v148
    v_and_b32 v57, 0xffff0000, v148
    v_add_f32 v80, v80, v56
    v_add_f32 v81, v81, v57
    v_lshlrev_b32 v56, 16, v149
    v_and_b32 v57, 0xffff0000, v149
    v_add_f32 v82, v82, v56
    v_add_f32 v83, v83, v57
    v_lshlrev_b32 v56, 16, v150
    v_and_b32 v57, 0xffff0000, v150
    v_add_f32 v84, v84, v56
    v_add_f32 v85, v85, v57
    v_lshlrev_b32 v56, 16, v151
    v_and_b32 v57, 0xffff0000, v151
    v_add_f32 v86, v86, v56
    v_add_f32 v87, v87, v57
    s_waitcnt vmcnt(3)
    v_lshlrev_b32 v56, 16, v152
    v_and_b32 v57, 0xffff0000, v152
    v_add_f32 v64, v64, v56
    v_add_f32 v65, v65, v57
    v_lshlrev_b32 v56, 16, v153
    v_and_b32 v57, 0xffff0000, v153
    v_add_f32 v66, v66, v56
    v_add_f32 v67, v67, v57
    v_lshlrev_b32 v56, 16, v154
    v_and_b32 v57, 0xffff0000, v154
    v_add_f32 v68, v68, v56
    v_add_f32 v69, v69, v57
    v_lshlrev_b32 v56, 16, v155
    v_and_b32 v57, 0xffff0000, v155
    v_add_f32 v70, v70, v56
    v_add_f32 v71, v71, v57
    v_lshlrev_b32 v56, 16, v156
    v_and_b32 v57, 0xffff0000, v156
    v_add_f32 v72, v72, v56
    v_add_f32 v73, v73, v57
    v_lshlrev_b32 v56, 16, v157
    v_and_b32 v57, 0xffff0000, v157
    v_add_f32 v74, v74, v56
    v_add_f32 v75, v75, v57
    v_lshlrev_b32 v56, 16, v158
    v_and_b32 v57, 0xffff0000, v158
    v_add_f32 v76, v76, v56
    v_add_f32 v77, v77, v57
    v_lshlrev_b32 v56, 16, v159
    v_and_b32 v57, 0xffff0000, v159
    v_add_f32 v78, v78, v56
    v_add_f32 v79, v79, v57
    v_lshlrev_b32 v56, 16, v160
    v_and_b32 v57, 0xffff0000, v160
    v_add_f32 v80, v80, v56
    v_add_f32 v81, v81, v57
    v_lshlrev_b32 v56, 16, v161
    v_and_b32 v57, 0xffff0000, v161
    v_add_f32 v82, v82, v56
    v_add_f32 v83, v83, v57
    v_lshlrev_b32 v56, 16, v162
    v_and_b32 v57, 0xffff0000, v162
    v_add_f32 v84, v84, v56
    v_add_f32 v85, v85, v57
    v_lshlrev_b32 v56, 16, v163
    v_and_b32 v57, 0xffff0000, v163
    v_add_f32 v86, v86, v56
    v_add_f32 v87, v87, v57
    s_waitcnt vmcnt(0)
    v_lshlrev_b32 v56, 16, v164
    v_and_b32 v57, 0xffff0000, v164
    v_add_f32 v64, v64, v56
    v_add_f32 v65, v65, v57
    v_lshlrev_b32 v56, 16, v165
    v_and_b32 v57, 0xffff0000, v165
    v_add_f32 v66, v66, v56
    v_add_f32 v67, v67, v57
    v_lshlrev_b32 v56, 16, v166
    v_and_b32 v57, 0xffff0000, v166
    v_add_f32 v68, v68, v56
    v_add_f32 v69, v69, v57
    v_lshlrev_b32 v56, 16, v167
    v_and_b32 v57, 0xffff0000, v167
    v_add_f32 v70, v70, v56
    v_add_f32 v71, v71, v57
    v_lshlrev_b32 v56, 16, v168
    v_and_b32 v57, 0xffff0000, v168
    v_add_f32 v72, v72, v56
    v_add_f32 v73, v73, v57
    v_lshlrev_b32 v56, 16, v169
    v_and_b32 v57, 0xffff0000, v169
    v_add_f32 v74, v74, v56
    v_add_f32 v75, v75, v57
    v_lshlrev_b32 v56, 16, v170
    v_and_b32 v57, 0xffff0000, v170
    v_add_f32 v76, v76, v56
    v_add_f32 v77, v77, v57
    v_lshlrev_b32 v56, 16, v171
    v_and_b32 v57, 0xffff0000, v171
    v_add_f32 v78, v78, v56
    v_add_f32 v79, v79, v57
    v_lshlrev_b32 v56, 16, v172
    v_and_b32 v57, 0xffff0000, v172
    v_add_f32 v80, v80, v56
    v_add_f32 v81, v81, v57
    v_lshlrev_b32 v56, 16, v173
    v_and_b32 v57, 0xffff0000, v173
    v_add_f32 v82, v82, v56
    v_add_f32 v83, v83, v57
    v_lshlrev_b32 v56, 16, v174
    v_and_b32 v57, 0xffff0000, v174
    v_add_f32 v84, v84, v56
    v_add_f32 v85, v85, v57
    v_lshlrev_b32 v56, 16, v175
    v_and_b32 v57, 0xffff0000, v175
    v_add_f32 v86, v86, v56
    v_add_f32 v87, v87, v57
    v_mul_f32 v64, v16, v64
    v_mul_f32 v65, v16, v65
    v_mul_f32 v66, v16, v66
    v_mul_f32 v67, v16, v67
    v_mul_f32 v68, v16, v68
    v_mul_f32 v69, v16, v69
    v_mul_f32 v70, v16, v70
    v_mul_f32 v71, v16, v71
    v_mul_f32 v72, v16, v72
    v_mul_f32 v73, v16, v73
    v_mul_f32 v74, v16, v74
    v_mul_f32 v75, v16, v75
    v_mul_f32 v76, v16, v76
    v_mul_f32 v77, v16, v77
    v_mul_f32 v78, v16, v78
    v_mul_f32 v79, v16, v79
    v_mul_f32 v80, v16, v80
    v_mul_f32 v81, v16, v81
    v_mul_f32 v82, v16, v82
    v_mul_f32 v83, v16, v83
    v_mul_f32 v84, v16, v84
    v_mul_f32 v85, v16, v85
    v_mul_f32 v86, v16, v86
    v_mul_f32 v87, v16, v87
    v_and_b32 v18, 31, v1
    s_mov_b32 s55, 1152
    v_mul_u32_u24 v18, s55, v18
    v_lshrrev_b32 v19, 5, v1
    v_lshl_add_u32 v18, v19, 3, v18
    s_lshl_b32 s55, s39, 8
    s_lshl_b32 s56, s42, 7
    s_add_u32 s55, s55, s56
    s_lshl_b32 s56, s38, 5
    s_add_u32 s55, s55, s56
    s_mul_i32 s55, s55, 1152
    s_mul_i32 s56, s43, 384
    s_add_u32 s55, s55, s56
    s_lshl_b32 s56, s37, 5
    s_add_u32 s55, s55, s56
    s_mov_b32 s56, s101
    s_add_u32 s4, s56, 0
    buffer_load_dword v58, v49, s[20:23], s4 offen sc1
    s_waitcnt vmcnt(0)
    s_mov_b32 s100, 0x8000
L_spin_17:
    v_cmp_gt_u32 vcc, 1, v58
    s_and_b32 s50, vcc_lo, 0xf
    s_cbranch_scc0 L_ok_16
    s_sub_u32 s100, s100, 1
    s_cbranch_scc1 L_ok_16
    s_sleep 1
    buffer_load_dword v58, v49, s[20:23], s4 offen sc1
    s_waitcnt vmcnt(0)
    s_branch L_spin_17
L_ok_16:
    s_add_u32 s51, s97, 3072
    buffer_load_dwordx4 v[128:131], v7, s[20:23], s51 offen sc1
    s_add_u32 s51, s97, 15360
    buffer_load_dwordx4 v[132:135], v7, s[20:23], s51 offen sc1
    s_add_u32 s51, s97, 27648
    buffer_load_dwordx4 v[136:139], v7, s[20:23], s51 offen sc1
    s_add_u32 s51, s97, 39936
    buffer_load_dwordx4 v[140:143], v7, s[20:23], s51 offen sc1
    s_mov_b32 s100, 0x8000
L_spin_19:
    v_cmp_gt_u32 vcc, 1, v58
    s_and_b32 s50, vcc_lo, 0xf0
    s_cbranch_scc0 L_ok_18
    s_sub_u32 s100, s100, 1
    s_cbranch_scc1 L_ok_18
    s_sleep 1
    buffer_load_dword v58, v49, s[20:23], s4 offen sc1
    s_waitcnt vmcnt(0)
    s_branch L_spin_19
L_ok_18:
    s_add_u32 s51, s97, 7168
    buffer_load_dwordx4 v[144:147], v7, s[20:23], s51 offen sc1
    s_add_u32 s51, s97, 19456
    buffer_load_dwordx4 v[148:151], v7, s[20:23], s51 offen sc1
    s_add_u32 s51, s97, 31744
    buffer_load_dwordx4 v[152:155], v7, s[20:23], s51 offen sc1
    s_add_u32 s51, s97, 44032
    buffer_load_dwordx4 v[156:159], v7, s[20:23], s51 offen sc1
    v_cmp_gt_u32 vcc, 1, v58
    s_and_b32 s52, vcc_lo, 0xf00
    s_cbranch_scc1 L_p2late
    s_add_u32 s51, s97, 11264
    buffer_load_dwordx4 v[160:163], v7, s[20:23], s51 offen sc1
    s_add_u32 s51, s97, 23552
    buffer_load_dwordx4 v[164:167], v7, s[20:23], s51 offen sc1
    s_add_u32 s51, s97, 35840
    buffer_load_dwordx4 v[168:171], v7, s[20:23], s51 offen sc1
    s_add_u32 s51, s97, 48128
    buffer_load_dwordx4 v[172:175], v7, s[20:23], s51 offen sc1
L_p2late:
    s_waitcnt vmcnt(7)
    v_lshlrev_b32 v96, 16, v128
    v_and_b32 v97, 0xffff0000, v128
    v_lshlrev_b32 v98, 16, v129
    v_and_b32 v99, 0xffff0000, v129
    v_lshlrev_b32 v100, 16, v130
    v_and_b32 v101, 0xffff0000, v130
    v_lshlrev_b32 v102, 16, v131
    v_and_b32 v103, 0xffff0000, v131
    s_waitcnt vmcnt(6)
    v_lshlrev_b32 v56, 16, v132
    v_and_b32 v57, 0xffff0000, v132
    v_add_f32 v96, v96, v56
    v_add_f32 v97, v97, v57
    v_lshlrev_b32 v56, 16, v133
    v_and_b32 v57, 0xffff0000, v133
    v_add_f32 v98, v98, v56
    v_add_f32 v99, v99, v57
    v_lshlrev_b32 v56, 16, v134
    v_and_b32 v57, 0xffff0000, v134
    v_add_f32 v100, v100, v56
    v_add_f32 v101, v101, v57
    v_lshlrev_b32 v56, 16, v135
    v_and_b32 v57, 0xffff0000, v135
    v_add_f32 v102, v102, v56
    v_add_f32 v103, v103, v57
    s_waitcnt vmcnt(5)
    v_lshlrev_b32 v56, 16, v136
    v_and_b32 v57, 0xffff0000, v136
    v_add_f32 v96, v96, v56
    v_add_f32 v97, v97, v57
    v_lshlrev_b32 v56, 16, v137
    v_and_b32 v57, 0xffff0000, v137
    v_add_f32 v98, v98, v56
    v_add_f32 v99, v99, v57
    v_lshlrev_b32 v56, 16, v138
    v_and_b32 v57, 0xffff0000, v138
    v_add_f32 v100, v100, v56
    v_add_f32 v101, v101, v57
    v_lshlrev_b32 v56, 16, v139
    v_and_b32 v57, 0xffff0000, v139
    v_add_f32 v102, v102, v56
    v_add_f32 v103, v103, v57
    s_waitcnt vmcnt(4)
    v_lshlrev_b32 v56, 16, v140
    v_and_b32 v57, 0xffff0000, v140
    v_add_f32 v96, v96, v56
    v_add_f32 v97, v97, v57
    v_lshlrev_b32 v56, 16, v141
    v_and_b32 v57, 0xffff0000, v141
    v_add_f32 v98, v98, v56
    v_add_f32 v99, v99, v57
    v_lshlrev_b32 v56, 16, v142
    v_and_b32 v57, 0xffff0000, v142
    v_add_f32 v100, v100, v56
    v_add_f32 v101, v101, v57
    v_lshlrev_b32 v56, 16, v143
    v_and_b32 v57, 0xffff0000, v143
    v_add_f32 v102, v102, v56
    v_add_f32 v103, v103, v57
    v_fma_f32 v64, v17, v96, v64
    v_fma_f32 v65, v17, v97, v65
    v_fma_f32 v66, v17, v98, v66
    v_fma_f32 v67, v17, v99, v67
    v_fma_f32 v68, v17, v100, v68
    v_fma_f32 v69, v17, v101, v69
    v_fma_f32 v70, v17, v102, v70
    v_fma_f32 v71, v17, v103, v71
    v_cvt_pk_bf16_f32 v176, v64, v65
    v_cvt_pk_bf16_f32 v177, v66, v67
    v_cvt_pk_bf16_f32 v178, v68, v69
    v_cvt_pk_bf16_f32 v179, v70, v71
    buffer_store_dwordx2 v[176:177], v18, s[24:27], s55 offen offset:0
    buffer_store_dwordx2 v[178:179], v18, s[24:27], s55 offen offset:16
    s_waitcnt vmcnt(5)
    v_lshlrev_b32 v96, 16, v144
    v_and_b32 v97, 0xffff0000, v144
    v_lshlrev_b32 v98, 16, v145
    v_and_b32 v99, 0xffff0000, v145
    v_lshlrev_b32 v100, 16, v146
    v_and_b32 v101, 0xffff0000, v146
    v_lshlrev_b32 v102, 16, v147
    v_and_b32 v103, 0xffff0000, v147
    s_waitcnt vmcnt(4)
    v_lshlrev_b32 v56, 16, v148
    v_and_b32 v57, 0xffff0000, v148
    v_add_f32 v96, v96, v56
    v_add_f32 v97, v97, v57
    v_lshlrev_b32 v56, 16, v149
    v_and_b32 v57, 0xffff0000, v149
    v_add_f32 v98, v98, v56
    v_add_f32 v99, v99, v57
    v_lshlrev_b32 v56, 16, v150
    v_and_b32 v57, 0xffff0000, v150
    v_add_f32 v100, v100, v56
    v_add_f32 v101, v101, v57
    v_lshlrev_b32 v56, 16, v151
    v_and_b32 v57, 0xffff0000, v151
    v_add_f32 v102, v102, v56
    v_add_f32 v103, v103, v57
    s_waitcnt vmcnt(3)
    v_lshlrev_b32 v56, 16, v152
    v_and_b32 v57, 0xffff0000, v152
    v_add_f32 v96, v96, v56
    v_add_f32 v97, v97, v57
    v_lshlrev_b32 v56, 16, v153
    v_and_b32 v57, 0xffff0000, v153
    v_add_f32 v98, v98, v56
    v_add_f32 v99, v99, v57
    v_lshlrev_b32 v56, 16, v154
    v_and_b32 v57, 0xffff0000, v154
    v_add_f32 v100, v100, v56
    v_add_f32 v101, v101, v57
    v_lshlrev_b32 v56, 16, v155
    v_and_b32 v57, 0xffff0000, v155
    v_add_f32 v102, v102, v56
    v_add_f32 v103, v103, v57
    s_waitcnt vmcnt(2)
    v_lshlrev_b32 v56, 16, v156
    v_and_b32 v57, 0xffff0000, v156
    v_add_f32 v96, v96, v56
    v_add_f32 v97, v97, v57
    v_lshlrev_b32 v56, 16, v157
    v_and_b32 v57, 0xffff0000, v157
    v_add_f32 v98, v98, v56
    v_add_f32 v99, v99, v57
    v_lshlrev_b32 v56, 16, v158
    v_and_b32 v57, 0xffff0000, v158
    v_add_f32 v100, v100, v56
    v_add_f32 v101, v101, v57
    v_lshlrev_b32 v56, 16, v159
    v_and_b32 v57, 0xffff0000, v159
    v_add_f32 v102, v102, v56
    v_add_f32 v103, v103, v57
    v_fma_f32 v72, v17, v96, v72
    v_fma_f32 v73, v17, v97, v73
    v_fma_f32 v74, v17, v98, v74
    v_fma_f32 v75, v17, v99, v75
    v_fma_f32 v76, v17, v100, v76
    v_fma_f32 v77, v17, v101, v77
    v_fma_f32 v78, v17, v102, v78
    v_fma_f32 v79, v17, v103, v79
    v_cvt_pk_bf16_f32 v180, v72, v73
    v_cvt_pk_bf16_f32 v181, v74, v75
    v_cvt_pk_bf16_f32 v182, v76, v77
    v_cvt_pk_bf16_f32 v183, v78, v79
    buffer_store_dwordx2 v[180:181], v18, s[24:27], s55 offen offset:128
    buffer_store_dwordx2 v[182:183], v18, s[24:27], s55 offen offset:144
    s_cmp_eq_u32 s52, 0
    s_cbranch_scc1 L_p2done
    s_mov_b32 s100, 0x8000
L_spin_21:
    v_cmp_gt_u32 vcc, 1, v58
    s_and_b32 s50, vcc_lo, 0xf00
    s_cbranch_scc0 L_ok_20
    s_sub_u32 s100, s100, 1
    s_cbranch_scc1 L_ok_20
    s_sleep 1
    buffer_load_dword v58, v49, s[20:23], s4 offen sc1
    s_waitcnt vmcnt(0)
    s_branch L_spin_21
L_ok_20:
    s_add_u32 s51, s97, 11264
    buffer_load_dwordx4 v[160:163], v7, s[20:23], s51 offen sc1
    s_add_u32 s51, s97, 23552
    buffer_load_dwordx4 v[164:167], v7, s[20:23], s51 offen sc1
    s_add_u32 s51, s97, 35840
    buffer_load_dwordx4 v[168:171], v7, s[20:23], s51 offen sc1
    s_add_u32 s51, s97, 48128
    buffer_load_dwordx4 v[172:175], v7, s[20:23], s51 offen sc1
L_p2done:
    s_waitcnt vmcnt(0)
    v_lshlrev_b32 v96, 16, v160
    v_and_b32 v97, 0xffff0000, v160
    v_lshlrev_b32 v98, 16, v161
    v_and_b32 v99, 0xffff0000, v161
    v_lshlrev_b32 v100, 16, v162
    v_and_b32 v101, 0xffff0000, v162
    v_lshlrev_b32 v102, 16, v163
    v_and_b32 v103, 0xffff0000, v163
    v_lshlrev_b32 v56, 16, v164
    v_and_b32 v57, 0xffff0000, v164
    v_add_f32 v96, v96, v56
    v_add_f32 v97, v97, v57
    v_lshlrev_b32 v56, 16, v165
    v_and_b32 v57, 0xffff0000, v165
    v_add_f32 v98, v98, v56
    v_add_f32 v99, v99, v57
    v_lshlrev_b32 v56, 16, v166
    v_and_b32 v57, 0xffff0000, v166
    v_add_f32 v100, v100, v56
    v_add_f32 v101, v101, v57
    v_lshlrev_b32 v56, 16, v167
    v_and_b32 v57, 0xffff0000, v167
    v_add_f32 v102, v102, v56
    v_add_f32 v103, v103, v57
    v_lshlrev_b32 v56, 16, v168
    v_and_b32 v57, 0xffff0000, v168
    v_add_f32 v96, v96, v56
    v_add_f32 v97, v97, v57
    v_lshlrev_b32 v56, 16, v169
    v_and_b32 v57, 0xffff0000, v169
    v_add_f32 v98, v98, v56
    v_add_f32 v99, v99, v57
    v_lshlrev_b32 v56, 16, v170
    v_and_b32 v57, 0xffff0000, v170
    v_add_f32 v100, v100, v56
    v_add_f32 v101, v101, v57
    v_lshlrev_b32 v56, 16, v171
    v_and_b32 v57, 0xffff0000, v171
    v_add_f32 v102, v102, v56
    v_add_f32 v103, v103, v57
    v_lshlrev_b32 v56, 16, v172
    v_and_b32 v57, 0xffff0000, v172
    v_add_f32 v96, v96, v56
    v_add_f32 v97, v97, v57
    v_lshlrev_b32 v56, 16, v173
    v_and_b32 v57, 0xffff0000, v173
    v_add_f32 v98, v98, v56
    v_add_f32 v99, v99, v57
    v_lshlrev_b32 v56, 16, v174
    v_and_b32 v57, 0xffff0000, v174
    v_add_f32 v100, v100, v56
    v_add_f32 v101, v101, v57
    v_lshlrev_b32 v56, 16, v175
    v_and_b32 v57, 0xffff0000, v175
    v_add_f32 v102, v102, v56
    v_add_f32 v103, v103, v57
    v_fma_f32 v80, v17, v96, v80
    v_fma_f32 v81, v17, v97, v81
    v_fma_f32 v82, v17, v98, v82
    v_fma_f32 v83, v17, v99, v83
    v_fma_f32 v84, v17, v100, v84
    v_fma_f32 v85, v17, v101, v85
    v_fma_f32 v86, v17, v102, v86
    v_fma_f32 v87, v17, v103, v87
    v_cvt_pk_bf16_f32 v184, v80, v81
    v_cvt_pk_bf16_f32 v185, v82, v83
    v_cvt_pk_bf16_f32 v186, v84, v85
    v_cvt_pk_bf16_f32 v187, v86, v87
    buffer_store_dwordx2 v[184:185], v18, s[24:27], s55 offen offset:256
    buffer_store_dwordx2 v[186:187], v18, s[24:27], s55 offen offset:272
    s_branch L_end
L_att:
    s_and_b32 s50, s50, 1
    s_lshl_b32 s50, s50, 3
    s_sub_u32 s39, s51, 24
    s_add_u32 s39, s39, s50
    v_add_u32 v56, 0, v1
    s_mov_b32 s55, 1214
    v_mul_u32_u24 v57, s55, v56
    v_lshrrev_b32 v57, 16, v57
    v_mul_u32_u24 v58, 54, v57
    v_sub_u32 v58, v56, v58
    s_mov_b32 s55, 3641
    v_mul_u32_u24 v56, s55, v58
    v_lshrrev_b32 v56, 16, v56
    v_mul_u32_u24 v59, 18, v56
    v_sub_u32 v59, v58, v59
    s_mov_b32 s55, 3456
    v_mul_u32_u24 v57, s55, v57
    s_mov_b32 s55, 1152
    v_mad_u32_u24 v57, v56, s55, v57
    v_lshl_add_u32 v8, v59, 4, v57
    v_add_u32 v56, 64, v1
    s_mov_b32 s55, 1214
    v_mul_u32_u24 v57, s55, v56
    v_lshrrev_b32 v57, 16, v57
    v_mul_u32_u24 v58, 54, v57
    v_sub_u32 v58, v56, v58
    s_mov_b32 s55, 3641
    v_mul_u32_u24 v56, s55, v58
    v_lshrrev_b32 v56, 16, v56
    v_mul_u32_u24 v59, 18, v56
    v_sub_u32 v59, v58, v59
    s_mov_b32 s55, 3456
    v_mul_u32_u24 v57, s55, v57
    s_mov_b32 s55, 1152
    v_mad_u32_u24 v57, v56, s55, v57
    v_lshl_add_u32 v9, v59, 4, v57
    v_add_u32 v56, 128, v1
    s_mov_b32 s55, 1214
    v_mul_u32_u24 v57, s55, v56
    v_lshrrev_b32 v57, 16, v57
    v_mul_u32_u24 v58, 54, v57
    v_sub_u32 v58, v56, v58
    s_mov_b32 s55, 3641
    v_mul_u32_u24 v56, s55, v58
    v_lshrrev_b32 v56, 16, v56
    v_mul_u32_u24 v59, 18, v56
    v_sub_u32 v59, v58, v59
    s_mov_b32 s55, 3456
    v_mul_u32_u24 v57, s55, v57
    s_mov_b32 s55, 1152
    v_mad_u32_u24 v57, v56, s55, v57
    v_lshl_add_u32 v10, v59, 4, v57
    v_add_u32 v56, 192, v1
    s_mov_b32 s55, 1214
    v_mul_u32_u24 v57, s55, v56
    v_lshrrev_b32 v57, 16, v57
    v_mul_u32_u24 v58, 54, v57
    v_sub_u32 v58, v56, v58
    s_mov_b32 s55, 3641
    v_mul_u32_u24 v56, s55, v58
    v_lshrrev_b32 v56, 16, v56
    v_mul_u32_u24 v59, 18, v56
    v_sub_u32 v59, v58, v59
    s_mov_b32 s55, 3456
    v_mul_u32_u24 v57, s55, v57
    s_mov_b32 s55, 1152
    v_mad_u32_u24 v57, v56, s55, v57
    v_lshl_add_u32 v11, v59, 4, v57
    v_add_u32 v56, 256, v1
    s_mov_b32 s55, 1214
    v_mul_u32_u24 v57, s55, v56
    v_lshrrev_b32 v57, 16, v57
    v_mul_u32_u24 v58, 54, v57
    v_sub_u32 v58, v56, v58
    s_mov_b32 s55, 3641
    v_mul_u32_u24 v56, s55, v58
    v_lshrrev_b32 v56, 16, v56
    v_mul_u32_u24 v59, 18, v56
    v_sub_u32 v59, v58, v59
    s_mov_b32 s55, 3456
    v_mul_u32_u24 v57, s55, v57
    s_mov_b32 s55, 1152
    v_mad_u32_u24 v57, v56, s55, v57
    v_lshl_add_u32 v12, v59, 4, v57
    v_add_u32 v56, 320, v1
    s_mov_b32 s55, 1214
    v_mul_u32_u24 v57, s55, v56
    v_lshrrev_b32 v57, 16, v57
    v_mul_u32_u24 v58, 54, v57
    v_sub_u32 v58, v56, v58
    s_mov_b32 s55, 3641
    v_mul_u32_u24 v56, s55, v58
    v_lshrrev_b32 v56, 16, v56
    v_mul_u32_u24 v59, 18, v56
    v_sub_u32 v59, v58, v59
    s_mov_b32 s55, 3456
    v_mul_u32_u24 v57, s55, v57
    s_mov_b32 s55, 1152
    v_mad_u32_u24 v57, v56, s55, v57
    v_lshl_add_u32 v13, v59, 4, v57
    v_add_u32 v56, 384, v1
    s_mov_b32 s55, 1214
    v_mul_u32_u24 v57, s55, v56
    v_lshrrev_b32 v57, 16, v57
    v_mul_u32_u24 v58, 54, v57
    v_sub_u32 v58, v56, v58
    s_mov_b32 s55, 3641
    v_mul_u32_u24 v56, s55, v58
    v_lshrrev_b32 v56, 16, v56
    v_mul_u32_u24 v59, 18, v56
    v_sub_u32 v59, v58, v59
    s_mov_b32 s55, 3456
    v_mul_u32_u24 v57, s55, v57
    s_mov_b32 s55, 1152
    v_mad_u32_u24 v57, v56, s55, v57
    v_lshl_add_u32 v14, v59, 4, v57
    v_lshrrev_b32 v56, 3, v1
    v_and_b32 v57, 7, v1
    v_lshrrev_b32 v58, 1, v56
    s_mov_b32 s55, 1152
    v_mul_u32_u24 v56, s55, v56
    v_xor_b32 v57, v57, v58
    v_lshl_add_u32 v2, v57, 4, v56
    v_xor_b32 v57, 4, v57
    v_lshl_add_u32 v3, v57, 4, v56
    s_mul_i32 s44, s36, 27648
    s_mul_i32 s55, s38, 288
    s_add_u32 s44, s44, s55
    s_mul_i32 s45, s36, 7040
    s_lshl_b32 s46, s39, 7
    s_lshl_b32 s55, s36, 4
    s_add_u32 s46, s46, s55
    s_mul_i32 s46, s46, 1152
    s_lshl_b32 s47, s36, 11
    s_add_u32 s47, s47, 58368
    s_lshl_b32 s48, s39, 7
    s_lshl_b32 s55, s36, 3
    s_add_u32 s48, s48, s55
    s_sub_i32 s48, s48, 16
    s_max_i32 s48, s48, 0
    s_mul_i32 s48, s48, 1152
    s_cmp_eq_u32 s36, 1
    s_cselect_b64 vcc, -1, 0
    v_cndmask_b32 v15, v2, v3, vcc
    s_waitcnt lgkmcnt(0)
    s_mov_b32 s8, s64
    s_and_b32 s9, s65, 0xffff
    s_mov_b32 s10, 0x240000
    s_mov_b32 s11, 0x20000
    s_mov_b32 s12, s66
    s_and_b32 s13, s67, 0xffff
    s_mov_b32 s14, 0x1e6000
    s_mov_b32 s15, 0x20000
    s_mov_b32 s16, s68
    s_and_b32 s17, s69, 0xffff
    s_mov_b32 s18, 0xa2000
    s_mov_b32 s19, 0x20000
    s_mov_b32 s28, s82
    s_and_b32 s29, s83, 0xffff
    s_mov_b32 s30, 0x100
    s_mov_b32 s31, 0x20000
    s_mov_b32 s20, s84
    s_and_b32 s21, s85, 0xffff
    s_mov_b32 s22, 0x4000000
    s_mov_b32 s23, 0x20000
    s_mov_b32 s53, 0
    s_and_b32 s54, s39, 7
    s_mul_i32 s95, s54, 221184
    s_add_u32 s95, s95, s44
    s_add_u32 s96, s45, s53
    s_lshl_b32 s50, s54, 7
    s_add_u32 s97, s46, s50
    s_add_u32 s98, s47, s53
    s_add_u32 m0, s98, 0
    s_add_u32 s51, s97, 0
    buffer_load_dwordx4 v2, s[8:11], s51 offen lds
    s_add_u32 m0, s98, 1024
    s_add_u32 s51, s97, 9216
    buffer_load_dwordx4 v3, s[8:11], s51 offen lds
    s_cmp_lt_u32 s36, 2
    s_cbranch_scc0 L_nohalo_22
    s_lshl_b32 s56, s36, 10
    s_add_u32 s56, s56, s53
    s_add_u32 m0, s56, 56320
    s_lshl_b32 s50, s54, 7
    s_add_u32 s51, s48, s50
    buffer_load_dwordx4 v15, s[8:11], s51 offen lds
L_nohalo_22:
    s_add_u32 m0, s96, 0
    s_nop 0
    buffer_load_dwordx4 v8, s[12:15], s95 offen lds
    s_add_u32 m0, s96, 1024
    s_nop 0
    buffer_load_dwordx4 v9, s[12:15], s95 offen lds
    s_add_u32 m0, s96, 2048
    s_nop 0
    buffer_load_dwordx4 v10, s[12:15], s95 offen lds
    s_add_u32 m0, s96, 3072
    s_nop 0
    buffer_load_dwordx4 v11, s[12:15], s95 offen lds
    s_add_u32 m0, s96, 4096
    s_nop 0
    buffer_load_dwordx4 v12, s[12:15], s95 offen lds
    s_add_u32 m0, s96, 5120
    s_nop 0
    buffer_load_dwordx4 v13, s[12:15], s95 offen lds
    s_mov_b32 exec_hi, 0xffff
    s_add_u32 m0, s96, 6144
    s_nop 0
    buffer_load_dwordx4 v14, s[12:15], s95 offen lds
    s_mov_b32 exec_hi, -1
    s_xor_b32 s53, s53, 74752
    s_add_u32 s54, s54, 1
    s_cmp_eq_u32 s54, 9
    s_cselect_b32 s54, 0, s54
    s_mul_i32 s99, s39, 12
    s_add_u32 s99, s99, s37
    s_mul_i32 s99, s99, 101376
    s_add_u32 s99, s99, 20971520
    s_mov_b32 s101, s99
    s_lshl_b32 s55, s38, 1
    s_add_u32 s55, s55, s59
    s_lshl_b32 s55, s55, 7
    s_add_u32 s99, s99, s55
    s_add_u32 s99, s99, 1536
    v_mov_b32 v52, 0
    v_mov_b32 v53, 0
    v_mov_b32 v54, 0
    v_mov_b32 v55, 0
    s_mov_b64 exec, 0xff
    buffer_store_dwordx4 v[52:55], v7, s[20:23], s99 offen sc1
    s_mov_b64 exec, -1
    v_lshrrev_b32 v56, 4, v1
    s_mov_b32 s55, 7040
    v_mul_u32_u24 v4, s55, v56
    v_bfe_u32 v57, v1, 2, 2
    s_mov_b32 s55, 864
    v_mad_u32_u24 v4, v57, s55, v4
    v_and_b32 v57, 3, v1
    v_lshl_add_u32 v4, v57, 3, v4
    s_mul_i32 s55, s37, 224
    v_add_u32 v4, s55, v4
    v_and_b32 v57, 15, v1
    v_lshrrev_b32 v58, 1, v57
    v_xor_b32 v58, v58, v56
    v_lshlrev_b32 v57, 7, v57
    v_lshl_add_u32 v5, v58, 4, v57
    s_mul_i32 s55, s59, 10240
    s_add_u32 s55, s55, 56320
    v_add_u32 v5, s55, v5
    v_xor_b32 v6, 64, v5
    v_lshlrev_b32 v59, 2, v1
    v_mov_b32 v116, 0
    v_mov_b32 v117, 0
    v_mov_b32 v118, 0
    v_mov_b32 v119, 0
    v_mov_b32 v120, 0
    v_mov_b32 v121, 0
    v_mov_b32 v122, 0
    v_mov_b32 v123, 0
    v_mov_b32 v124, 0
    v_mov_b32 v125, 0
    v_mov_b32 v126, 0
    v_mov_b32 v127, 0
    v_mov_b32 v128, 0
    v_mov_b32 v129, 0
    v_mov_b32 v130, 0
    v_mov_b32 v131, 0
    v_mov_b32 v132, 0
    v_mov_b32 v133, 0
    v_mov_b32 v134, 0
    v_mov_b32 v135, 0
    v_mov_b32 v136, 0
    v_mov_b32 v137, 0
    v_mov_b32 v138, 0
    v_mov_b32 v139, 0
    v_mov_b32 v140, 0
    v_mov_b32 v141, 0
    v_mov_b32 v142, 0
    v_mov_b32 v143, 0
    v_mov_b32 v144, 0
    v_mov_b32 v145, 0
    v_mov_b32 v146, 0
    v_mov_b32 v147, 0
    v_mov_b32 v148, 0
    v_mov_b32 v149, 0
    v_mov_b32 v150, 0
    v_mov_b32 v151, 0
    v_mov_b32 v152, 0
    v_mov_b32 v153, 0
    v_mov_b32 v154, 0
    v_mov_b32 v155, 0
    v_mov_b32 v156, 0
    v_mov_b32 v157, 0
    v_mov_b32 v158, 0
    v_mov_b32 v159, 0
    v_mov_b32 v160, 0
    v_mov_b32 v161, 0
    v_mov_b32 v162, 0
    v_mov_b32 v163, 0
    v_mov_b32 v164, 0
    v_mov_b32 v165, 0
    v_mov_b32 v166, 0
    v_mov_b32 v167, 0
    v_mov_b32 v168, 0
    v_mov_b32 v169, 0
    v_mov_b32 v170, 0
    v_mov_b32 v171, 0
    v_mov_b32 v172, 0
    v_mov_b32 v173, 0
    v_mov_b32 v174, 0
    v_mov_b32 v175, 0
    v_mov_b32 v176, 0
    v_mov_b32 v177, 0
    v_mov_b32 v178, 0
    v_mov_b32 v179, 0
    v_mov_b32 v180, 0
    v_mov_b32 v181, 0
    v_mov_b32 v182, 0
    v_mov_b32 v183, 0
    v_mov_b32 v184, 0
    v_mov_b32 v185, 0
    v_mov_b32 v186, 0
    v_mov_b32 v187, 0
    v_mov_b32 v188, 0
    v_mov_b32 v189, 0
    v_mov_b32 v190, 0
    v_mov_b32 v191, 0
    v_mov_b32 v192, 0
    v_mov_b32 v193, 0
    v_mov_b32 v194, 0
    v_mov_b32 v195, 0
    v_mov_b32 v196, 0
    v_mov_b32 v197, 0
    v_mov_b32 v198, 0
    v_mov_b32 v199, 0
    v_mov_b32 v200, 0
    v_mov_b32 v201, 0
    v_mov_b32 v202, 0
    v_mov_b32 v203, 0
    v_mov_b32 v204, 0
    v_mov_b32 v205, 0
    v_mov_b32 v206, 0
    v_mov_b32 v207, 0
    v_mov_b32 v208, 0
    v_mov_b32 v209, 0
    v_mov_b32 v210, 0
    v_mov_b32 v211, 0
    v_mov_b32 v212, 0
    v_mov_b32 v213, 0
    v_mov_b32 v214, 0
    v_mov_b32 v215, 0
    v_mov_b32 v216, 0
    v_mov_b32 v217, 0
    v_mov_b32 v218, 0
    v_mov_b32 v219, 0
    v_mov_b32 v220, 0
    v_mov_b32 v221, 0
    v_mov_b32 v222, 0
    v_mov_b32 v223, 0
    v_mov_b32 v224, 0
    v_mov_b32 v225, 0
    v_mov_b32 v226, 0
    v_mov_b32 v227, 0
    v_mov_b32 v228, 0
    v_mov_b32 v229, 0
    v_mov_b32 v230, 0
    v_mov_b32 v231, 0
    v_mov_b32 v232, 0
    v_mov_b32 v233, 0
    v_mov_b32 v234, 0
    v_mov_b32 v235, 0
    v_mov_b32 v236, 0
    v_mov_b32 v237, 0
    v_mov_b32 v238, 0
    v_mov_b32 v239, 0
    v_mov_b32 v240, 0
    v_mov_b32 v241, 0
    v_mov_b32 v242, 0
    v_mov_b32 v243, 0
    v_mov_b32 v244, 0
    v_mov_b32 v245, 0
    v_mov_b32 v246, 0
    v_mov_b32 v247, 0
    v_mov_b32 v248, 0
    v_mov_b32 v249, 0
    v_mov_b32 v250, 0
    v_mov_b32 v251, 0
    v_mov_b32 v252, 0
    v_mov_b32 v253, 0
    v_mov_b32 v254, 0
    v_mov_b32 v255, 0
    s_waitcnt vmcnt(0)
    s_barrier
    s_mul_i32 s95, s54, 221184
    s_add_u32 s95, s95, s44
    s_add_u32 s96, s45, s53
    s_lshl_b32 s50, s54, 7
    s_add_u32 s97, s46, s50
    s_add_u32 s98, s47, s53
    s_add_u32 m0, s98, 0
    s_add_u32 s51, s97, 0
    buffer_load_dwordx4 v2, s[8:11], s51 offen lds
    s_add_u32 m0, s98, 1024
    s_add_u32 s51, s97, 9216
    buffer_load_dwordx4 v3, s[8:11], s51 offen lds
    s_cmp_lt_u32 s36, 2
    s_cbranch_scc0 L_nohalo_23
    s_lshl_b32 s56, s36, 10
    s_add_u32 s56, s56, s53
    s_add_u32 m0, s56, 56320
    s_lshl_b32 s50, s54, 7
    s_add_u32 s51, s48, s50
    buffer_load_dwordx4 v15, s[8:11], s51 offen lds
L_nohalo_23:
    s_add_u32 m0, s96, 0
    s_nop 0
    buffer_load_dwordx4 v8, s[12:15], s95 offen lds
    s_add_u32 m0, s96, 1024
    s_nop 0
    buffer_load_dwordx4 v9, s[12:15], s95 offen lds
    s_cmp_eq_u32 s36, 0
    s_cbranch_scc0 L_noat_24
    s_and_b32 s50, s2, 31
    s_lshl_b32 s50, s50, 2
    s_add_u32 s50, s50, 128
    v_mov_b32 v60, 1
    v_mov_b32 v61, s50
    s_mov_b64 exec, 1
    buffer_atomic_add v60, v61, s[28:31], 0 offen sc1
    s_mov_b64 exec, -1
L_noat_24:
    ds_read_b128 v[72:75], v5 offset:0
    ds_read_b64_tr_b16 v[16:17], v4 offset:0
    ds_read_b64_tr_b16 v[18:19], v4 offset:3456
    ds_read_b64_tr_b16 v[20:21], v4 offset:32
    ds_read_b64_tr_b16 v[22:23], v4 offset:3488
    ds_read_b64_tr_b16 v[24:25], v4 offset:64
    ds_read_b64_tr_b16 v[26:27], v4 offset:3520
    ds_read_b64_tr_b16 v[28:29], v4 offset:96
    ds_read_b64_tr_b16 v[30:31], v4 offset:3552
    ds_read_b64_tr_b16 v[32:33], v4 offset:128
    ds_read_b64_tr_b16 v[34:35], v4 offset:3584
    ds_read_b64_tr_b16 v[36:37], v4 offset:160
    ds_read_b64_tr_b16 v[38:39], v4 offset:3616
    ds_read_b64_tr_b16 v[40:41], v4 offset:192
    ds_read_b64_tr_b16 v[42:43], v4 offset:3648
    ds_read_b128 v[76:79], v5 offset:2048
    ds_read_b128 v[80:83], v5 offset:4096
    ds_read_b128 v[84:87], v5 offset:6144
    ds_read_b128 v[88:91], v5 offset:8192
    s_mov_b32 s52, 9
.p2align 6
L_qkv:
    s_waitcnt lgkmcnt(0)
    v_mfma_f32_16x16x32_bf16 v[116:119], v[16:19], v[72:75], v[116:119]
    ds_read_b128 v[92:95], v6 offset:0
    v_mfma_f32_16x16x32_bf16 v[120:123], v[20:23], v[72:75], v[120:123]
    ds_read_b64_tr_b16 v[44:45], v4 offset:28160
    v_mfma_f32_16x16x32_bf16 v[124:127], v[24:27], v[72:75], v[124:127]
    ds_read_b64_tr_b16 v[46:47], v4 offset:31616
    v_mfma_f32_16x16x32_bf16 v[128:131], v[28:31], v[72:75], v[128:131]
    ds_read_b64_tr_b16 v[48:49], v4 offset:28192
    s_cmp_eq_u32 s52, 1
    s_cbranch_scc1 L_nd_25
    s_add_u32 m0, s96, 2048
    s_nop 0
    buffer_load_dwordx4 v10, s[12:15], s95 offen lds
L_nd_25:
    v_mfma_f32_16x16x32_bf16 v[132:135], v[32:35], v[72:75], v[132:135]
    ds_read_b64_tr_b16 v[50:51], v4 offset:31648
    v_mfma_f32_16x16x32_bf16 v[136:139], v[36:39], v[72:75], v[136:139]
    ds_read_b64_tr_b16 v[52:53], v4 offset:28224
    v_mfma_f32_16x16x32_bf16 v[140:143], v[40:43], v[72:75], v[140:143]
    ds_read_b64_tr_b16 v[54:55], v4 offset:31680
    v_mfma_f32_16x16x32_bf16 v[144:147], v[16:19], v[76:79], v[144:147]
    ds_read_b64_tr_b16 v[56:57], v4 offset:28256
    s_cmp_eq_u32 s52, 1
    s_cbranch_scc1 L_nd_26
    s_add_u32 m0, s96, 3072
    s_nop 0
    buffer_load_dwordx4 v11, s[12:15], s95 offen lds
L_nd_26:
    v_mfma_f32_16x16x32_bf16 v[148:151], v[20:23], v[76:79], v[148:151]
    ds_read_b64_tr_b16 v[58:59], v4 offset:31712
    v_mfma_f32_16x16x32_bf16 v[152:155], v[24:27], v[76:79], v[152:155]
    ds_read_b64_tr_b16 v[60:61], v4 offset:28288
    v_mfma_f32_16x16x32_bf16 v[156:159], v[28:31], v[76:79], v[156:159]
    ds_read_b64_tr_b16 v[62:63], v4 offset:31744
    v_mfma_f32_16x16x32_bf16 v[160:163], v[32:35], v[76:79], v[160:163]
    ds_read_b64_tr_b16 v[64:65], v4 offset:28320
    s_cmp_eq_u32 s52, 1
    s_cbranch_scc1 L_nd_27
    s_add_u32 m0, s96, 4096
    s_nop 0
    buffer_load_dwordx4 v12, s[12:15], s95 offen lds
L_nd_27:
    v_mfma_f32_16x16x32_bf16 v[164:167], v[36:39], v[76:79], v[164:167]
    ds_read_b64_tr_b16 v[66:67], v4 offset:31776
    v_mfma_f32_16x16x32_bf16 v[168:171], v[40:43], v[76:79], v[168:171]
    ds_read_b64_tr_b16 v[68:69], v4 offset:28352
    v_mfma_f32_16x16x32_bf16 v[172:175], v[16:19], v[80:83], v[172:175]
    ds_read_b64_tr_b16 v[70:71], v4 offset:31808
    v_mfma_f32_16x16x32_bf16 v[176:179], v[20:23], v[80:83], v[176:179]
    ds_read_b128 v[96:99], v6 offset:2048
    s_cmp_eq_u32 s52, 1
    s_cbranch_scc1 L_nd_28
    s_add_u32 m0, s96, 5120
    s_nop 0
    buffer_load_dwordx4 v13, s[12:15], s95 offen lds
L_nd_28:
    v_mfma_f32_16x16x32_bf16 v[180:183], v[24:27], v[80:83], v[180:183]
    ds_read_b128 v[100:103], v6 offset:4096
    v_mfma_f32_16x16x32_bf16 v[184:187], v[28:31], v[80:83], v[184:187]
    ds_read_b128 v[104:107], v6 offset:6144
    v_mfma_f32_16x16x32_bf16 v[188:191], v[32:35], v[80:83], v[188:191]
    ds_read_b128 v[108:111], v6 offset:8192
    v_mfma_f32_16x16x32_bf16 v[192:195], v[36:39], v[80:83], v[192:195]
    s_cmp_eq_u32 s52, 1
    s_cbranch_scc1 L_nd_29
    s_mov_b32 exec_hi, 0xffff
    s_add_u32 m0, s96, 6144
    s_nop 0
    buffer_load_dwordx4 v14, s[12:15], s95 offen lds
    s_mov_b32 exec_hi, -1
L_nd_29:
    v_mfma_f32_16x16x32_bf16 v[196:199], v[40:43], v[80:83], v[196:199]
    v_mfma_f32_16x16x32_bf16 v[200:203], v[16:19], v[84:87], v[200:203]
    v_mfma_f32_16x16x32_bf16 v[204:207], v[20:23], v[84:87], v[204:207]
    v_mfma_f32_16x16x32_bf16 v[208:211], v[24:27], v[84:87], v[208:211]
    v_mfma_f32_16x16x32_bf16 v[212:215], v[28:31], v[84:87], v[212:215]
    v_mfma_f32_16x16x32_bf16 v[216:219], v[32:35], v[84:87], v[216:219]
    v_mfma_f32_16x16x32_bf16 v[220:223], v[36:39], v[84:87], v[220:223]
    v_mfma_f32_16x16x32_bf16 v[224:227], v[40:43], v[84:87], v[224:227]
    s_cmp_eq_u32 s59, 1
    s_cbranch_scc1 L_qkv_s0
    v_mfma_f32_16x16x32_bf16 v[228:231], v[16:19], v[88:91], v[228:231]
    v_mfma_f32_16x16x32_bf16 v[232:235], v[20:23], v[88:91], v[232:235]
    v_mfma_f32_16x16x32_bf16 v[236:239], v[24:27], v[88:91], v[236:239]
    v_mfma_f32_16x16x32_bf16 v[240:243], v[28:31], v[88:91], v[240:243]
    v_mfma_f32_16x16x32_bf16 v[244:247], v[32:35], v[88:91], v[244:247]
    v_mfma_f32_16x16x32_bf16 v[248:251], v[36:39], v[88:91], v[248:251]
    v_mfma_f32_16x16x32_bf16 v[252:255], v[40:43], v[88:91], v[252:255]
L_qkv_s0:
    s_waitcnt lgkmcnt(0)
    v_mfma_f32_16x16x32_bf16 v[116:119], v[44:47], v[92:95], v[116:119]
    v_mfma_f32_16x16x32_bf16 v[120:123], v[48:51], v[92:95], v[120:123]
    v_mfma_f32_16x16x32_bf16 v[124:127], v[52:55], v[92:95], v[124:127]
    v_mfma_f32_16x16x32_bf16 v[128:131], v[56:59], v[92:95], v[128:131]
    v_mfma_f32_16x16x32_bf16 v[132:135], v[60:63], v[92:95], v[132:135]
    v_mfma_f32_16x16x32_bf16 v[136:139], v[64:67], v[92:95], v[136:139]
    v_mfma_f32_16x16x32_bf16 v[140:143], v[68:71], v[92:95], v[140:143]
    v_mfma_f32_16x16x32_bf16 v[144:147], v[44:47], v[96:99], v[144:147]
    v_mfma_f32_16x16x32_bf16 v[148:151], v[48:51], v[96:99], v[148:151]
    v_mfma_f32_16x16x32_bf16 v[152:155], v[52:55], v[96:99], v[152:155]
    v_mfma_f32_16x16x32_bf16 v[156:159], v[56:59], v[96:99], v[156:159]
    v_mfma_f32_16x16x32_bf16 v[160:163], v[60:63], v[96:99], v[160:163]
    v_mfma_f32_16x16x32_bf16 v[164:167], v[64:67], v[96:99], v[164:167]
    v_mfma_f32_16x16x32_bf16 v[168:171], v[68:71], v[96:99], v[168:171]
    s_cmp_eq_u32 s53, 0
    s_mov_b32 s55, 74752
    s_cselect_b32 s55, 0xfffedc00, s55
    v_add_u32 v4, s55, v4
    v_add_u32 v5, s55, v5
    v_add_u32 v6, s55, v6
    s_xor_b32 s53, s53, 74752
    s_add_u32 s54, s54, 1
    s_cmp_eq_u32 s54, 9
    s_cselect_b32 s54, 0, s54
    s_mul_i32 s95, s54, 221184
    s_add_u32 s95, s95, s44
    s_add_u32 s96, s45, s53
    s_lshl_b32 s50, s54, 7
    s_add_u32 s97, s46, s50
    s_add_u32 s98, s47, s53
    s_waitcnt vmcnt(0)
    s_barrier
    v_mfma_f32_16x16x32_bf16 v[172:175], v[44:47], v[100:103], v[172:175]
    ds_read_b128 v[72:75], v5 offset:0
    ds_read_b64_tr_b16 v[16:17], v4 offset:0
    v_mfma_f32_16x16x32_bf16 v[176:179], v[48:51], v[100:103], v[176:179]
    ds_read_b64_tr_b16 v[18:19], v4 offset:3456
    ds_read_b64_tr_b16 v[20:21], v4 offset:32
    v_mfma_f32_16x16x32_bf16 v[180:183], v[52:55], v[100:103], v[180:183]
    ds_read_b64_tr_b16 v[22:23], v4 offset:3488
    ds_read_b64_tr_b16 v[24:25], v4 offset:64
    s_cmp_le_u32 s52, 2
    s_cbranch_scc1 L_nd_30
    s_add_u32 m0, s98, 0
    s_add_u32 s51, s97, 0
    buffer_load_dwordx4 v2, s[8:11], s51 offen lds
L_nd_30:
    v_mfma_f32_16x16x32_bf16 v[184:187], v[56:59], v[100:103], v[184:187]
    ds_read_b64_tr_b16 v[26:27], v4 offset:3520
    ds_read_b64_tr_b16 v[28:29], v4 offset:96
    v_mfma_f32_16x16x32_bf16 v[188:191], v[60:63], v[100:103], v[188:191]
    ds_read_b64_tr_b16 v[30:31], v4 offset:3552
    ds_read_b64_tr_b16 v[32:33], v4 offset:128
    v_mfma_f32_16x16x32_bf16 v[192:195], v[64:67], v[100:103], v[192:195]
    ds_read_b64_tr_b16 v[34:35], v4 offset:3584
    s_cmp_le_u32 s52, 2
    s_cbranch_scc1 L_nd_31
    s_add_u32 m0, s98, 1024
    s_add_u32 s51, s97, 9216
    buffer_load_dwordx4 v3, s[8:11], s51 offen lds
L_nd_31:
    v_mfma_f32_16x16x32_bf16 v[196:199], v[68:71], v[100:103], v[196:199]
    ds_read_b64_tr_b16 v[36:37], v4 offset:160
    v_mfma_f32_16x16x32_bf16 v[200:203], v[44:47], v[104:107], v[200:203]
    ds_read_b64_tr_b16 v[38:39], v4 offset:3616
    v_mfma_f32_16x16x32_bf16 v[204:207], v[48:51], v[104:107], v[204:207]
    ds_read_b64_tr_b16 v[40:41], v4 offset:192
    s_cmp_le_u32 s52, 2
    s_cbranch_scc1 L_nd_32
    s_cmp_lt_u32 s36, 2
    s_cbranch_scc0 L_nohalo_33
    s_lshl_b32 s56, s36, 10
    s_add_u32 s56, s56, s53
    s_add_u32 m0, s56, 56320
    s_lshl_b32 s50, s54, 7
    s_add_u32 s51, s48, s50
    buffer_load_dwordx4 v15, s[8:11], s51 offen lds
L_nohalo_33:
L_nd_32:
    v_mfma_f32_16x16x32_bf16 v[208:211], v[52:55], v[104:107], v[208:211]
    ds_read_b64_tr_b16 v[42:43], v4 offset:3648
    v_mfma_f32_16x16x32_bf16 v[212:215], v[56:59], v[104:107], v[212:215]
    ds_read_b128 v[76:79], v5 offset:2048
    v_mfma_f32_16x16x32_bf16 v[216:219], v[60:63], v[104:107], v[216:219]
    ds_read_b128 v[80:83], v5 offset:4096
    s_cmp_le_u32 s52, 2
    s_cbranch_scc1 L_nd_34
    s_add_u32 m0, s96, 0
    s_nop 0
    buffer_load_dwordx4 v8, s[12:15], s95 offen lds
L_nd_34:
    v_mfma_f32_16x16x32_bf16 v[220:223], v[64:67], v[104:107], v[220:223]
    ds_read_b128 v[84:87], v5 offset:6144
    v_mfma_f32_16x16x32_bf16 v[224:227], v[68:71], v[104:107], v[224:227]
    ds_read_b128 v[88:91], v5 offset:8192
    s_cmp_le_u32 s52, 2
    s_cbranch_scc1 L_nd_35
    s_add_u32 m0, s96, 1024
    s_nop 0
    buffer_load_dwordx4 v9, s[12:15], s95 offen lds
L_nd_35:
    s_cmp_eq_u32 s59, 1
    s_cbranch_scc1 L_qkv_s1
    v_mfma_f32_16x16x32_bf16 v[228:231], v[44:47], v[108:111], v[228:231]
    v_mfma_f32_16x16x32_bf16 v[232:235], v[48:51], v[108:111], v[232:235]
    v_mfma_f32_16x16x32_bf16 v[236:239], v[52:55], v[108:111], v[236:239]
    v_mfma_f32_16x16x32_bf16 v[240:243], v[56:59], v[108:111], v[240:243]
    v_mfma_f32_16x16x32_bf16 v[244:247], v[60:63], v[108:111], v[244:247]
    v_mfma_f32_16x16x32_bf16 v[248:251], v[64:67], v[108:111], v[248:251]
    v_mfma_f32_16x16x32_bf16 v[252:255], v[68:71], v[108:111], v[252:255]
L_qkv_s1:
    s_sub_u32 s52, s52, 1
    s_cmp_lg_u32 s52, 0
    s_cbranch_scc1 L_qkv
    s_waitcnt lgkmcnt(0)
    s_barrier
    v_lshrrev_b32 v56, 3, v1
    v_and_b32 v57, 7, v1
    v_bfe_u32 v58, v1, 4, 1
    v_lshlrev_b32 v58, 2, v58
    v_xor_b32 v57, v57, v58
    s_mov_b32 s55, 1152
    v_mul_u32_u24 v56, s55, v56
    v_lshl_add_u32 v8, v57, 4, v56
    s_mul_i32 s44, s38, 165888
    s_lshl_b32 s45, s36, 10
    s_mul_i32 s46, s36, 9216
    s_add_u32 s46, s46, s44
    s_cmp_lt_u32 s36, 2
    s_cbranch_scc0 L_nox_36
    s_add_u32 m0, s45, 161536
    s_add_u32 s50, s46, 147456
    buffer_load_dwordx4 v8, s[16:19], s50 offen lds
L_nox_36:
    s_add_u32 m0, s45, 145152
    s_add_u32 s50, s46, 0
    buffer_load_dwordx4 v8, s[16:19], s50 offen lds
    s_add_u32 m0, s45, 153344
    s_add_u32 s50, s46, 73728
    buffer_load_dwordx4 v8, s[16:19], s50 offen lds
    s_and_b32 s55, s39, 7
    s_mul_i32 s55, s55, 20736
    s_mul_i32 s56, s36, 2688
    s_add_u32 s55, s55, s56
    s_add_u32 s55, s55, s44
    v_lshlrev_b32 v14, 7, v1
    s_mov_b64 exec, 0x1fffff
    buffer_load_dword v15, v14, s[16:19], s55 offen
    s_mov_b64 exec, -1
    s_mul_i32 s55, s37, 7
    s_add_u32 s55, s55, 0
    s_mul_i32 s56, s55, 57
    s_lshr_b32 s56, s56, 9
    s_mul_i32 s50, s56, 44640
    s_lshl_b32 s55, s55, 5
    s_add_u32 s88, s55, s50
    s_mul_i32 s55, s37, 7
    s_add_u32 s55, s55, 1
    s_mul_i32 s56, s55, 57
    s_lshr_b32 s56, s56, 9
    s_mul_i32 s50, s56, 44640
    s_lshl_b32 s55, s55, 5
    s_add_u32 s89, s55, s50
    s_mul_i32 s55, s37, 7
    s_add_u32 s55, s55, 2
    s_mul_i32 s56, s55, 57
    s_lshr_b32 s56, s56, 9
    s_mul_i32 s50, s56, 44640
    s_lshl_b32 s55, s55, 5
    s_add_u32 s90, s55, s50
    s_mul_i32 s55, s37, 7
    s_add_u32 s55, s55, 3
    s_mul_i32 s56, s55, 57
    s_lshr_b32 s56, s56, 9
    s_mul_i32 s50, s56, 44640
    s_lshl_b32 s55, s55, 5
    s_add_u32 s91, s55, s50
    s_mul_i32 s55, s37, 7
    s_add_u32 s55, s55, 4
    s_mul_i32 s56, s55, 57
    s_lshr_b32 s56, s56, 9
    s_mul_i32 s50, s56, 44640
    s_lshl_b32 s55, s55, 5
    s_add_u32 s92, s55, s50
    s_mul_i32 s55, s37, 7
    s_add_u32 s55, s55, 5
    s_mul_i32 s56, s55, 57
    s_lshr_b32 s56, s56, 9
    s_mul_i32 s50, s56, 44640
    s_lshl_b32 s55, s55, 5
    s_add_u32 s93, s55, s50
    s_mul_i32 s55, s37, 7
    s_add_u32 s55, s55, 6
    s_mul_i32 s56, s55, 57
    s_lshr_b32 s56, s56, 9
    s_mul_i32 s50, s56, 44640
    s_lshl_b32 s55, s55, 5
    s_add_u32 s94, s55, s50
    v_and_b32 v56, 15, v1
    s_mov_b32 s55, 312
    v_mul_u32_u24 v56, s55, v56
    v_lshrrev_b32 v57, 4, v1
    v_lshl_add_u32 v56, v57, 3, v56
    s_mul_i32 s55, s59, 24960
    v_add_u32 v56, s55, v56
    v_add_u32 v57, s88, v56
    v_cvt_pk_bf16_f32 v16, v116, v117
    v_cvt_pk_bf16_f32 v17, v118, v119
    ds_write_b64 v57, v[16:17] offset:0
    v_cvt_pk_bf16_f32 v18, v144, v145
    v_cvt_pk_bf16_f32 v19, v146, v147
    ds_write_b64 v57, v[18:19] offset:4992
    v_cvt_pk_bf16_f32 v20, v172, v173
    v_cvt_pk_bf16_f32 v21, v174, v175
    ds_write_b64 v57, v[20:21] offset:9984
    v_cvt_pk_bf16_f32 v22, v200, v201
    v_cvt_pk_bf16_f32 v23, v202, v203
    ds_write_b64 v57, v[22:23] offset:14976
    s_cmp_eq_u32 s59, 1
    s_cbranch_scc1 L_qw_37
    v_cvt_pk_bf16_f32 v24, v228, v229
    v_cvt_pk_bf16_f32 v25, v230, v231
    ds_write_b64 v57, v[24:25] offset:19968
L_qw_37:
    v_add_u32 v57, s89, v56
    v_cvt_pk_bf16_f32 v26, v120, v121
    v_cvt_pk_bf16_f32 v27, v122, v123
    ds_write_b64 v57, v[26:27] offset:0
    v_cvt_pk_bf16_f32 v28, v148, v149
    v_cvt_pk_bf16_f32 v29, v150, v151
    ds_write_b64 v57, v[28:29] offset:4992
    v_cvt_pk_bf16_f32 v30, v176, v177
    v_cvt_pk_bf16_f32 v31, v178, v179
    ds_write_b64 v57, v[30:31] offset:9984
    v_cvt_pk_bf16_f32 v16, v204, v205
    v_cvt_pk_bf16_f32 v17, v206, v207
    ds_write_b64 v57, v[16:17] offset:14976
    s_cmp_eq_u32 s59, 1
    s_cbranch_scc1 L_qw_38
    v_cvt_pk_bf16_f32 v18, v232, v233
    v_cvt_pk_bf16_f32 v19, v234, v235
    ds_write_b64 v57, v[18:19] offset:19968
L_qw_38:
    v_add_u32 v57, s90, v56
    v_cvt_pk_bf16_f32 v20, v124, v125
    v_cvt_pk_bf16_f32 v21, v126, v127
    ds_write_b64 v57, v[20:21] offset:0
    v_cvt_pk_bf16_f32 v22, v152, v153
    v_cvt_pk_bf16_f32 v23, v154, v155
    ds_write_b64 v57, v[22:23] offset:4992
    v_cvt_pk_bf16_f32 v24, v180, v181
    v_cvt_pk_bf16_f32 v25, v182, v183
    ds_write_b64 v57, v[24:25] offset:9984
    v_cvt_pk_bf16_f32 v26, v208, v209
    v_cvt_pk_bf16_f32 v27, v210, v211
    ds_write_b64 v57, v[26:27] offset:14976
    s_cmp_eq_u32 s59, 1
    s_cbranch_scc1 L_qw_39
    v_cvt_pk_bf16_f32 v28, v236, v237
    v_cvt_pk_bf16_f32 v29, v238, v239
    ds_write_b64 v57, v[28:29] offset:19968
L_qw_39:
    v_add_u32 v57, s91, v56
    v_cvt_pk_bf16_f32 v30, v128, v129
    v_cvt_pk_bf16_f32 v31, v130, v131
    ds_write_b64 v57, v[30:31] offset:0
    v_cvt_pk_bf16_f32 v16, v156, v157
    v_cvt_pk_bf16_f32 v17, v158, v159
    ds_write_b64 v57, v[16:17] offset:4992
    v_cvt_pk_bf16_f32 v18, v184, v185
    v_cvt_pk_bf16_f32 v19, v186, v187
    ds_write_b64 v57, v[18:19] offset:9984
    v_cvt_pk_bf16_f32 v20, v212, v213
    v_cvt_pk_bf16_f32 v21, v214, v215
    ds_write_b64 v57, v[20:21] offset:14976
    s_cmp_eq_u32 s59, 1
    s_cbranch_scc1 L_qw_40
    v_cvt_pk_bf16_f32 v22, v240, v241
    v_cvt_pk_bf16_f32 v23, v242, v243
    ds_write_b64 v57, v[22:23] offset:19968
L_qw_40:
    v_add_u32 v57, s92, v56
    v_cvt_pk_bf16_f32 v24, v132, v133
    v_cvt_pk_bf16_f32 v25, v134, v135
    ds_write_b64 v57, v[24:25] offset:0
    v_cvt_pk_bf16_f32 v26, v160, v161
    v_cvt_pk_bf16_f32 v27, v162, v163
    ds_write_b64 v57, v[26:27] offset:4992
    v_cvt_pk_bf16_f32 v28, v188, v189
    v_cvt_pk_bf16_f32 v29, v190, v191
    ds_write_b64 v57, v[28:29] offset:9984
    v_cvt_pk_bf16_f32 v30, v216, v217
    v_cvt_pk_bf16_f32 v31, v218, v219
    ds_write_b64 v57, v[30:31] offset:14976
    s_cmp_eq_u32 s59, 1
    s_cbranch_scc1 L_qw_41
    v_cvt_pk_bf16_f32 v16, v244, v245
    v_cvt_pk_bf16_f32 v17, v246, v247
    ds_write_b64 v57, v[16:17] offset:19968
L_qw_41:
    v_add_u32 v57, s93, v56
    v_cvt_pk_bf16_f32 v18, v136, v137
    v_cvt_pk_bf16_f32 v19, v138, v139
    ds_write_b64 v57, v[18:19] offset:0
    v_cvt_pk_bf16_f32 v20, v164, v165
    v_cvt_pk_bf16_f32 v21, v166, v167
    ds_write_b64 v57, v[20:21] offset:4992
    v_cvt_pk_bf16_f32 v22, v192, v193
    v_cvt_pk_bf16_f32 v23, v194, v195
    ds_write_b64 v57, v[22:23] offset:9984
    v_cvt_pk_bf16_f32 v24, v220, v221
    v_cvt_pk_bf16_f32 v25, v222, v223
    ds_write_b64 v57, v[24:25] offset:14976
    s_cmp_eq_u32 s59, 1
    s_cbranch_scc1 L_qw_42
    v_cvt_pk_bf16_f32 v26, v248, v249
    v_cvt_pk_bf16_f32 v27, v250, v251
    ds_write_b64 v57, v[26:27] offset:19968
L_qw_42:
    s_cmp_eq_u32 s37, 3
    s_cbranch_scc1 L_qw_done
    v_add_u32 v57, s94, v56
    v_cvt_pk_bf16_f32 v28, v140, v141
    v_cvt_pk_bf16_f32 v29, v142, v143
    ds_write_b64 v57, v[28:29] offset:0
    v_cvt_pk_bf16_f32 v30, v168, v169
    v_cvt_pk_bf16_f32 v31, v170, v171
    ds_write_b64 v57, v[30:31] offset:4992
    v_cvt_pk_bf16_f32 v16, v196, v197
    v_cvt_pk_bf16_f32 v17, v198, v199
    ds_write_b64 v57, v[16:17] offset:9984
    v_cvt_pk_bf16_f32 v18, v224, v225
    v_cvt_pk_bf16_f32 v19, v226, v227
    ds_write_b64 v57, v[18:19] offset:14976
    s_cmp_eq_u32 s59, 1
    s_cbranch_scc1 L_qw_43
    v_cvt_pk_bf16_f32 v20, v252, v253
    v_cvt_pk_bf16_f32 v21, v254, v255
    ds_write_b64 v57, v[20:21] offset:19968
L_qw_43:
L_qw_done:
    s_waitcnt lgkmcnt(0)
    s_barrier
    v_bfe_u32 v56, v1, 3, 2
    v_lshrrev_b32 v57, 5, v1
    v_lshl_add_u32 v10, v56, 2, v57
    s_lshl_b32 s55, s36, 4
    v_add_u32 v10, s55, v10
    v_and_b32 v56, 7, v1
    v_mul_u32_u24 v56, 36, v56
    s_mov_b32 s55, 312
    v_mad_u32_u24 v11, v10, s55, v56
    v_add_u32 v12, 4992, v11
    s_mov_b32 s8, s76
    s_and_b32 s9, s77, 0xffff
    s_mov_b32 s10, 0x510000
    s_mov_b32 s11, 0x20000
    s_and_b32 s5, s39, 7
    s_lshl_b32 s5, s5, 3
    s_add_u32 s5, s5, s36
    s_mul_i32 s5, s5, 54
    v_add_u32 v245, s5, v1
    v_lshrrev_b32 v246, 6, v245
    s_mov_b32 s56, 7282
    v_mul_u32_u24 v247, s56, v246
    v_lshrrev_b32 v247, 16, v247
    s_movk_i32 s56, 1152
    v_mad_u32_u24 v245, v247, s56, v245
    v_lshlrev_b32 v14, 7, v245
    s_mul_i32 s5, s38, 1327104
    ds_read2_b32 v[16:17], v12 offset0:0 offset1:1
    ds_read2_b32 v[18:19], v12 offset0:2 offset1:3
    ds_read2_b32 v[20:21], v12 offset0:4 offset1:5
    ds_read2_b32 v[22:23], v12 offset0:6 offset1:7
    ds_read_b32 v24, v12 offset:32
    ds_read2_b32 v[26:27], v12 offset0:156 offset1:157
    ds_read2_b32 v[28:29], v12 offset0:158 offset1:159
    ds_read2_b32 v[30:31], v12 offset0:160 offset1:161
    ds_read2_b32 v[32:33], v12 offset0:162 offset1:163
    ds_read_b32 v34, v12 offset:656
    v_add_u32 v13, 45552, v11
    ds_read2_b32 v[36:37], v13 offset0:0 offset1:1
    ds_read2_b32 v[38:39], v13 offset0:2 offset1:3
    ds_read2_b32 v[40:41], v13 offset0:4 offset1:5
    ds_read2_b32 v[42:43], v13 offset0:6 offset1:7
    ds_read_b32 v44, v13 offset:32
    ds_read2_b32 v[46:47], v13 offset0:156 offset1:157
    ds_read2_b32 v[48:49], v13 offset0:158 offset1:159
    ds_read2_b32 v[50:51], v13 offset0:160 offset1:161
    ds_read2_b32 v[52:53], v13 offset0:162 offset1:163
    ds_read_b32 v54, v13 offset:656
    s_add_u32 s50, s5, 0
    s_mov_b32 exec_hi, 0x3fffff
    buffer_load_dword v15, v14, s[8:11], s50 offen
    s_mov_b32 exec_hi, -1
    s_waitcnt lgkmcnt(5)
    v_dot2_f32_bf16 v223, v16, v36, 0
    s_nop 2
    v_add_u32 v13, 46800, v11
    v_dot2c_f32_bf16 v223, v17, v37
    ds_read2_b32 v[56:57], v13 offset0:0 offset1:1
    v_dot2c_f32_bf16 v223, v18, v38
    ds_read2_b32 v[58:59], v13 offset0:2 offset1:3
    v_dot2c_f32_bf16 v223, v19, v39
    ds_read2_b32 v[60:61], v13 offset0:4 offset1:5
    v_dot2c_f32_bf16 v223, v20, v40
    ds_read2_b32 v[62:63], v13 offset0:6 offset1:7
    v_dot2c_f32_bf16 v223, v21, v41
    ds_read_b32 v64, v13 offset:32
    v_dot2c_f32_bf16 v223, v22, v42
    ds_read2_b32 v[66:67], v13 offset0:156 offset1:157
    v_dot2c_f32_bf16 v223, v23, v43
    ds_read2_b32 v[68:69], v13 offset0:158 offset1:159
    v_dot2c_f32_bf16 v223, v24, v44
    ds_read2_b32 v[70:71], v13 offset0:160 offset1:161
    ds_read2_b32 v[72:73], v13 offset0:162 offset1:163
    ds_read_b32 v74, v13 offset:656
    s_waitcnt lgkmcnt(10)
    v_dot2_f32_bf16 v222, v16, v46, 0
    s_nop 2
    v_add_u32 v13, 48048, v11
    v_dot2_f32_bf16 v231, v26, v46, 0
    s_nop 2
    ds_read2_b32 v[76:77], v13 offset0:0 offset1:1
    v_dot2c_f32_bf16 v222, v17, v47
    ds_read2_b32 v[78:79], v13 offset0:2 offset1:3
    v_dot2c_f32_bf16 v231, v27, v47
    ds_read2_b32 v[80:81], v13 offset0:4 offset1:5
    v_dot2c_f32_bf16 v222, v18, v48
    ds_read2_b32 v[82:83], v13 offset0:6 offset1:7
    v_dot2c_f32_bf16 v231, v28, v48
    ds_read_b32 v84, v13 offset:32
    v_dot2c_f32_bf16 v222, v19, v49
    v_dot2c_f32_bf16 v231, v29, v49
    v_dot2c_f32_bf16 v222, v20, v50
    v_dot2c_f32_bf16 v231, v30, v50
    v_dot2c_f32_bf16 v222, v21, v51
    v_dot2c_f32_bf16 v231, v31, v51
    v_dot2c_f32_bf16 v222, v22, v52
    v_dot2c_f32_bf16 v231, v32, v52
    v_dot2c_f32_bf16 v222, v23, v53
    v_dot2c_f32_bf16 v231, v33, v53
    v_dot2c_f32_bf16 v222, v24, v54
    v_dot2c_f32_bf16 v231, v34, v54
    s_waitcnt lgkmcnt(10)
    v_dot2_f32_bf16 v221, v16, v56, 0
    s_nop 2
    ds_read2_b32 v[86:87], v13 offset0:156 offset1:157
    v_dot2_f32_bf16 v230, v26, v56, 0
    s_nop 2
    ds_read2_b32 v[88:89], v13 offset0:158 offset1:159
    v_dot2c_f32_bf16 v221, v17, v57
    ds_read2_b32 v[90:91], v13 offset0:160 offset1:161
    v_dot2c_f32_bf16 v230, v27, v57
    ds_read2_b32 v[92:93], v13 offset0:162 offset1:163
    v_dot2c_f32_bf16 v221, v18, v58
    ds_read_b32 v94, v13 offset:656
    v_dot2c_f32_bf16 v230, v28, v58
    v_dot2c_f32_bf16 v221, v19, v59
    v_dot2c_f32_bf16 v230, v29, v59
    v_dot2c_f32_bf16 v221, v20, v60
    v_dot2c_f32_bf16 v230, v30, v60
    v_dot2c_f32_bf16 v221, v21, v61
    v_dot2c_f32_bf16 v230, v31, v61
    v_dot2c_f32_bf16 v221, v22, v62
    v_dot2c_f32_bf16 v230, v32, v62
    v_dot2c_f32_bf16 v221, v23, v63
    v_dot2c_f32_bf16 v230, v33, v63
    v_dot2c_f32_bf16 v221, v24, v64
    v_dot2c_f32_bf16 v230, v34, v64
    s_waitcnt lgkmcnt(10)
    v_dot2_f32_bf16 v220, v16, v66, 0
    s_nop 2
    v_add_u32 v13, 49296, v11
    v_dot2_f32_bf16 v229, v26, v66, 0
    s_nop 2
    ds_read2_b32 v[96:97], v13 offset0:0 offset1:1
    v_dot2c_f32_bf16 v220, v17, v67
    ds_read2_b32 v[98:99], v13 offset0:2 offset1:3
    v_dot2c_f32_bf16 v229, v27, v67
    ds_read2_b32 v[100:101], v13 offset0:4 offset1:5
    v_dot2c_f32_bf16 v220, v18, v68
    ds_read2_b32 v[102:103], v13 offset0:6 offset1:7
    v_dot2c_f32_bf16 v229, v28, v68
    ds_read_b32 v104, v13 offset:32
    v_dot2c_f32_bf16 v220, v19, v69
    v_dot2c_f32_bf16 v229, v29, v69
    v_dot2c_f32_bf16 v220, v20, v70
    v_dot2c_f32_bf16 v229, v30, v70
    v_dot2c_f32_bf16 v220, v21, v71
    v_dot2c_f32_bf16 v229, v31, v71
    v_dot2c_f32_bf16 v220, v22, v72
    v_dot2c_f32_bf16 v229, v32, v72
    v_dot2c_f32_bf16 v220, v23, v73
    v_dot2c_f32_bf16 v229, v33, v73
    v_dot2c_f32_bf16 v220, v24, v74
    v_dot2c_f32_bf16 v229, v34, v74
    s_waitcnt lgkmcnt(10)
    v_dot2_f32_bf16 v219, v16, v76, 0
    s_nop 2
    ds_read2_b32 v[106:107], v13 offset0:156 offset1:157
    v_dot2_f32_bf16 v228, v26, v76, 0
    s_nop 2
    ds_read2_b32 v[108:109], v13 offset0:158 offset1:159
    v_dot2c_f32_bf16 v219, v17, v77
    ds_read2_b32 v[110:111], v13 offset0:160 offset1:161
    v_dot2c_f32_bf16 v228, v27, v77
    ds_read2_b32 v[112:113], v13 offset0:162 offset1:163
    v_dot2c_f32_bf16 v219, v18, v78
    ds_read_b32 v114, v13 offset:656
    v_dot2c_f32_bf16 v228, v28, v78
    v_dot2c_f32_bf16 v219, v19, v79
    v_dot2c_f32_bf16 v228, v29, v79
    v_dot2c_f32_bf16 v219, v20, v80
    v_dot2c_f32_bf16 v228, v30, v80
    v_dot2c_f32_bf16 v219, v21, v81
    v_dot2c_f32_bf16 v228, v31, v81
    v_dot2c_f32_bf16 v219, v22, v82
    v_dot2c_f32_bf16 v228, v32, v82
    v_dot2c_f32_bf16 v219, v23, v83
    v_dot2c_f32_bf16 v228, v33, v83
    v_dot2c_f32_bf16 v219, v24, v84
    v_dot2c_f32_bf16 v228, v34, v84
    s_waitcnt lgkmcnt(10)
    v_dot2_f32_bf16 v218, v16, v86, 0
    s_nop 2
    v_add_u32 v13, 50544, v11
    v_dot2_f32_bf16 v227, v26, v86, 0
    s_nop 2
    ds_read2_b32 v[116:117], v13 offset0:0 offset1:1
    v_dot2c_f32_bf16 v218, v17, v87
    ds_read2_b32 v[118:119], v13 offset0:2 offset1:3
    v_dot2c_f32_bf16 v227, v27, v87
    ds_read2_b32 v[120:121], v13 offset0:4 offset1:5
    v_dot2c_f32_bf16 v218, v18, v88
    ds_read2_b32 v[122:123], v13 offset0:6 offset1:7
    v_dot2c_f32_bf16 v227, v28, v88
    ds_read_b32 v124, v13 offset:32
    v_dot2c_f32_bf16 v218, v19, v89
    v_dot2c_f32_bf16 v227, v29, v89
    v_dot2c_f32_bf16 v218, v20, v90
    v_dot2c_f32_bf16 v227, v30, v90
    v_dot2c_f32_bf16 v218, v21, v91
    v_dot2c_f32_bf16 v227, v31, v91
    v_dot2c_f32_bf16 v218, v22, v92
    v_dot2c_f32_bf16 v227, v32, v92
    v_dot2c_f32_bf16 v218, v23, v93
    v_dot2c_f32_bf16 v227, v33, v93
    v_dot2c_f32_bf16 v218, v24, v94
    v_dot2c_f32_bf16 v227, v34, v94
    s_waitcnt lgkmcnt(10)
    v_dot2_f32_bf16 v217, v16, v96, 0
    s_nop 2
    v_add_u32 v9, 90480, v11
    v_dot2_f32_bf16 v226, v26, v96, 0
    s_nop 2
    ds_read2_b32 v[126:127], v9 offset0:0 offset1:1
    v_dot2c_f32_bf16 v217, v17, v97
    ds_read2_b32 v[128:129], v9 offset0:2 offset1:3
    v_dot2c_f32_bf16 v226, v27, v97
    ds_read2_b32 v[130:131], v9 offset0:4 offset1:5
    v_dot2c_f32_bf16 v217, v18, v98
    ds_read2_b32 v[132:133], v9 offset0:6 offset1:7
    v_dot2c_f32_bf16 v226, v28, v98
    ds_read_b32 v134, v9 offset:32
    v_dot2c_f32_bf16 v217, v19, v99
    v_dot2c_f32_bf16 v226, v29, v99
    v_dot2c_f32_bf16 v217, v20, v100
    v_dot2c_f32_bf16 v226, v30, v100
    v_dot2c_f32_bf16 v217, v21, v101
    v_dot2c_f32_bf16 v226, v31, v101
    v_dot2c_f32_bf16 v217, v22, v102
    v_dot2c_f32_bf16 v226, v32, v102
    v_dot2c_f32_bf16 v217, v23, v103
    v_dot2c_f32_bf16 v226, v33, v103
    v_dot2c_f32_bf16 v217, v24, v104
    v_dot2c_f32_bf16 v226, v34, v104
    s_waitcnt lgkmcnt(10)
    v_dot2_f32_bf16 v216, v16, v106, 0
    s_nop 2
    ds_read2_b32 v[136:137], v9 offset0:156 offset1:157
    v_dot2_f32_bf16 v225, v26, v106, 0
    s_nop 2
    ds_read2_b32 v[138:139], v9 offset0:158 offset1:159
    v_dot2c_f32_bf16 v216, v17, v107
    ds_read2_b32 v[140:141], v9 offset0:160 offset1:161
    v_dot2c_f32_bf16 v225, v27, v107
    ds_read2_b32 v[142:143], v9 offset0:162 offset1:163
    v_dot2c_f32_bf16 v216, v18, v108
    ds_read_b32 v144, v9 offset:656
    v_dot2c_f32_bf16 v225, v28, v108
    v_dot2c_f32_bf16 v216, v19, v109
    v_dot2c_f32_bf16 v225, v29, v109
    v_dot2c_f32_bf16 v216, v20, v110
    v_dot2c_f32_bf16 v225, v30, v110
    v_dot2c_f32_bf16 v216, v21, v111
    v_dot2c_f32_bf16 v225, v31, v111
    v_dot2c_f32_bf16 v216, v22, v112
    v_dot2c_f32_bf16 v225, v32, v112
    v_dot2c_f32_bf16 v216, v23, v113
    v_dot2c_f32_bf16 v225, v33, v113
    v_dot2c_f32_bf16 v216, v24, v114
    v_dot2c_f32_bf16 v225, v34, v114
    s_waitcnt lgkmcnt(10)
    v_dot2_f32_bf16 v224, v26, v116, 0
    s_nop 2
    v_add_u32 v9, 91728, v11
    v_dot2c_f32_bf16 v224, v27, v117
    ds_read2_b32 v[146:147], v9 offset0:0 offset1:1
    v_dot2c_f32_bf16 v224, v28, v118
    ds_read2_b32 v[148:149], v9 offset0:2 offset1:3
    v_dot2c_f32_bf16 v224, v29, v119
    ds_read2_b32 v[150:151], v9 offset0:4 offset1:5
    v_dot2c_f32_bf16 v224, v30, v120
    ds_read2_b32 v[152:153], v9 offset0:6 offset1:7
    v_dot2c_f32_bf16 v224, v31, v121
    ds_read_b32 v154, v9 offset:32
    v_dot2c_f32_bf16 v224, v32, v122
    v_dot2c_f32_bf16 v224, v33, v123
    v_dot2c_f32_bf16 v224, v34, v124
    s_add_u32 s50, s5, 73728
    s_mov_b32 exec_hi, 0x3fffff
    buffer_load_dword v15, v14, s[8:11], s50 offen
    s_mov_b32 exec_hi, -1
    s_nop 2
    s_cmp_eq_u32 s39, 0
    s_cbranch_scc0 L_nomask
    v_mov_b32 v244, 0xf149f2ca
    v_cmp_gt_u32 vcc, 2, v10
    s_nop 1
    v_cndmask_b32 v217, v217, v244, vcc
    v_cmp_gt_u32 vcc, 4, v10
    s_nop 1
    v_cndmask_b32 v218, v218, v244, vcc
    v_cmp_gt_u32 vcc, 6, v10
    s_nop 1
    v_cndmask_b32 v219, v219, v244, vcc
    v_cmp_gt_u32 vcc, 8, v10
    s_nop 1
    v_cndmask_b32 v220, v220, v244, vcc
    v_cmp_gt_u32 vcc, 10, v10
    s_nop 1
    v_cndmask_b32 v221, v221, v244, vcc
    v_cmp_gt_u32 vcc, 12, v10
    s_nop 1
    v_cndmask_b32 v222, v222, v244, vcc
    v_cmp_gt_u32 vcc, 14, v10
    s_nop 1
    v_cndmask_b32 v223, v223, v244, vcc
    v_cmp_gt_u32 vcc, 2, v10
    s_nop 1
    v_cndmask_b32 v226, v226, v244, vcc
    v_cmp_gt_u32 vcc, 4, v10
    s_nop 1
    v_cndmask_b32 v227, v227, v244, vcc
    v_cmp_gt_u32 vcc, 6, v10
    s_nop 1
    v_cndmask_b32 v228, v228, v244, vcc
    v_cmp_gt_u32 vcc, 8, v10
    s_nop 1
    v_cndmask_b32 v229, v229, v244, vcc
    v_cmp_gt_u32 vcc, 10, v10
    s_nop 1
    v_cndmask_b32 v230, v230, v244, vcc
    v_cmp_gt_u32 vcc, 12, v10
    s_nop 1
    v_cndmask_b32 v231, v231, v244, vcc
L_nomask:
    s_mov_b32 s55, 0x3eae1a93
    ds_read2_b32 v[156:157], v9 offset0:156 offset1:157
    ds_read2_b32 v[158:159], v9 offset0:158 offset1:159
    ds_read2_b32 v[160:161], v9 offset0:160 offset1:161
    ds_read2_b32 v[162:163], v9 offset0:162 offset1:163
    ds_read_b32 v164, v9 offset:656
    v_add_u32 v9, 92976, v11
    ds_read2_b32 v[166:167], v9 offset0:0 offset1:1
    ds_read2_b32 v[168:169], v9 offset0:2 offset1:3
    ds_read2_b32 v[170:171], v9 offset0:4 offset1:5
    ds_read2_b32 v[172:173], v9 offset0:6 offset1:7
    ds_read_b32 v174, v9 offset:32
    ds_read2_b32 v[176:177], v9 offset0:156 offset1:157
    ds_read2_b32 v[178:179], v9 offset0:158 offset1:159
    ds_read2_b32 v[180:181], v9 offset0:160 offset1:161
    ds_read2_b32 v[182:183], v9 offset0:162 offset1:163
    ds_read_b32 v184, v9 offset:656
    v_add_u32 v9, 94224, v11
    ds_read2_b32 v[186:187], v9 offset0:0 offset1:1
    ds_read2_b32 v[188:189], v9 offset0:2 offset1:3
    ds_read2_b32 v[190:191], v9 offset0:4 offset1:5
    ds_read2_b32 v[192:193], v9 offset0:6 offset1:7
    ds_read_b32 v194, v9 offset:32
    ds_read2_b32 v[196:197], v9 offset0:156 offset1:157
    ds_read2_b32 v[198:199], v9 offset0:158 offset1:159
    ds_read2_b32 v[200:201], v9 offset0:160 offset1:161
    ds_read2_b32 v[202:203], v9 offset0:162 offset1:163
    ds_read_b32 v204, v9 offset:656
    v_add_u32 v9, 95472, v11
    ds_read2_b32 v[206:207], v9 offset0:0 offset1:1
    ds_read2_b32 v[208:209], v9 offset0:2 offset1:3
    ds_read2_b32 v[210:211], v9 offset0:4 offset1:5
    ds_read2_b32 v[212:213], v9 offset0:6 offset1:7
    ds_read_b32 v214, v9 offset:32
    v_max3_f32 v240, v216, v217, v218
    v_max3_f32 v240, v240, v219, v220
    v_max3_f32 v240, v240, v221, v222
    v_max_f32 v240, v240, v223
    v_sub_f32 v216, v216, v240
    v_sub_f32 v217, v217, v240
    v_sub_f32 v218, v218, v240
    v_sub_f32 v219, v219, v240
    v_sub_f32 v220, v220, v240
    v_sub_f32 v221, v221, v240
    v_sub_f32 v222, v222, v240
    v_sub_f32 v223, v223, v240
    v_mul_f32 v216, s55, v216
    v_mul_f32 v217, s55, v217
    v_mul_f32 v218, s55, v218
    v_mul_f32 v219, s55, v219
    v_mul_f32 v220, s55, v220
    v_mul_f32 v221, s55, v221
    v_mul_f32 v222, s55, v222
    v_mul_f32 v223, s55, v223
    v_exp_f32 v216, v216
    v_exp_f32 v217, v217
    v_exp_f32 v218, v218
    v_exp_f32 v219, v219
    v_exp_f32 v220, v220
    v_exp_f32 v221, v221
    v_exp_f32 v222, v222
    v_exp_f32 v223, v223
    s_nop 0
    v_add_f32 v242, v216, v217
    v_add_f32 v242, v242, v218
    v_add_f32 v242, v242, v219
    v_add_f32 v242, v242, v220
    v_add_f32 v242, v242, v221
    v_add_f32 v242, v242, v222
    v_add_f32 v242, v242, v223
    v_rcp_f32 v242, v242
    s_nop 0
    v_mul_f32 v216, v216, v242
    v_mul_f32 v217, v217, v242
    v_mul_f32 v218, v218, v242
    v_mul_f32 v219, v219, v242
    v_mul_f32 v220, v220, v242
    v_mul_f32 v221, v221, v242
    v_mul_f32 v222, v222, v242
    v_mul_f32 v223, v223, v242
    v_cvt_pk_bf16_f32 v232, v223, v222
    v_cvt_pk_bf16_f32 v233, v221, v220
    v_cvt_pk_bf16_f32 v234, v219, v218
    v_cvt_pk_bf16_f32 v235, v217, v216
    v_max3_f32 v241, v224, v225, v226
    v_max3_f32 v241, v241, v227, v228
    v_max3_f32 v241, v241, v229, v230
    v_max_f32 v241, v241, v231
    v_sub_f32 v224, v224, v241
    v_sub_f32 v225, v225, v241
    v_sub_f32 v226, v226, v241
    v_sub_f32 v227, v227, v241
    v_sub_f32 v228, v228, v241
    v_sub_f32 v229, v229, v241
    v_sub_f32 v230, v230, v241
    v_sub_f32 v231, v231, v241
    v_mul_f32 v224, s55, v224
    v_mul_f32 v225, s55, v225
    v_mul_f32 v226, s55, v226
    v_mul_f32 v227, s55, v227
    v_mul_f32 v228, s55, v228
    v_mul_f32 v229, s55, v229
    v_mul_f32 v230, s55, v230
    v_mul_f32 v231, s55, v231
    v_exp_f32 v224, v224
    v_exp_f32 v225, v225
    v_exp_f32 v226, v226
    v_exp_f32 v227, v227
    v_exp_f32 v228, v228
    v_exp_f32 v229, v229
    v_exp_f32 v230, v230
    v_exp_f32 v231, v231
    s_nop 0
    v_add_f32 v243, v224, v225
    v_add_f32 v243, v243, v226
    v_add_f32 v243, v243, v227
    v_add_f32 v243, v243, v228
    v_add_f32 v243, v243, v229
    v_add_f32 v243, v243, v230
    v_add_f32 v243, v243, v231
    v_rcp_f32 v243, v243
    s_nop 0
    v_mul_f32 v224, v224, v243
    v_mul_f32 v225, v225, v243
    v_mul_f32 v226, v226, v243
    v_mul_f32 v227, v227, v243
    v_mul_f32 v228, v228, v243
    v_mul_f32 v229, v229, v243
    v_mul_f32 v230, v230, v243
    v_mul_f32 v231, v231, v243
    v_cvt_pk_bf16_f32 v236, 0, v231
    v_cvt_pk_bf16_f32 v237, v230, v229
    v_cvt_pk_bf16_f32 v238, v228, v227
    v_cvt_pk_bf16_f32 v239, v226, v225
    v_cvt_pk_bf16_f32 v245, v224, 0
    v_cvt_pk_bf16_f32 v246, 0, v224
    s_mov_b32 s55, 0x05040100
    s_mov_b32 s56, 0x07060302
    s_waitcnt lgkmcnt(0)
    v_dot2_f32_bf16 v54, v206, v245, 0
    v_dot2_f32_bf16 v55, v206, v246, 0
    v_dot2_f32_bf16 v56, v207, v245, 0
    v_dot2_f32_bf16 v57, v207, v246, 0
    v_dot2_f32_bf16 v58, v208, v245, 0
    v_dot2_f32_bf16 v59, v208, v246, 0
    v_dot2_f32_bf16 v60, v209, v245, 0
    v_dot2_f32_bf16 v61, v209, v246, 0
    v_dot2_f32_bf16 v62, v210, v245, 0
    v_dot2_f32_bf16 v63, v210, v246, 0
    v_dot2_f32_bf16 v64, v211, v245, 0
    v_dot2_f32_bf16 v65, v211, v246, 0
    v_dot2_f32_bf16 v66, v212, v245, 0
    v_dot2_f32_bf16 v67, v212, v246, 0
    v_dot2_f32_bf16 v68, v213, v245, 0
    v_dot2_f32_bf16 v69, v213, v246, 0
    v_dot2_f32_bf16 v70, v214, v245, 0
    v_dot2_f32_bf16 v71, v214, v246, 0
    v_perm_b32 v80, v136, v126, s55
    v_perm_b32 v81, v136, v126, s56
    v_dot2_f32_bf16 v36, v80, v232, 0
    v_dot2c_f32_bf16 v54, v80, v236
    v_dot2_f32_bf16 v37, v81, v232, 0
    v_dot2c_f32_bf16 v55, v81, v236
    v_perm_b32 v82, v137, v127, s55
    v_perm_b32 v83, v137, v127, s56
    v_dot2_f32_bf16 v38, v82, v232, 0
    v_dot2c_f32_bf16 v56, v82, v236
    v_dot2_f32_bf16 v39, v83, v232, 0
    v_dot2c_f32_bf16 v57, v83, v236
    v_perm_b32 v84, v138, v128, s55
    v_perm_b32 v85, v138, v128, s56
    v_dot2_f32_bf16 v40, v84, v232, 0
    v_dot2c_f32_bf16 v58, v84, v236
    v_dot2_f32_bf16 v41, v85, v232, 0
    v_dot2c_f32_bf16 v59, v85, v236
    v_perm_b32 v86, v139, v129, s55
    v_perm_b32 v87, v139, v129, s56
    v_dot2_f32_bf16 v42, v86, v232, 0
    v_dot2c_f32_bf16 v60, v86, v236
    v_dot2_f32_bf16 v43, v87, v232, 0
    v_dot2c_f32_bf16 v61, v87, v236
    v_perm_b32 v88, v140, v130, s55
    v_perm_b32 v89, v140, v130, s56
    v_dot2_f32_bf16 v44, v88, v232, 0
    v_dot2c_f32_bf16 v62, v88, v236
    v_dot2_f32_bf16 v45, v89, v232, 0
    v_dot2c_f32_bf16 v63, v89, v236
    v_perm_b32 v90, v141, v131, s55
    v_perm_b32 v91, v141, v131, s56
    v_dot2_f32_bf16 v46, v90, v232, 0
    v_dot2c_f32_bf16 v64, v90, v236
    v_dot2_f32_bf16 v47, v91, v232, 0
    v_dot2c_f32_bf16 v65, v91, v236
    v_perm_b32 v92, v142, v132, s55
    v_perm_b32 v93, v142, v132, s56
    v_dot2_f32_bf16 v48, v92, v232, 0
    v_dot2c_f32_bf16 v66, v92, v236
    v_dot2_f32_bf16 v49, v93, v232, 0
    v_dot2c_f32_bf16 v67, v93, v236
    v_perm_b32 v94, v143, v133, s55
    v_perm_b32 v95, v143, v133, s56
    v_dot2_f32_bf16 v50, v94, v232, 0
    v_dot2c_f32_bf16 v68, v94, v236
    v_dot2_f32_bf16 v51, v95, v232, 0
    v_dot2c_f32_bf16 v69, v95, v236
    v_perm_b32 v96, v144, v134, s55
    v_perm_b32 v97, v144, v134, s56
    v_dot2_f32_bf16 v52, v96, v232, 0
    v_dot2c_f32_bf16 v70, v96, v236
    v_dot2_f32_bf16 v53, v97, v232, 0
    v_dot2c_f32_bf16 v71, v97, v236
    s_add_u32 s50, s5, 147456
    s_mov_b32 exec_hi, 0x3fffff
    buffer_load_dword v15, v14, s[8:11], s50 offen
    s_mov_b32 exec_hi, -1
    v_perm_b32 v98, v156, v146, s55
    v_perm_b32 v99, v156, v146, s56
    v_dot2c_f32_bf16 v36, v98, v233
    v_dot2c_f32_bf16 v54, v98, v237
    v_dot2c_f32_bf16 v37, v99, v233
    v_dot2c_f32_bf16 v55, v99, v237
    v_perm_b32 v100, v157, v147, s55
    v_perm_b32 v101, v157, v147, s56
    v_dot2c_f32_bf16 v38, v100, v233
    v_dot2c_f32_bf16 v56, v100, v237
    v_dot2c_f32_bf16 v39, v101, v233
    v_dot2c_f32_bf16 v57, v101, v237
    v_perm_b32 v102, v158, v148, s55
    v_perm_b32 v103, v158, v148, s56
    v_dot2c_f32_bf16 v40, v102, v233
    v_dot2c_f32_bf16 v58, v102, v237
    v_dot2c_f32_bf16 v41, v103, v233
    v_dot2c_f32_bf16 v59, v103, v237
    v_perm_b32 v104, v159, v149, s55
    v_perm_b32 v105, v159, v149, s56
    v_dot2c_f32_bf16 v42, v104, v233
    v_dot2c_f32_bf16 v60, v104, v237
    v_dot2c_f32_bf16 v43, v105, v233
    v_dot2c_f32_bf16 v61, v105, v237
    v_perm_b32 v106, v160, v150, s55
    v_perm_b32 v107, v160, v150, s56
    v_dot2c_f32_bf16 v44, v106, v233
    v_dot2c_f32_bf16 v62, v106, v237
    v_dot2c_f32_bf16 v45, v107, v233
    v_dot2c_f32_bf16 v63, v107, v237
    v_perm_b32 v108, v161, v151, s55
    v_perm_b32 v109, v161, v151, s56
    v_dot2c_f32_bf16 v46, v108, v233
    v_dot2c_f32_bf16 v64, v108, v237
    v_dot2c_f32_bf16 v47, v109, v233
    v_dot2c_f32_bf16 v65, v109, v237
    v_perm_b32 v110, v162, v152, s55
    v_perm_b32 v111, v162, v152, s56
    v_dot2c_f32_bf16 v48, v110, v233
    v_dot2c_f32_bf16 v66, v110, v237
    v_dot2c_f32_bf16 v49, v111, v233
    v_dot2c_f32_bf16 v67, v111, v237
    v_perm_b32 v80, v163, v153, s55
    v_perm_b32 v81, v163, v153, s56
    v_dot2c_f32_bf16 v50, v80, v233
    v_dot2c_f32_bf16 v68, v80, v237
    v_dot2c_f32_bf16 v51, v81, v233
    v_dot2c_f32_bf16 v69, v81, v237
    v_perm_b32 v82, v164, v154, s55
    v_perm_b32 v83, v164, v154, s56
    v_dot2c_f32_bf16 v52, v82, v233
    v_dot2c_f32_bf16 v70, v82, v237
    v_dot2c_f32_bf16 v53, v83, v233
    v_dot2c_f32_bf16 v71, v83, v237
    v_perm_b32 v84, v176, v166, s55
    v_perm_b32 v85, v176, v166, s56
    v_dot2c_f32_bf16 v36, v84, v234
    v_dot2c_f32_bf16 v54, v84, v238
    v_dot2c_f32_bf16 v37, v85, v234
    v_dot2c_f32_bf16 v55, v85, v238
    v_perm_b32 v86, v177, v167, s55
    v_perm_b32 v87, v177, v167, s56
    v_dot2c_f32_bf16 v38, v86, v234
    v_dot2c_f32_bf16 v56, v86, v238
    v_dot2c_f32_bf16 v39, v87, v234
    v_dot2c_f32_bf16 v57, v87, v238
    v_perm_b32 v88, v178, v168, s55
    v_perm_b32 v89, v178, v168, s56
    v_dot2c_f32_bf16 v40, v88, v234
    v_dot2c_f32_bf16 v58, v88, v238
    v_dot2c_f32_bf16 v41, v89, v234
    v_dot2c_f32_bf16 v59, v89, v238
    v_perm_b32 v90, v179, v169, s55
    v_perm_b32 v91, v179, v169, s56
    v_dot2c_f32_bf16 v42, v90, v234
    v_dot2c_f32_bf16 v60, v90, v238
    v_dot2c_f32_bf16 v43, v91, v234
    v_dot2c_f32_bf16 v61, v91, v238
    v_perm_b32 v92, v180, v170, s55
    v_perm_b32 v93, v180, v170, s56
    v_dot2c_f32_bf16 v44, v92, v234
    v_dot2c_f32_bf16 v62, v92, v238
    v_dot2c_f32_bf16 v45, v93, v234
    v_dot2c_f32_bf16 v63, v93, v238
    v_perm_b32 v94, v181, v171, s55
    v_perm_b32 v95, v181, v171, s56
    v_dot2c_f32_bf16 v46, v94, v234
    v_dot2c_f32_bf16 v64, v94, v238
    v_dot2c_f32_bf16 v47, v95, v234
    v_dot2c_f32_bf16 v65, v95, v238
    v_perm_b32 v96, v182, v172, s55
    v_perm_b32 v97, v182, v172, s56
    v_dot2c_f32_bf16 v48, v96, v234
    v_dot2c_f32_bf16 v66, v96, v238
    v_dot2c_f32_bf16 v49, v97, v234
    v_dot2c_f32_bf16 v67, v97, v238
    v_perm_b32 v98, v183, v173, s55
    v_perm_b32 v99, v183, v173, s56
    v_dot2c_f32_bf16 v50, v98, v234
    v_dot2c_f32_bf16 v68, v98, v238
    v_dot2c_f32_bf16 v51, v99, v234
    v_dot2c_f32_bf16 v69, v99, v238
    v_perm_b32 v100, v184, v174, s55
    v_perm_b32 v101, v184, v174, s56
    v_dot2c_f32_bf16 v52, v100, v234
    v_dot2c_f32_bf16 v70, v100, v238
    v_dot2c_f32_bf16 v53, v101, v234
    v_dot2c_f32_bf16 v71, v101, v238
    v_perm_b32 v102, v196, v186, s55
    v_perm_b32 v103, v196, v186, s56
    v_dot2c_f32_bf16 v36, v102, v235
    v_dot2c_f32_bf16 v54, v102, v239
    v_dot2c_f32_bf16 v37, v103, v235
    v_dot2c_f32_bf16 v55, v103, v239
    v_perm_b32 v104, v197, v187, s55
    v_perm_b32 v105, v197, v187, s56
    v_dot2c_f32_bf16 v38, v104, v235
    v_dot2c_f32_bf16 v56, v104, v239
    v_dot2c_f32_bf16 v39, v105, v235
    v_dot2c_f32_bf16 v57, v105, v239
    v_perm_b32 v106, v198, v188, s55
    v_perm_b32 v107, v198, v188, s56
    v_dot2c_f32_bf16 v40, v106, v235
    v_dot2c_f32_bf16 v58, v106, v239
    v_dot2c_f32_bf16 v41, v107, v235
    v_dot2c_f32_bf16 v59, v107, v239
    v_perm_b32 v108, v199, v189, s55
    v_perm_b32 v109, v199, v189, s56
    v_dot2c_f32_bf16 v42, v108, v235
    v_dot2c_f32_bf16 v60, v108, v239
    v_dot2c_f32_bf16 v43, v109, v235
    v_dot2c_f32_bf16 v61, v109, v239
    v_perm_b32 v110, v200, v190, s55
    v_perm_b32 v111, v200, v190, s56
    v_dot2c_f32_bf16 v44, v110, v235
    v_dot2c_f32_bf16 v62, v110, v239
    v_dot2c_f32_bf16 v45, v111, v235
    v_dot2c_f32_bf16 v63, v111, v239
    v_perm_b32 v80, v201, v191, s55
    v_perm_b32 v81, v201, v191, s56
    v_dot2c_f32_bf16 v46, v80, v235
    v_dot2c_f32_bf16 v64, v80, v239
    v_dot2c_f32_bf16 v47, v81, v235
    v_dot2c_f32_bf16 v65, v81, v239
    v_perm_b32 v82, v202, v192, s55
    v_perm_b32 v83, v202, v192, s56
    v_dot2c_f32_bf16 v48, v82, v235
    v_dot2c_f32_bf16 v66, v82, v239
    v_dot2c_f32_bf16 v49, v83, v235
    v_dot2c_f32_bf16 v67, v83, v239
    v_perm_b32 v84, v203, v193, s55
    v_perm_b32 v85, v203, v193, s56
    v_dot2c_f32_bf16 v50, v84, v235
    v_dot2c_f32_bf16 v68, v84, v239
    v_dot2c_f32_bf16 v51, v85, v235
    v_dot2c_f32_bf16 v69, v85, v239
    v_perm_b32 v86, v204, v194, s55
    v_perm_b32 v87, v204, v194, s56
    v_dot2c_f32_bf16 v52, v86, v235
    v_dot2c_f32_bf16 v70, v86, v239
    v_dot2c_f32_bf16 v53, v87, v235
    v_dot2c_f32_bf16 v71, v87, v239
    s_nop 2
    v_cvt_pk_bf16_f32 v16, v36, v37
    v_cvt_pk_bf16_f32 v17, v38, v39
    v_cvt_pk_bf16_f32 v18, v40, v41
    v_cvt_pk_bf16_f32 v19, v42, v43
    v_cvt_pk_bf16_f32 v20, v44, v45
    v_cvt_pk_bf16_f32 v21, v46, v47
    v_cvt_pk_bf16_f32 v22, v48, v49
    v_cvt_pk_bf16_f32 v23, v50, v51
    v_cvt_pk_bf16_f32 v24, v52, v53
    ds_write2_b32 v12, v16, v17 offset0:0 offset1:1
    ds_write2_b32 v12, v18, v19 offset0:2 offset1:3
    ds_write2_b32 v12, v20, v21 offset0:4 offset1:5
    ds_write2_b32 v12, v22, v23 offset0:6 offset1:7
    ds_write_b32 v12, v24 offset:32
    v_cvt_pk_bf16_f32 v26, v54, v55
    v_cvt_pk_bf16_f32 v27, v56, v57
    v_cvt_pk_bf16_f32 v28, v58, v59
    v_cvt_pk_bf16_f32 v29, v60, v61
    v_cvt_pk_bf16_f32 v30, v62, v63
    v_cvt_pk_bf16_f32 v31, v64, v65
    v_cvt_pk_bf16_f32 v32, v66, v67
    v_cvt_pk_bf16_f32 v33, v68, v69
    v_cvt_pk_bf16_f32 v34, v70, v71
    ds_write2_b32 v12, v26, v27 offset0:156 offset1:157
    ds_write2_b32 v12, v28, v29 offset0:158 offset1:159
    ds_write2_b32 v12, v30, v31 offset0:160 offset1:161
    ds_write2_b32 v12, v32, v33 offset0:162 offset1:163
    ds_write_b32 v12, v34 offset:656
    s_waitcnt vmcnt(3) lgkmcnt(0)
    s_barrier
    s_cmp_lt_u32 s36, 2
    s_cbranch_scc0 L_nox_44
    s_add_u32 m0, s45, 61312
    s_add_u32 s50, s46, 147584
    buffer_load_dwordx4 v8, s[16:19], s50 offen lds
L_nox_44:
    s_add_u32 m0, s45, 44928
    s_add_u32 s50, s46, 128
    buffer_load_dwordx4 v8, s[16:19], s50 offen lds
    s_add_u32 m0, s45, 53120
    s_add_u32 s50, s46, 73856
    buffer_load_dwordx4 v8, s[16:19], s50 offen lds
    s_cmp_lt_u32 s36, 2
    s_cbranch_scc0 L_nox_45
    s_add_u32 m0, s45, 79744
    s_add_u32 s50, s46, 147712
    buffer_load_dwordx4 v8, s[16:19], s50 offen lds
L_nox_45:
    s_add_u32 m0, s45, 63360
    s_add_u32 s50, s46, 256
    buffer_load_dwordx4 v8, s[16:19], s50 offen lds
    s_add_u32 m0, s45, 71552
    s_add_u32 s50, s46, 73984
    buffer_load_dwordx4 v8, s[16:19], s50 offen lds
    s_cmp_lt_u32 s36, 2
    s_cbranch_scc0 L_nox_46
    s_add_u32 m0, s45, 98176
    s_add_u32 s50, s46, 147840
    buffer_load_dwordx4 v8, s[16:19], s50 offen lds
L_nox_46:
    s_add_u32 m0, s45, 81792
    s_add_u32 s50, s46, 384
    buffer_load_dwordx4 v8, s[16:19], s50 offen lds
    s_add_u32 m0, s45, 89984
    s_add_u32 s50, s46, 74112
    buffer_load_dwordx4 v8, s[16:19], s50 offen lds
    s_cmp_lt_u32 s36, 2
    s_cbranch_scc0 L_nox_47
    s_add_u32 m0, s45, 116608
    s_add_u32 s50, s46, 147968
    buffer_load_dwordx4 v8, s[16:19], s50 offen lds
L_nox_47:
    s_add_u32 m0, s45, 100224
    s_add_u32 s50, s46, 512
    buffer_load_dwordx4 v8, s[16:19], s50 offen lds
    s_add_u32 m0, s45, 108416
    s_add_u32 s50, s46, 74240
    buffer_load_dwordx4 v8, s[16:19], s50 offen lds
    s_cmp_lt_u32 s36, 2
    s_cbranch_scc0 L_nox_48
    s_add_u32 m0, s45, 135040
    s_add_u32 s50, s46, 148096
    buffer_load_dwordx4 v8, s[16:19], s50 offen lds
L_nox_48:
    s_add_u32 m0, s45, 118656
    s_add_u32 s50, s46, 640
    buffer_load_dwordx4 v8, s[16:19], s50 offen lds
    s_add_u32 m0, s45, 126848
    s_add_u32 s50, s46, 74368
    buffer_load_dwordx4 v8, s[16:19], s50 offen lds
    v_lshrrev_b32 v90, 5, v1
    v_lshlrev_b32 v90, 3, v90
    v_bfe_u32 v91, v1, 2, 2
    v_add_u32 v90, v90, v91
    v_lshlrev_b32 v90, 7, v90
    v_bfe_u32 v91, v1, 4, 1
    v_lshl_add_u32 v90, v91, 5, v90
    v_and_b32 v91, 3, v1
    v_lshl_add_u32 v90, v91, 3, v90
    v_bfe_u32 v91, v1, 3, 1
    v_xor_b32 v91, s59, v91
    v_lshl_add_u32 v90, v91, 6, v90
    v_add_u32 v2, 44928, v90
    v_add_u32 v3, 100224, v90
    v_add_u32 v4, 145152, v90
    v_and_b32 v90, 31, v1
    s_mov_b32 s55, 312
    v_mul_u32_u24 v6, s55, v90
    v_lshrrev_b32 v90, 5, v1
    v_lshl_add_u32 v6, v90, 4, v6
    s_mul_i32 s55, s37, 9984
    s_add_u32 s55, s55, 4992
    v_add_u32 v6, s55, v6
    ds_read_b64 v[48:49], v6 offset:0
    ds_read_b64 v[50:51], v6 offset:8
    ds_read_b64 v[52:53], v6 offset:32
    ds_read_b64 v[54:55], v6 offset:40
    ds_read_b64 v[56:57], v6 offset:64
    ds_read_b64 v[58:59], v6 offset:72
    ds_read_b64 v[60:61], v6 offset:96
    ds_read_b64 v[62:63], v6 offset:104
    ds_read_b64 v[64:65], v6 offset:128
    ds_read_b64 v[66:67], v6 offset:136
    ds_read_b64 v[68:69], v6 offset:160
    ds_read_b64 v[70:71], v6 offset:168
    ds_read_b64 v[72:73], v6 offset:192
    ds_read_b64 v[74:75], v6 offset:200
    ds_read_b64 v[76:77], v6 offset:224
    ds_read_b64 v[78:79], v6 offset:232
    ds_read_b64 v[80:81], v6 offset:256
    ds_read_b64 v[82:83], v6 offset:264
    s_mul_i32 s55, s38, 12288
    s_add_u32 s55, s55, s101
    s_lshl_b32 s56, s59, 11
    s_add_u32 s55, s55, s56
    s_add_u32 s55, s55, 52224
    ds_read_b64_tr_b16 v[16:17], v4 offset:0
    ds_read_b64_tr_b16 v[18:19], v4 offset:512
    ds_read_b64_tr_b16 v[20:21], v4 offset:2048
    ds_read_b64_tr_b16 v[22:23], v4 offset:2560
    ds_read_b64_tr_b16 v[24:25], v4 offset:4096
    ds_read_b64_tr_b16 v[26:27], v4 offset:4608
    ds_read_b64_tr_b16 v[28:29], v4 offset:6144
    ds_read_b64_tr_b16 v[30:31], v4 offset:6656
    ds_read_b64_tr_b16 v[32:33], v4 offset:8192
    ds_read_b64_tr_b16 v[34:35], v4 offset:8704
    ds_read_b64_tr_b16 v[36:37], v4 offset:10240
    ds_read_b64_tr_b16 v[38:39], v4 offset:10752
    s_waitcnt lgkmcnt(10)
    v_mfma_f32_32x32x16_bf16 v[96:111], v[16:19], v[48:51], 0
    ds_read_b64_tr_b16 v[40:41], v4 offset:12288
    ds_read_b64_tr_b16 v[42:43], v4 offset:12800
    s_waitcnt lgkmcnt(10)
    v_mfma_f32_32x32x16_bf16 v[96:111], v[20:23], v[52:55], v[96:111]
    ds_read_b64_tr_b16 v[44:45], v4 offset:14336
    ds_read_b64_tr_b16 v[46:47], v4 offset:14848
    s_waitcnt lgkmcnt(10)
    v_mfma_f32_32x32x16_bf16 v[96:111], v[24:27], v[56:59], v[96:111]
    ds_read_b64_tr_b16 v[16:17], v4 offset:16384
    ds_read_b64_tr_b16 v[18:19], v4 offset:16896
    s_waitcnt lgkmcnt(10)
    v_mfma_f32_32x32x16_bf16 v[96:111], v[28:31], v[60:63], v[96:111]
    s_waitcnt lgkmcnt(8)
    v_mfma_f32_32x32x16_bf16 v[96:111], v[32:35], v[64:67], v[96:111]
    s_waitcnt lgkmcnt(6)
    v_mfma_f32_32x32x16_bf16 v[96:111], v[36:39], v[68:71], v[96:111]
    s_waitcnt lgkmcnt(4)
    v_mfma_f32_32x32x16_bf16 v[96:111], v[40:43], v[72:75], v[96:111]
    s_waitcnt lgkmcnt(2)
    v_mfma_f32_32x32x16_bf16 v[96:111], v[44:47], v[76:79], v[96:111]
    s_waitcnt lgkmcnt(0)
    v_mfma_f32_32x32x16_bf16 v[96:111], v[16:19], v[80:83], v[96:111]
    s_waitcnt vmcnt(6)
    s_barrier
    ds_read_b64_tr_b16 v[16:17], v2 offset:0
    ds_read_b64_tr_b16 v[18:19], v2 offset:512
    ds_read_b64_tr_b16 v[20:21], v2 offset:2048
    ds_read_b64_tr_b16 v[22:23], v2 offset:2560
    ds_read_b64_tr_b16 v[24:25], v2 offset:4096
    ds_read_b64_tr_b16 v[26:27], v2 offset:4608
    ds_read_b64_tr_b16 v[28:29], v2 offset:6144
    ds_read_b64_tr_b16 v[30:31], v2 offset:6656
    ds_read_b64_tr_b16 v[32:33], v2 offset:8192
    ds_read_b64_tr_b16 v[34:35], v2 offset:8704
    ds_read_b64_tr_b16 v[36:37], v2 offset:10240
    ds_read_b64_tr_b16 v[38:39], v2 offset:10752
    s_waitcnt lgkmcnt(10)
    v_mfma_f32_32x32x16_bf16 v[112:127], v[16:19], v[48:51], 0
    ds_read_b64_tr_b16 v[40:41], v2 offset:12288
    ds_read_b64_tr_b16 v[42:43], v2 offset:12800
    s_waitcnt lgkmcnt(10)
    v_mfma_f32_32x32x16_bf16 v[112:127], v[20:23], v[52:55], v[112:127]
    ds_read_b64_tr_b16 v[44:45], v2 offset:14336
    ds_read_b64_tr_b16 v[46:47], v2 offset:14848
    s_waitcnt lgkmcnt(10)
    v_mfma_f32_32x32x16_bf16 v[112:127], v[24:27], v[56:59], v[112:127]
    ds_read_b64_tr_b16 v[16:17], v2 offset:16384
    ds_read_b64_tr_b16 v[18:19], v2 offset:16896
    s_waitcnt lgkmcnt(10)
    v_mfma_f32_32x32x16_bf16 v[112:127], v[28:31], v[60:63], v[112:127]
    ds_read_b64_tr_b16 v[20:21], v2 offset:18432
    ds_read_b64_tr_b16 v[22:23], v2 offset:18944
    s_nop 3
    s_add_u32 s50, s55, 0
    v_cvt_pk_bf16_f32 v128, v96, v97
    v_cvt_pk_bf16_f32 v129, v98, v99
    v_cvt_pk_bf16_f32 v130, v100, v101
    v_cvt_pk_bf16_f32 v131, v102, v103
    buffer_store_dwordx4 v[128:131], v7, s[20:23], s50 offen offset:0 sc1
    v_cvt_pk_bf16_f32 v132, v104, v105
    v_cvt_pk_bf16_f32 v133, v106, v107
    v_cvt_pk_bf16_f32 v134, v108, v109
    v_cvt_pk_bf16_f32 v135, v110, v111
    buffer_store_dwordx4 v[132:135], v7, s[20:23], s50 offen offset:1024 sc1
    s_waitcnt lgkmcnt(10)
    v_mfma_f32_32x32x16_bf16 v[112:127], v[32:35], v[64:67], v[112:127]
    ds_read_b64_tr_b16 v[24:25], v2 offset:20480
    ds_read_b64_tr_b16 v[26:27], v2 offset:20992
    s_waitcnt lgkmcnt(10)
    v_mfma_f32_32x32x16_bf16 v[112:127], v[36:39], v[68:71], v[112:127]
    ds_read_b64_tr_b16 v[28:29], v2 offset:22528
    ds_read_b64_tr_b16 v[30:31], v2 offset:23040
    s_waitcnt lgkmcnt(10)
    v_mfma_f32_32x32x16_bf16 v[112:127], v[40:43], v[72:75], v[112:127]
    ds_read_b64_tr_b16 v[32:33], v2 offset:24576
    ds_read_b64_tr_b16 v[34:35], v2 offset:25088
    s_waitcnt lgkmcnt(10)
    v_mfma_f32_32x32x16_bf16 v[112:127], v[44:47], v[76:79], v[112:127]
    ds_read_b64_tr_b16 v[36:37], v2 offset:26624
    ds_read_b64_tr_b16 v[38:39], v2 offset:27136
    s_waitcnt lgkmcnt(10)
    v_mfma_f32_32x32x16_bf16 v[112:127], v[16:19], v[80:83], v[112:127]
    ds_read_b64_tr_b16 v[40:41], v2 offset:28672
    ds_read_b64_tr_b16 v[42:43], v2 offset:29184
    s_waitcnt lgkmcnt(10)
    v_mfma_f32_32x32x16_bf16 v[96:111], v[20:23], v[48:51], 0
    ds_read_b64_tr_b16 v[44:45], v2 offset:30720
    ds_read_b64_tr_b16 v[46:47], v2 offset:31232
    s_waitcnt lgkmcnt(10)
    v_mfma_f32_32x32x16_bf16 v[96:111], v[24:27], v[52:55], v[96:111]
    ds_read_b64_tr_b16 v[16:17], v2 offset:32768
    ds_read_b64_tr_b16 v[18:19], v2 offset:33280
    s_waitcnt lgkmcnt(10)
    v_mfma_f32_32x32x16_bf16 v[96:111], v[28:31], v[56:59], v[96:111]
    ds_read_b64_tr_b16 v[20:21], v2 offset:34816
    ds_read_b64_tr_b16 v[22:23], v2 offset:35328
    s_waitcnt lgkmcnt(10)
    v_mfma_f32_32x32x16_bf16 v[96:111], v[32:35], v[60:63], v[96:111]
    s_nop 3
    s_add_u32 s50, s55, 4096
    v_cvt_pk_bf16_f32 v136, v112, v113
    v_cvt_pk_bf16_f32 v137, v114, v115
    v_cvt_pk_bf16_f32 v138, v116, v117
    v_cvt_pk_bf16_f32 v139, v118, v119
    buffer_store_dwordx4 v[136:139], v7, s[20:23], s50 offen offset:0 sc1
    v_cvt_pk_bf16_f32 v140, v120, v121
    v_cvt_pk_bf16_f32 v141, v122, v123
    v_cvt_pk_bf16_f32 v142, v124, v125
    v_cvt_pk_bf16_f32 v143, v126, v127
    buffer_store_dwordx4 v[140:143], v7, s[20:23], s50 offen offset:1024 sc1
    s_waitcnt lgkmcnt(8)
    v_mfma_f32_32x32x16_bf16 v[96:111], v[36:39], v[64:67], v[96:111]
    s_waitcnt lgkmcnt(6)
    v_mfma_f32_32x32x16_bf16 v[96:111], v[40:43], v[68:71], v[96:111]
    s_waitcnt lgkmcnt(4)
    v_mfma_f32_32x32x16_bf16 v[96:111], v[44:47], v[72:75], v[96:111]
    s_waitcnt lgkmcnt(2)
    v_mfma_f32_32x32x16_bf16 v[96:111], v[16:19], v[76:79], v[96:111]
    s_waitcnt lgkmcnt(0)
    v_mfma_f32_32x32x16_bf16 v[96:111], v[20:23], v[80:83], v[96:111]
    s_waitcnt vmcnt(4)
    s_barrier
    s_cmp_lt_u32 s36, 2
    s_cbranch_scc0 L_nox_49
    s_add_u32 m0, s45, 161536
    s_add_u32 s50, s46, 148224
    buffer_load_dwordx4 v8, s[16:19], s50 offen lds
L_nox_49:
    s_add_u32 m0, s45, 145152
    s_add_u32 s50, s46, 768
    buffer_load_dwordx4 v8, s[16:19], s50 offen lds
    s_add_u32 m0, s45, 153344
    s_add_u32 s50, s46, 74496
    buffer_load_dwordx4 v8, s[16:19], s50 offen lds
    s_cmp_lt_u32 s36, 2
    s_cbranch_scc0 L_nox_50
    s_add_u32 m0, s45, 61312
    s_add_u32 s50, s46, 148352
    buffer_load_dwordx4 v8, s[16:19], s50 offen lds
L_nox_50:
    s_add_u32 m0, s45, 44928
    s_add_u32 s50, s46, 896
    buffer_load_dwordx4 v8, s[16:19], s50 offen lds
    s_add_u32 m0, s45, 53120
    s_add_u32 s50, s46, 74624
    buffer_load_dwordx4 v8, s[16:19], s50 offen lds
    s_cmp_lt_u32 s36, 2
    s_cbranch_scc0 L_nox_51
    s_add_u32 m0, s45, 79744
    s_add_u32 s50, s46, 148480
    buffer_load_dwordx4 v8, s[16:19], s50 offen lds
L_nox_51:
    s_add_u32 m0, s45, 63360
    s_add_u32 s50, s46, 1024
    buffer_load_dwordx4 v8, s[16:19], s50 offen lds
    s_add_u32 m0, s45, 71552
    s_add_u32 s50, s46, 74752
    buffer_load_dwordx4 v8, s[16:19], s50 offen lds
    ds_read_b64_tr_b16 v[16:17], v2 offset:36864
    ds_read_b64_tr_b16 v[18:19], v2 offset:37376
    ds_read_b64_tr_b16 v[20:21], v2 offset:38912
    ds_read_b64_tr_b16 v[22:23], v2 offset:39424
    ds_read_b64_tr_b16 v[24:25], v2 offset:40960
    ds_read_b64_tr_b16 v[26:27], v2 offset:41472
    ds_read_b64_tr_b16 v[28:29], v2 offset:43008
    ds_read_b64_tr_b16 v[30:31], v2 offset:43520
    ds_read_b64_tr_b16 v[32:33], v2 offset:45056
    ds_read_b64_tr_b16 v[34:35], v2 offset:45568
    ds_read_b64_tr_b16 v[36:37], v2 offset:47104
    ds_read_b64_tr_b16 v[38:39], v2 offset:47616
    s_waitcnt lgkmcnt(10)
    v_mfma_f32_32x32x16_bf16 v[112:127], v[16:19], v[48:51], 0
    ds_read_b64_tr_b16 v[40:41], v2 offset:49152
    ds_read_b64_tr_b16 v[42:43], v2 offset:49664
    s_waitcnt lgkmcnt(10)
    v_mfma_f32_32x32x16_bf16 v[112:127], v[20:23], v[52:55], v[112:127]
    ds_read_b64_tr_b16 v[44:45], v2 offset:51200
    ds_read_b64_tr_b16 v[46:47], v2 offset:51712
    s_waitcnt lgkmcnt(10)
    v_mfma_f32_32x32x16_bf16 v[112:127], v[24:27], v[56:59], v[112:127]
    ds_read_b64_tr_b16 v[16:17], v2 offset:53248
    ds_read_b64_tr_b16 v[18:19], v2 offset:53760
    s_waitcnt lgkmcnt(10)
    v_mfma_f32_32x32x16_bf16 v[112:127], v[28:31], v[60:63], v[112:127]
    ds_read_b64_tr_b16 v[20:21], v3 offset:0
    ds_read_b64_tr_b16 v[22:23], v3 offset:512
    s_nop 3
    s_add_u32 s50, s55, 8192
    v_cvt_pk_bf16_f32 v144, v96, v97
    v_cvt_pk_bf16_f32 v145, v98, v99
    v_cvt_pk_bf16_f32 v146, v100, v101
    v_cvt_pk_bf16_f32 v147, v102, v103
    buffer_store_dwordx4 v[144:147], v7, s[20:23], s50 offen offset:0 sc1
    v_cvt_pk_bf16_f32 v148, v104, v105
    v_cvt_pk_bf16_f32 v149, v106, v107
    v_cvt_pk_bf16_f32 v150, v108, v109
    v_cvt_pk_bf16_f32 v151, v110, v111
    buffer_store_dwordx4 v[148:151], v7, s[20:23], s50 offen offset:1024 sc1
    s_waitcnt lgkmcnt(10)
    v_mfma_f32_32x32x16_bf16 v[112:127], v[32:35], v[64:67], v[112:127]
    ds_read_b64_tr_b16 v[24:25], v3 offset:2048
    ds_read_b64_tr_b16 v[26:27], v3 offset:2560
    s_waitcnt lgkmcnt(10)
    v_mfma_f32_32x32x16_bf16 v[112:127], v[36:39], v[68:71], v[112:127]
    ds_read_b64_tr_b16 v[28:29], v3 offset:4096
    ds_read_b64_tr_b16 v[30:31], v3 offset:4608
    s_waitcnt lgkmcnt(10)
    v_mfma_f32_32x32x16_bf16 v[112:127], v[40:43], v[72:75], v[112:127]
    ds_read_b64_tr_b16 v[32:33], v3 offset:6144
    ds_read_b64_tr_b16 v[34:35], v3 offset:6656
    s_waitcnt lgkmcnt(10)
    v_mfma_f32_32x32x16_bf16 v[112:127], v[44:47], v[76:79], v[112:127]
    ds_read_b64_tr_b16 v[36:37], v3 offset:8192
    ds_read_b64_tr_b16 v[38:39], v3 offset:8704
    s_waitcnt lgkmcnt(10)
    v_mfma_f32_32x32x16_bf16 v[112:127], v[16:19], v[80:83], v[112:127]
    ds_read_b64_tr_b16 v[40:41], v3 offset:10240
    ds_read_b64_tr_b16 v[42:43], v3 offset:10752
    s_waitcnt lgkmcnt(10)
    v_mfma_f32_32x32x16_bf16 v[96:111], v[20:23], v[48:51], 0
    ds_read_b64_tr_b16 v[44:45], v3 offset:12288
    ds_read_b64_tr_b16 v[46:47], v3 offset:12800
    s_waitcnt lgkmcnt(10)
    v_mfma_f32_32x32x16_bf16 v[96:111], v[24:27], v[52:55], v[96:111]
    ds_read_b64_tr_b16 v[16:17], v3 offset:14336
    ds_read_b64_tr_b16 v[18:19], v3 offset:14848
    s_waitcnt lgkmcnt(10)
    v_mfma_f32_32x32x16_bf16 v[96:111], v[28:31], v[56:59], v[96:111]
    ds_read_b64_tr_b16 v[20:21], v3 offset:16384
    ds_read_b64_tr_b16 v[22:23], v3 offset:16896
    s_waitcnt lgkmcnt(10)
    v_mfma_f32_32x32x16_bf16 v[96:111], v[32:35], v[60:63], v[96:111]
    ds_read_b64_tr_b16 v[24:25], v3 offset:18432
    ds_read_b64_tr_b16 v[26:27], v3 offset:18944
    s_nop 3
    s_add_u32 s50, s55, 405504
    v_cvt_pk_bf16_f32 v152, v112, v113
    v_cvt_pk_bf16_f32 v153, v114, v115
    v_cvt_pk_bf16_f32 v154, v116, v117
    v_cvt_pk_bf16_f32 v155, v118, v119
    buffer_store_dwordx4 v[152:155], v7, s[20:23], s50 offen offset:0 sc1
    v_cvt_pk_bf16_f32 v156, v120, v121
    v_cvt_pk_bf16_f32 v157, v122, v123
    v_cvt_pk_bf16_f32 v158, v124, v125
    v_cvt_pk_bf16_f32 v159, v126, v127
    buffer_store_dwordx4 v[156:159], v7, s[20:23], s50 offen offset:1024 sc1
    s_waitcnt lgkmcnt(10)
    v_mfma_f32_32x32x16_bf16 v[96:111], v[36:39], v[64:67], v[96:111]
    ds_read_b64_tr_b16 v[28:29], v3 offset:20480
    ds_read_b64_tr_b16 v[30:31], v3 offset:20992
    s_waitcnt lgkmcnt(10)
    v_mfma_f32_32x32x16_bf16 v[96:111], v[40:43], v[68:71], v[96:111]
    ds_read_b64_tr_b16 v[32:33], v3 offset:22528
    ds_read_b64_tr_b16 v[34:35], v3 offset:23040
    s_waitcnt lgkmcnt(10)
    v_mfma_f32_32x32x16_bf16 v[96:111], v[44:47], v[72:75], v[96:111]
    ds_read_b64_tr_b16 v[36:37], v3 offset:24576
    ds_read_b64_tr_b16 v[38:39], v3 offset:25088
    s_waitcnt lgkmcnt(10)
    v_mfma_f32_32x32x16_bf16 v[96:111], v[16:19], v[76:79], v[96:111]
    ds_read_b64_tr_b16 v[40:41], v3 offset:26624
    ds_read_b64_tr_b16 v[42:43], v3 offset:27136
    s_waitcnt lgkmcnt(10)
    v_mfma_f32_32x32x16_bf16 v[96:111], v[20:23], v[80:83], v[96:111]
    ds_read_b64_tr_b16 v[44:45], v3 offset:28672
    ds_read_b64_tr_b16 v[46:47], v3 offset:29184
    s_waitcnt lgkmcnt(10)
    v_mfma_f32_32x32x16_bf16 v[112:127], v[24:27], v[48:51], 0
    ds_read_b64_tr_b16 v[16:17], v3 offset:30720
    ds_read_b64_tr_b16 v[18:19], v3 offset:31232
    s_waitcnt lgkmcnt(10)
    v_mfma_f32_32x32x16_bf16 v[112:127], v[28:31], v[52:55], v[112:127]
    ds_read_b64_tr_b16 v[20:21], v3 offset:32768
    ds_read_b64_tr_b16 v[22:23], v3 offset:33280
    s_waitcnt lgkmcnt(10)
    v_mfma_f32_32x32x16_bf16 v[112:127], v[32:35], v[56:59], v[112:127]
    ds_read_b64_tr_b16 v[24:25], v3 offset:34816
    ds_read_b64_tr_b16 v[26:27], v3 offset:35328
    s_waitcnt lgkmcnt(10)
    v_mfma_f32_32x32x16_bf16 v[112:127], v[36:39], v[60:63], v[112:127]
    s_nop 3
    s_add_u32 s50, s55, 409600
    v_cvt_pk_bf16_f32 v128, v96, v97
    v_cvt_pk_bf16_f32 v129, v98, v99
    v_cvt_pk_bf16_f32 v130, v100, v101
    v_cvt_pk_bf16_f32 v131, v102, v103
    buffer_store_dwordx4 v[128:131], v7, s[20:23], s50 offen offset:0 sc1
    v_cvt_pk_bf16_f32 v132, v104, v105
    v_cvt_pk_bf16_f32 v133, v106, v107
    v_cvt_pk_bf16_f32 v134, v108, v109
    v_cvt_pk_bf16_f32 v135, v110, v111
    buffer_store_dwordx4 v[132:135], v7, s[20:23], s50 offen offset:1024 sc1
    s_waitcnt lgkmcnt(8)
    v_mfma_f32_32x32x16_bf16 v[112:127], v[40:43], v[64:67], v[112:127]
    s_waitcnt lgkmcnt(6)
    v_mfma_f32_32x32x16_bf16 v[112:127], v[44:47], v[68:71], v[112:127]
    s_waitcnt lgkmcnt(4)
    v_mfma_f32_32x32x16_bf16 v[112:127], v[16:19], v[72:75], v[112:127]
    s_waitcnt lgkmcnt(2)
    v_mfma_f32_32x32x16_bf16 v[112:127], v[20:23], v[76:79], v[112:127]
    s_waitcnt lgkmcnt(0)
    v_mfma_f32_32x32x16_bf16 v[112:127], v[24:27], v[80:83], v[112:127]
    s_waitcnt vmcnt(6)
    s_barrier
    ds_read_b64_tr_b16 v[16:17], v4 offset:0
    ds_read_b64_tr_b16 v[18:19], v4 offset:512
    ds_read_b64_tr_b16 v[20:21], v4 offset:2048
    ds_read_b64_tr_b16 v[22:23], v4 offset:2560
    ds_read_b64_tr_b16 v[24:25], v4 offset:4096
    ds_read_b64_tr_b16 v[26:27], v4 offset:4608
    ds_read_b64_tr_b16 v[28:29], v4 offset:6144
    ds_read_b64_tr_b16 v[30:31], v4 offset:6656
    ds_read_b64_tr_b16 v[32:33], v4 offset:8192
    ds_read_b64_tr_b16 v[34:35], v4 offset:8704
    ds_read_b64_tr_b16 v[36:37], v4 offset:10240
    ds_read_b64_tr_b16 v[38:39], v4 offset:10752
    s_waitcnt lgkmcnt(10)
    v_mfma_f32_32x32x16_bf16 v[96:111], v[16:19], v[48:51], 0
    ds_read_b64_tr_b16 v[40:41], v4 offset:12288
    ds_read_b64_tr_b16 v[42:43], v4 offset:12800
    s_waitcnt lgkmcnt(10)
    v_mfma_f32_32x32x16_bf16 v[96:111], v[20:23], v[52:55], v[96:111]
    ds_read_b64_tr_b16 v[44:45], v4 offset:14336
    ds_read_b64_tr_b16 v[46:47], v4 offset:14848
    s_waitcnt lgkmcnt(10)
    v_mfma_f32_32x32x16_bf16 v[96:111], v[24:27], v[56:59], v[96:111]
    ds_read_b64_tr_b16 v[16:17], v4 offset:16384
    ds_read_b64_tr_b16 v[18:19], v4 offset:16896
    s_waitcnt lgkmcnt(10)
    v_mfma_f32_32x32x16_bf16 v[96:111], v[28:31], v[60:63], v[96:111]
    ds_read_b64_tr_b16 v[20:21], v2 offset:0
    ds_read_b64_tr_b16 v[22:23], v2 offset:512
    s_nop 3
    s_add_u32 s50, s55, 413696
    v_cvt_pk_bf16_f32 v136, v112, v113
    v_cvt_pk_bf16_f32 v137, v114, v115
    v_cvt_pk_bf16_f32 v138, v116, v117
    v_cvt_pk_bf16_f32 v139, v118, v119
    buffer_store_dwordx4 v[136:139], v7, s[20:23], s50 offen offset:0 sc1
    v_cvt_pk_bf16_f32 v140, v120, v121
    v_cvt_pk_bf16_f32 v141, v122, v123
    v_cvt_pk_bf16_f32 v142, v124, v125
    v_cvt_pk_bf16_f32 v143, v126, v127
    buffer_store_dwordx4 v[140:143], v7, s[20:23], s50 offen offset:1024 sc1
    s_waitcnt lgkmcnt(10)
    v_mfma_f32_32x32x16_bf16 v[96:111], v[32:35], v[64:67], v[96:111]
    ds_read_b64_tr_b16 v[24:25], v2 offset:2048
    ds_read_b64_tr_b16 v[26:27], v2 offset:2560
    s_waitcnt lgkmcnt(10)
    v_mfma_f32_32x32x16_bf16 v[96:111], v[36:39], v[68:71], v[96:111]
    ds_read_b64_tr_b16 v[28:29], v2 offset:4096
    ds_read_b64_tr_b16 v[30:31], v2 offset:4608
    s_waitcnt lgkmcnt(10)
    v_mfma_f32_32x32x16_bf16 v[96:111], v[40:43], v[72:75], v[96:111]
    ds_read_b64_tr_b16 v[32:33], v2 offset:6144
    ds_read_b64_tr_b16 v[34:35], v2 offset:6656
    s_waitcnt lgkmcnt(10)
    v_mfma_f32_32x32x16_bf16 v[96:111], v[44:47], v[76:79], v[96:111]
    ds_read_b64_tr_b16 v[36:37], v2 offset:8192
    ds_read_b64_tr_b16 v[38:39], v2 offset:8704
    s_waitcnt lgkmcnt(10)
    v_mfma_f32_32x32x16_bf16 v[96:111], v[16:19], v[80:83], v[96:111]
    ds_read_b64_tr_b16 v[40:41], v2 offset:10240
    ds_read_b64_tr_b16 v[42:43], v2 offset:10752
    s_waitcnt lgkmcnt(10)
    v_mfma_f32_32x32x16_bf16 v[112:127], v[20:23], v[48:51], 0
    ds_read_b64_tr_b16 v[44:45], v2 offset:12288
    ds_read_b64_tr_b16 v[46:47], v2 offset:12800
    s_waitcnt lgkmcnt(10)
    v_mfma_f32_32x32x16_bf16 v[112:127], v[24:27], v[52:55], v[112:127]
    ds_read_b64_tr_b16 v[16:17], v2 offset:14336
    ds_read_b64_tr_b16 v[18:19], v2 offset:14848
    s_waitcnt lgkmcnt(10)
    v_mfma_f32_32x32x16_bf16 v[112:127], v[28:31], v[56:59], v[112:127]
    ds_read_b64_tr_b16 v[20:21], v2 offset:16384
    ds_read_b64_tr_b16 v[22:23], v2 offset:16896
    s_waitcnt lgkmcnt(10)
    v_mfma_f32_32x32x16_bf16 v[112:127], v[32:35], v[60:63], v[112:127]
    ds_read_b64_tr_b16 v[24:25], v2 offset:18432
    ds_read_b64_tr_b16 v[26:27], v2 offset:18944
    s_nop 3
    s_add_u32 s50, s55, 811008
    v_cvt_pk_bf16_f32 v144, v96, v97
    v_cvt_pk_bf16_f32 v145, v98, v99
    v_cvt_pk_bf16_f32 v146, v100, v101
    v_cvt_pk_bf16_f32 v147, v102, v103
    buffer_store_dwordx4 v[144:147], v7, s[20:23], s50 offen offset:0 sc1
    v_cvt_pk_bf16_f32 v148, v104, v105
    v_cvt_pk_bf16_f32 v149, v106, v107
    v_cvt_pk_bf16_f32 v150, v108, v109
    v_cvt_pk_bf16_f32 v151, v110, v111
    buffer_store_dwordx4 v[148:151], v7, s[20:23], s50 offen offset:1024 sc1
    s_waitcnt lgkmcnt(10)
    v_mfma_f32_32x32x16_bf16 v[112:127], v[36:39], v[64:67], v[112:127]
    ds_read_b64_tr_b16 v[28:29], v2 offset:20480
    ds_read_b64_tr_b16 v[30:31], v2 offset:20992
    s_waitcnt lgkmcnt(10)
    v_mfma_f32_32x32x16_bf16 v[112:127], v[40:43], v[68:71], v[112:127]
    ds_read_b64_tr_b16 v[32:33], v2 offset:22528
    ds_read_b64_tr_b16 v[34:35], v2 offset:23040
    s_waitcnt lgkmcnt(10)
    v_mfma_f32_32x32x16_bf16 v[112:127], v[44:47], v[72:75], v[112:127]
    ds_read_b64_tr_b16 v[36:37], v2 offset:24576
    ds_read_b64_tr_b16 v[38:39], v2 offset:25088
    s_waitcnt lgkmcnt(10)
    v_mfma_f32_32x32x16_bf16 v[112:127], v[16:19], v[76:79], v[112:127]
    ds_read_b64_tr_b16 v[40:41], v2 offset:26624
    ds_read_b64_tr_b16 v[42:43], v2 offset:27136
    s_waitcnt lgkmcnt(10)
    v_mfma_f32_32x32x16_bf16 v[112:127], v[20:23], v[80:83], v[112:127]
    ds_read_b64_tr_b16 v[44:45], v2 offset:28672
    ds_read_b64_tr_b16 v[46:47], v2 offset:29184
    s_waitcnt lgkmcnt(10)
    v_mfma_f32_32x32x16_bf16 v[96:111], v[24:27], v[48:51], 0
    ds_read_b64_tr_b16 v[16:17], v2 offset:30720
    ds_read_b64_tr_b16 v[18:19], v2 offset:31232
    s_waitcnt lgkmcnt(10)
    v_mfma_f32_32x32x16_bf16 v[96:111], v[28:31], v[52:55], v[96:111]
    ds_read_b64_tr_b16 v[20:21], v2 offset:32768
    ds_read_b64_tr_b16 v[22:23], v2 offset:33280
    s_waitcnt lgkmcnt(10)
    v_mfma_f32_32x32x16_bf16 v[96:111], v[32:35], v[56:59], v[96:111]
    ds_read_b64_tr_b16 v[24:25], v2 offset:34816
    ds_read_b64_tr_b16 v[26:27], v2 offset:35328
    s_waitcnt lgkmcnt(10)
    v_mfma_f32_32x32x16_bf16 v[96:111], v[36:39], v[60:63], v[96:111]
    s_nop 3
    s_add_u32 s50, s55, 815104
    v_cvt_pk_bf16_f32 v152, v112, v113
    v_cvt_pk_bf16_f32 v153, v114, v115
    v_cvt_pk_bf16_f32 v154, v116, v117
    v_cvt_pk_bf16_f32 v155, v118, v119
    buffer_store_dwordx4 v[152:155], v7, s[20:23], s50 offen offset:0 sc1
    v_cvt_pk_bf16_f32 v156, v120, v121
    v_cvt_pk_bf16_f32 v157, v122, v123
    v_cvt_pk_bf16_f32 v158, v124, v125
    v_cvt_pk_bf16_f32 v159, v126, v127
    buffer_store_dwordx4 v[156:159], v7, s[20:23], s50 offen offset:1024 sc1
    s_waitcnt lgkmcnt(8)
    v_mfma_f32_32x32x16_bf16 v[96:111], v[40:43], v[64:67], v[96:111]
    s_waitcnt lgkmcnt(6)
    v_mfma_f32_32x32x16_bf16 v[96:111], v[44:47], v[68:71], v[96:111]
    s_waitcnt lgkmcnt(4)
    v_mfma_f32_32x32x16_bf16 v[96:111], v[16:19], v[72:75], v[96:111]
    s_waitcnt lgkmcnt(2)
    v_mfma_f32_32x32x16_bf16 v[96:111], v[20:23], v[76:79], v[96:111]
    s_waitcnt lgkmcnt(0)
    v_mfma_f32_32x32x16_bf16 v[96:111], v[24:27], v[80:83], v[96:111]
    s_nop 7
    s_nop 3
    s_add_u32 s50, s55, 819200
    v_cvt_pk_bf16_f32 v128, v96, v97
    v_cvt_pk_bf16_f32 v129, v98, v99
    v_cvt_pk_bf16_f32 v130, v100, v101
    v_cvt_pk_bf16_f32 v131, v102, v103
    buffer_store_dwordx4 v[128:131], v7, s[20:23], s50 offen offset:0 sc1
    v_cvt_pk_bf16_f32 v132, v104, v105
    v_cvt_pk_bf16_f32 v133, v106, v107
    v_cvt_pk_bf16_f32 v134, v108, v109
    v_cvt_pk_bf16_f32 v135, v110, v111
    buffer_store_dwordx4 v[132:135], v7, s[20:23], s50 offen offset:1024 sc1
    s_waitcnt vmcnt(0)
    v_mov_b32 v60, 1
    v_mov_b32 v61, 1
    v_mov_b32 v62, 1
    v_mov_b32 v63, 1
    s_add_u32 s51, s99, 0
    s_mov_b64 exec, 0xff
    buffer_store_dwordx4 v[60:63], v7, s[20:23], s51 offen sc1
    s_mov_b64 exec, -1
    s_nop 0
L_end:
    s_endpgm
L_codeend:
.section .rodata,"a"
.p2align 6
.amdhsa_kernel gated_mix__sliding_local_dilated__glu_gated_glu__prompt_kernel
  .amdhsa_next_free_vgpr 256
  .amdhsa_next_free_sgpr 102
  .amdhsa_accum_offset 256
  .amdhsa_group_segment_fixed_size 0
  .amdhsa_kernarg_size 88
  .amdhsa_user_sgpr_count 2
  .amdhsa_user_sgpr_kernarg_segment_ptr 1
  .amdhsa_system_sgpr_workgroup_id_x 1
.end_amdhsa_kernel
```
